```python
import torch

def _softmax(x, axis=-1):
    return torch.softmax(x, dim=axis)
def _gelu(x):
    return torch.nn.functional.gelu(x, approximate="tanh")
def _silu(x):
    return torch.nn.functional.silu(x)
def _sigmoid(x):
    return torch.sigmoid(x)
def _layernorm(x, axis=-1, eps=1e-5):
    m = x.mean(dim=axis, keepdim=True)
    v = x.var(dim=axis, keepdim=True, unbiased=False)
    return (x - m) / torch.sqrt(v + eps)
def _scatter_add(tgt, idx, src, axis=0):
    return tgt.clone().index_add_(axis, idx, src)
def _segment_sum(src, seg, n):
    out = torch.zeros((n,) + src.shape[1:], dtype=src.dtype)
    return out.index_add_(0, seg, src)
def _pad(x, pw):
    flat = tuple(v for pair in reversed(pw) for v in pair)
    return torch.nn.functional.pad(x, flat)

kernel_name = 'recurrent_scan__linear_kernel_hedgehog__dense_activation_squared_relu__prompt'

def setup_inputs():

    _w = (lambda a: (lambda t: t.to(torch.bfloat16) if t.is_floating_point() else t)(torch.as_tensor(a)))
    def _A_setup():
        B, S, D, H = 1, 2048, 1024, 32
        Dh = D // H
        return {
            "x": _w((lambda *s: torch.randn(*s, dtype=torch.bfloat16) * 0.05)(B, S, D)),
            "wqkv": _w((lambda *s: torch.randn(*s, dtype=torch.bfloat16) * 0.2)(D, 3 * D)),
            "w_phi": _w((lambda *s: torch.randn(*s, dtype=torch.bfloat16) * 0.2)(H, Dh, Dh) * (Dh ** -0.5)),
            "wo": _w((lambda *s: torch.randn(*s, dtype=torch.bfloat16) * 0.05)(D, D)),
        }
    _A_in = _A_setup()

    def _B_setup():
        B, S, D, F = 1, 2048, 1024, 3584
        return {
            "x": _w((lambda *s: torch.randn(*s, dtype=torch.bfloat16) * 0.05)(B, S, D)),
            "w1": _w((lambda *s: torch.randn(*s, dtype=torch.bfloat16) * 0.05)(D, F)),
            "b1": _w((lambda *s: torch.randn(*s, dtype=torch.bfloat16) * 0.4)(F)),
            "w2": _w((lambda *s: torch.randn(*s, dtype=torch.bfloat16) * 0.05)(F, D)),
            "b2": _w((lambda *s: torch.randn(*s, dtype=torch.bfloat16) * 3.2)(D)),
        }
    _B_in = _B_setup()

    return {
        "A_x": _A_in["x"],
        "A_wqkv": _A_in["wqkv"],
        "A_w_phi": _A_in["w_phi"],
        "A_wo": _A_in["wo"],
        "B_x": _B_in["x"],
        "B_w1": _B_in["w1"],
        "B_b1": _B_in["b1"],
        "B_w2": _B_in["w2"],
        "B_b2": _B_in["b2"],
    }

def reference(A_x, A_wqkv, A_w_phi, A_wo, B_x, B_w1, B_b1, B_w2, B_b2):
    def _A_ref(x, wqkv, w_phi, wo):
        B, S, D = x.shape
        H = 32; Dh = D // H
        qkv = (lambda x, *d: x.permute(*d))((x @ wqkv).reshape(B, S, 3, H, Dh), 2, 0, 3, 1, 4)
        q, k, v = qkv[0], qkv[1], qkv[2]
        pq = torch.einsum("bhsd,hdf->bhsf", q, w_phi)
        pk = torch.einsum("bhsd,hdf->bhsf", k, w_phi)
        phi_q = torch.concatenate([_softmax(pq, axis=-1), _softmax(-pq, axis=-1)], axis=-1)
        phi_k = torch.concatenate([_softmax(pk, axis=-1), _softmax(-pk, axis=-1)], axis=-1)
        kv = torch.einsum("bhsf,bhsd->bhfd", phi_k, v)
        z  = torch.einsum("bhsf->bhf", phi_k)
        num = torch.einsum("bhqf,bhfd->bhqd", phi_q, kv)
        den = torch.einsum("bhqf,bhf->bhq", phi_q, z)[..., None] + 1e-6
        o = num / den
        return (lambda x, *d: x.permute(*d))(o, 0, 2, 1, 3).reshape(B, S, D) @ wo

    def _B_ref(x, w1, b1, w2, b2):
        h = torch.einsum("bsd,df->bsf", x, w1) + b1
        zero = torch.zeros_like(h)
        r = torch.where(h > zero, h, zero)
        h = r * r
        out = torch.einsum("bsf,fd->bsd", h, w2) + b2
        return out

    x = A_x
    xn = _layernorm(x, axis=-1)
    s = _A_ref(xn, A_wqkv, A_w_phi, A_wo)
    g = _silu(_B_ref(xn, B_w1, B_b1, B_w2, B_b2))
    return x + s * g
```

```asm
; @launch grid=(256,1,1) block=(512,1,1) lds=163840
.amdgcn_target "amdgcn-amd-amdhsa--gfx950"
.text
.p2align 12
.fill 832, 4, 0xbf810000
.globl recurrent_scan__linear_kernel_hedgehog__dense_activation_squared_relu__prompt_kernel
.p2align 8
.type recurrent_scan__linear_kernel_hedgehog__dense_activation_squared_relu__prompt_kernel,@function
recurrent_scan__linear_kernel_hedgehog__dense_activation_squared_relu__prompt_kernel:
  s_cmp_ge_u32 s2, 256
  s_cbranch_scc1 L_exit0
  s_load_dwordx2 s[8:9], s[0:1], 0
  s_load_dwordx2 s[16:17], s[0:1], 88
  s_load_dwordx2 s[20:21], s[0:1], 80
  s_load_dwordx2 s[28:29], s[0:1], 56
  s_load_dwordx2 s[32:33], s[0:1], 24
  s_load_dwordx2 s[36:37], s[0:1], 72
  s_load_dwordx2 s[40:41], s[0:1], 64
  v_lshrrev_b32 v1, 6, v0
  v_and_b32 v0, 63, v0
  v_readfirstlane_b32 s44, v1
  s_cmp_ge_u32 s44, 4
  s_cbranch_scc1 L_role_B
  s_load_dwordx2 s[12:13], s[0:1], 8
  s_load_dwordx2 s[24:25], s[0:1], 16
  s_mov_b32 s14, 0x600000
  s_mov_b32 s26, 0x10000
  s_and_b32 s49, s2, 3
  s_bfe_u32 s51, s2, 0x10002
  s_lshr_b32 s47, s2, 6
  s_lshl_b32 s52, s51, 2
  s_add_u32 s46, s52, s47
  s_bfe_u32 s48, s2, 0x30003
  s_lshl_b32 s50, s49, 3
  s_add_u32 s50, s50, s48
  s_and_b32 s45, s44, 3
  s_mov_b32 s10, 0x400000
  s_mov_b32 s11, 0x20000
  s_mov_b32 s18, 0x10000000
  s_mov_b32 s19, 0x20000
  s_mov_b32 s22, 0x100
  s_mov_b32 s23, 0x20000
  s_mov_b32 s30, 0x700000
  s_mov_b32 s31, 0x20000
  s_mov_b32 s34, 0x200000
  s_mov_b32 s35, 0x20000
  s_mov_b32 s38, 0x400000
  s_mov_b32 s39, 0x20000
  s_mov_b32 s42, 0x800
  s_mov_b32 s43, 0x20000
  s_mov_b32 s15, 0x20000
  s_mov_b32 s27, 0x20000
  s_lshl_b32 s52, s46, 8
  s_lshl_b32 s53, s44, 5
  s_add_u32 s52, s52, s53
  v_lshrrev_b32 v2, 3, v0
  v_add_u32 v2, s52, v2
  v_lshlrev_b32 v2, 11, v2
  v_lshrrev_b32 v3, 4, v0
  v_and_b32 v4, 7, v0
  v_xor_b32 v5, v4, v3
  v_lshl_add_u32 v236, v5, 4, v2
  v_add_u32 v3, 4, v3
  v_xor_b32 v5, v4, v3
  v_lshl_add_u32 v237, v5, 4, v2
  v_add_u32 v237, 0x3c00, v237
  s_lshl_b32 s62, s44, 12
  s_add_u32 s6, s62, 2048
  s_lshl_b32 s60, s51, 10
  s_lshl_b32 s3, s46, 5
  s_add_u32 s3, s3, s50
  s_lshl_b32 s3, s3, 3
  s_add_u32 s3, s3, s44
  s_lshl_b32 s54, s3, 11
  v_lshlrev_b32 v1, 4, v0
  s_waitcnt lgkmcnt(0)
  buffer_load_dwordx4 v[216:219], v1, s[8:11], s54 offen
  buffer_load_dwordx4 v[220:223], v1, s[8:11], s54 offen offset:1024
  s_add_u32 s52, s60, 0
  s_and_b32 s52, s52, 0x7ff
  s_mov_b32 s53, 0
  s_add_u32 m0, s53, s62
  s_nop 0
  buffer_load_dwordx4 v236, s[8:11], s52 offen lds
  buffer_load_dwordx4 v237, s[8:11], s52 offen offset:1024 lds
  s_mov_b32 s4, 0xffffffff
  s_mov_b32 s5, 0xffff
  v_mul_u32_u24 v2, 43, v0
  v_lshrrev_b32 v2, 9, v2
  v_mul_u32_u24 v3, 12, v2
  v_sub_u32 v3, v0, v3
  s_lshr_b32 s52, s45, 1
  s_lshl_b32 s52, s52, 4
  s_and_b32 s53, s45, 1
  s_lshl_b32 s53, s53, 2
  s_add_u32 s52, s52, s53
  v_add_u32 v2, s52, v2
  v_mul_u32_u24 v2, 0x1800, v2
  v_lshrrev_b32 v4, 2, v3
  v_lshl_add_u32 v2, v4, 11, v2
  s_lshl_b32 s52, s50, 6
  v_add_u32 v2, s52, v2
  v_and_b32 v3, 3, v3
  v_lshl_add_u32 v238, v3, 4, v2
  v_xor_b32 v3, 2, v3
  v_lshl_add_u32 v239, v3, 4, v2
  v_add_u32 v239, 0xbd00, v239
  s_mul_i32 s63, s45, 1536
  s_add_u32 s63, s63, 98304
  s_lshr_b32 s52, s60, 1
  s_mul_i32 s61, s52, 6144
  v_and_b32 v2, 15, v0
  v_lshrrev_b32 v3, 4, v0
  v_lshrrev_b32 v4, 1, v3
  v_lshlrev_b32 v4, 4, v4
  v_and_b32 v5, 1, v3
  v_lshl_add_u32 v4, v5, 2, v4
  v_lshrrev_b32 v6, 2, v2
  v_add_u32 v4, v4, v6
  v_mul_u32_u24 v4, 192, v4
  v_and_b32 v6, 3, v2
  v_lshl_add_u32 v4, v6, 3, v4
  v_add_u32 v4, 98304, v4
  v_lshl_add_u32 v242, v5, 5, v4
  v_xor_b32 v243, 32, v242
  v_lshrrev_b32 v4, 1, v2
  v_xor_b32 v4, v4, v3
  s_lshl_b32 s52, s45, 6
  v_add_u32 v2, s52, v2
  v_lshlrev_b32 v2, 7, v2
  v_lshl_add_u32 v240, v4, 4, v2
  v_xor_b32 v241, 64, v240
  s_mov_b32 m0, s63
  s_mov_b64 exec, s[4:5]
  buffer_load_dwordx4 v238, s[12:15], s61 offen lds
  buffer_load_dwordx4 v239, s[12:15], s61 offen offset:768 lds
  s_mov_b64 exec, -1
  s_add_u32 s63, s63, 13312
  s_add_u32 s61, s61, 196608
  s_cmp_eq_u32 s61, 6291456
  s_cselect_b32 s61, 0, s61
  v_mov_b64 v[4:5], 0
  v_mov_b64 v[6:7], 0
  v_mov_b64 v[8:9], 0
  v_mov_b64 v[10:11], 0
  v_mov_b64 v[16:17], 0
  v_mov_b64 v[18:19], 0
  v_mov_b64 v[20:21], 0
  v_mov_b64 v[22:23], 0
  v_mov_b64 v[24:25], 0
  v_mov_b64 v[26:27], 0
  v_mov_b64 v[28:29], 0
  v_mov_b64 v[30:31], 0
  v_mov_b64 v[32:33], 0
  v_mov_b64 v[34:35], 0
  v_mov_b64 v[36:37], 0
  v_mov_b64 v[38:39], 0
  v_mov_b64 v[40:41], 0
  v_mov_b64 v[42:43], 0
  v_mov_b64 v[44:45], 0
  v_mov_b64 v[46:47], 0
  v_mov_b64 v[48:49], 0
  v_mov_b64 v[50:51], 0
  v_mov_b64 v[52:53], 0
  v_mov_b64 v[54:55], 0
  v_mov_b64 v[56:57], 0
  v_mov_b64 v[58:59], 0
  v_mov_b64 v[60:61], 0
  v_mov_b64 v[62:63], 0
  v_mov_b64 v[64:65], 0
  v_mov_b64 v[66:67], 0
  s_add_u32 s52, s60, 0
  s_and_b32 s52, s52, 0x7ff
  s_add_u32 s52, s52, 32768
  s_mov_b32 s53, 0
  s_add_u32 m0, s53, s6
  s_nop 0
  buffer_load_dwordx4 v236, s[8:11], s52 offen lds
  buffer_load_dwordx4 v237, s[8:11], s52 offen offset:1024 lds
  s_waitcnt vmcnt(6)
  v_mov_b32 v12, 0
  s_mov_b32 s52, 0x3f803f80
  v_dot2c_f32_bf16 v12, s52, v216
  v_dot2c_f32_bf16 v12, s52, v217
  v_dot2c_f32_bf16 v12, s52, v218
  v_dot2c_f32_bf16 v12, s52, v219
  v_dot2c_f32_bf16 v12, s52, v220
  v_dot2c_f32_bf16 v12, s52, v221
  v_dot2c_f32_bf16 v12, s52, v222
  v_dot2c_f32_bf16 v12, s52, v223
  s_nop 2
  v_add_f32_dpp v12, v12, v12 row_ror:8 row_mask:0xf bank_mask:0xf
  s_nop 1
  v_add_f32_dpp v12, v12, v12 row_ror:4 row_mask:0xf bank_mask:0xf
  s_nop 1
  v_add_f32_dpp v12, v12, v12 row_ror:2 row_mask:0xf bank_mask:0xf
  s_nop 1
  v_add_f32_dpp v12, v12, v12 row_ror:1 row_mask:0xf bank_mask:0xf
  v_mov_b32 v13, v12
  s_nop 1
  v_permlane16_swap_b32 v12, v13
  v_add_f32 v12, v12, v13
  v_mov_b32 v13, v12
  s_nop 1
  v_permlane32_swap_b32 v12, v13
  v_add_f32 v12, v12, v13
  v_mul_f32 v12, 0x3a800000, v12
  v_lshlrev_b32 v172, 16, v216
  v_and_b32 v173, 0xffff0000, v216
  v_lshlrev_b32 v174, 16, v217
  v_and_b32 v175, 0xffff0000, v217
  v_lshlrev_b32 v176, 16, v218
  v_and_b32 v177, 0xffff0000, v218
  v_lshlrev_b32 v178, 16, v219
  v_and_b32 v179, 0xffff0000, v219
  v_lshlrev_b32 v180, 16, v220
  v_and_b32 v181, 0xffff0000, v220
  v_lshlrev_b32 v182, 16, v221
  v_and_b32 v183, 0xffff0000, v221
  v_lshlrev_b32 v184, 16, v222
  v_and_b32 v185, 0xffff0000, v222
  v_lshlrev_b32 v186, 16, v223
  v_and_b32 v187, 0xffff0000, v223
  v_sub_f32 v172, v172, v12
  v_sub_f32 v173, v173, v12
  v_sub_f32 v174, v174, v12
  v_sub_f32 v175, v175, v12
  v_sub_f32 v176, v176, v12
  v_sub_f32 v177, v177, v12
  v_sub_f32 v178, v178, v12
  v_sub_f32 v179, v179, v12
  v_sub_f32 v180, v180, v12
  v_sub_f32 v181, v181, v12
  v_sub_f32 v182, v182, v12
  v_sub_f32 v183, v183, v12
  v_sub_f32 v184, v184, v12
  v_sub_f32 v185, v185, v12
  v_sub_f32 v186, v186, v12
  v_sub_f32 v187, v187, v12
  v_mul_f32 v14, v172, v172
  v_mul_f32 v15, v173, v173
  v_fmac_f32 v14, v174, v174
  v_fmac_f32 v15, v175, v175
  v_fmac_f32 v14, v176, v176
  v_fmac_f32 v15, v177, v177
  v_fmac_f32 v14, v178, v178
  v_fmac_f32 v15, v179, v179
  v_fmac_f32 v14, v180, v180
  v_fmac_f32 v15, v181, v181
  v_fmac_f32 v14, v182, v182
  v_fmac_f32 v15, v183, v183
  v_fmac_f32 v14, v184, v184
  v_fmac_f32 v15, v185, v185
  v_fmac_f32 v14, v186, v186
  v_fmac_f32 v15, v187, v187
  v_add_f32 v14, v14, v15
  s_nop 1
  v_add_f32_dpp v14, v14, v14 row_ror:8 row_mask:0xf bank_mask:0xf
  s_nop 1
  v_add_f32_dpp v14, v14, v14 row_ror:4 row_mask:0xf bank_mask:0xf
  s_nop 1
  v_add_f32_dpp v14, v14, v14 row_ror:2 row_mask:0xf bank_mask:0xf
  s_nop 1
  v_add_f32_dpp v14, v14, v14 row_ror:1 row_mask:0xf bank_mask:0xf
  v_mov_b32 v13, v14
  s_nop 1
  v_permlane16_swap_b32 v14, v13
  v_add_f32 v14, v14, v13
  v_mov_b32 v13, v14
  s_nop 1
  v_permlane32_swap_b32 v14, v13
  v_add_f32 v14, v14, v13
  v_mul_f32 v14, 0x3a800000, v14
  v_cvt_pk_bf16_f32 v12, v12, v12
  v_lshlrev_b32 v12, 16, v12
  v_cvt_pk_bf16_f32 v14, v14, v14
  v_lshlrev_b32 v14, 16, v14
  v_add_f32 v14, 0x3727c5ac, v14
  v_cvt_pk_bf16_f32 v14, v14, v14
  v_lshlrev_b32 v14, 16, v14
  v_sqrt_f32 v14, v14
  s_nop 0
  v_cvt_pk_bf16_f32 v14, v14, v14
  v_lshlrev_b32 v14, 16, v14
  v_rcp_f32 v13, v14
  s_lshl_b32 s52, s3, 3
  v_mov_b32 v14, 0
  s_mov_b64 exec, 1
  buffer_store_dwordx2 v[12:13], v14, s[16:19], s52 offen offset:0 sc1
  s_mov_b64 exec, -1
  s_mov_b32 m0, s63
  s_mov_b64 exec, s[4:5]
  buffer_load_dwordx4 v238, s[12:15], s61 offen lds
  buffer_load_dwordx4 v239, s[12:15], s61 offen offset:768 lds
  s_mov_b64 exec, -1
  s_add_u32 s63, s63, 13312
  s_add_u32 s61, s61, 196608
  s_cmp_eq_u32 s61, 6291456
  s_cselect_b32 s61, 0, s61
L_main_A:
  v_mov_b64 v[68:69], 0
  v_mov_b64 v[70:71], 0
  v_mov_b64 v[72:73], 0
  v_mov_b64 v[74:75], 0
  v_mov_b64 v[76:77], 0
  v_mov_b64 v[78:79], 0
  v_mov_b64 v[80:81], 0
  v_mov_b64 v[82:83], 0
  v_mov_b64 v[84:85], 0
  v_mov_b64 v[86:87], 0
  v_mov_b64 v[88:89], 0
  v_mov_b64 v[90:91], 0
  v_mov_b64 v[92:93], 0
  v_mov_b64 v[94:95], 0
  v_mov_b64 v[96:97], 0
  v_mov_b64 v[98:99], 0
  v_mov_b64 v[116:117], 0
  v_mov_b64 v[118:119], 0
  v_mov_b64 v[120:121], 0
  v_mov_b64 v[122:123], 0
  v_mov_b64 v[124:125], 0
  v_mov_b64 v[126:127], 0
  v_mov_b64 v[128:129], 0
  v_mov_b64 v[130:131], 0
  v_mov_b64 v[132:133], 0
  v_mov_b64 v[134:135], 0
  v_mov_b64 v[136:137], 0
  v_mov_b64 v[138:139], 0
  v_mov_b64 v[12:13], 0
  v_mov_b64 v[14:15], 0
  v_and_b32 v2, 15, v0
  v_lshrrev_b32 v3, 4, v0
  s_lshl_b32 s52, s45, 6
  v_add_u32 v4, s52, v2
  v_and_b32 v5, 4, v2
  v_bfe_u32 v6, v2, 3, 1
  v_lshl_add_u32 v5, v6, 1, v5
  v_bfe_u32 v6, v2, 1, 1
  v_or_b32 v5, v5, v6
  v_xor_b32 v5, v5, v3
  v_lshlrev_b32 v5, 3, v5
  v_lshl_add_u32 v5, v4, 6, v5
  v_add_u32 v108, 106496, v5
  v_xor_b32 v109, 32, v108
  v_bfe_u32 v6, v2, 1, 1
  v_bfe_u32 v7, v2, 2, 1
  v_lshlrev_b32 v7, 3, v7
  v_lshl_add_u32 v7, v6, 2, v7
  v_bfe_u32 v6, v2, 3, 1
  v_lshl_add_u32 v7, v6, 1, v7
  v_and_b32 v6, 1, v2
  v_or_b32 v7, v7, v6
  v_xor_b32 v7, v7, v3
  v_lshlrev_b32 v7, 3, v7
  v_lshl_add_u32 v7, v4, 7, v7
  v_add_u32 v110, 73728, v7
  v_xor_b32 v111, 32, v110
  v_xor_b32 v112, 64, v110
  v_xor_b32 v113, 96, v110
  v_lshrrev_b32 v5, 2, v2
  v_lshl_add_u32 v5, v3, 2, v5
  v_and_b32 v6, 3, v2
  v_bfe_u32 v7, v5, 2, 1
  v_lshlrev_b32 v7, 3, v7
  v_bfe_u32 v8, v5, 1, 1
  v_lshl_add_u32 v7, v8, 2, v7
  v_bfe_u32 v8, v5, 3, 1
  v_lshl_add_u32 v7, v8, 1, v7
  v_and_b32 v8, 1, v5
  v_or_b32 v7, v7, v8
  s_lshl_b32 s52, s45, 2
  v_or_b32 v8, s52, v6
  v_xor_b32 v7, v7, v8
  v_lshlrev_b32 v7, 3, v7
  v_lshl_add_u32 v7, v5, 7, v7
  v_add_u32 v114, 73728, v7
  v_and_b32 v7, 4, v5
  v_bfe_u32 v8, v5, 3, 1
  v_lshl_add_u32 v7, v8, 1, v7
  v_bfe_u32 v8, v5, 1, 1
  v_or_b32 v7, v7, v8
  v_xor_b32 v7, v7, v6
  v_lshlrev_b32 v7, 3, v7
  v_lshl_add_u32 v7, v5, 6, v7
  v_add_u32 v115, 106496, v7
  v_xor_b32 v140, 32, v115
  v_lshlrev_b32 v7, 6, v5
  v_lshl_add_u32 v7, v6, 3, v7
  v_add_u32 v141, 155648, v7
  v_mov_b32 v232, 0x3f803f80
  v_mov_b32 v233, 0x3f803f80
  v_mov_b32 v234, 0x3f803f80
  v_mov_b32 v235, 0x3f803f80
  s_add_u32 s52, s60, 128
  s_and_b32 s52, s52, 0x7ff
  s_mov_b32 s53, 32768
  s_add_u32 m0, s53, s62
  s_nop 0
  buffer_load_dwordx4 v236, s[8:11], s52 offen lds
  buffer_load_dwordx4 v237, s[8:11], s52 offen offset:1024 lds
  s_cmp_eq_u32 s45, 0
  s_cbranch_scc1 L_touch_0
  s_cmp_eq_u32 s45, 1
  s_cbranch_scc1 L_touch_1
  s_cmp_eq_u32 s45, 2
  s_cbranch_scc1 L_touch_4
  s_branch L_touch_5
L_tret_A0:
  s_waitcnt vmcnt(5)
  s_barrier
  ds_read_b128 v[200:203], v240 offset:0
  ds_read_b128 v[204:207], v240 offset:2048
  ds_read_b128 v[208:211], v240 offset:4096
  ds_read_b128 v[212:215], v240 offset:6144
  ds_read_b64_tr_b16 v[144:145], v242 offset:0
  ds_read_b64_tr_b16 v[146:147], v242 offset:1536
  ds_read_b64_tr_b16 v[148:149], v243 offset:0
  ds_read_b64_tr_b16 v[150:151], v243 offset:1536
  ds_read_b64_tr_b16 v[152:153], v242 offset:64
  ds_read_b64_tr_b16 v[154:155], v242 offset:1600
  ds_read_b64_tr_b16 v[156:157], v243 offset:64
  ds_read_b64_tr_b16 v[158:159], v243 offset:1600
  ds_read_b64_tr_b16 v[160:161], v242 offset:128
  ds_read_b64_tr_b16 v[162:163], v242 offset:1664
  ds_read_b64_tr_b16 v[164:165], v243 offset:128
  ds_read_b64_tr_b16 v[166:167], v243 offset:1664
  s_add_u32 s52, s60, 128
  s_and_b32 s52, s52, 0x7ff
  s_add_u32 s52, s52, 32768
  s_mov_b32 s53, 32768
  s_add_u32 m0, s53, s6
  s_nop 0
  buffer_load_dwordx4 v236, s[8:11], s52 offen lds
  buffer_load_dwordx4 v237, s[8:11], s52 offen offset:1024 lds
  s_and_b32 s52, s44, 1
  s_lshl_b32 s52, s52, 10
  s_lshl_b32 s53, s50, 11
  s_add_u32 s53, s53, s52
  s_add_u32 m0, s52, 155648
  v_lshlrev_b32 v1, 4, v0
  buffer_load_dwordx4 v1, s[24:27], s53 offen lds
  s_cmp_lg_u32 s44, 0
  s_cbranch_scc1 L_mi_1
  v_mov_b32 v2, 0
  s_lshl_b32 s52, s46, 2
  s_add_u32 s52, s52, s49
  s_lshl_b32 s52, s52, 8
  s_add_u32 s52, s52, 0x80000
  s_lshl_b32 s56, s48, 2
  s_add_u32 s52, s52, s56
  v_writelane_b32 v2, s52, 0
  s_lshl_b32 s52, s50, 8
  s_add_u32 s52, s52, 0x84000
  s_lshl_b32 s56, s46, 2
  s_add_u32 s52, s52, s56
  v_writelane_b32 v2, s52, 1
  s_lshl_b32 s52, s46, 8
  s_add_u32 s52, s52, 0x88000
  s_lshl_b32 s56, s50, 2
  s_add_u32 s52, s52, s56
  v_writelane_b32 v2, s52, 2
  s_lshl_b32 s52, s46, 3
  s_add_u32 s52, s52, s48
  s_lshl_b32 s52, s52, 8
  s_add_u32 s52, s52, 0x8c000
  s_lshl_b32 s56, s49, 2
  s_add_u32 s52, s52, s56
  v_writelane_b32 v2, s52, 3
  v_mov_b32 v3, 0
  s_mov_b64 exec, 15
  buffer_store_dword v3, v2, s[16:19], 0 offen sc1
  s_mov_b64 exec, -1
  v_lshlrev_b32 v2, 2, v0
  v_add_u32 v2, 161792, v2
  ds_write_b32 v2, v3
L_mi_1:
  s_add_u32 s60, s60, 256
  s_and_b32 s60, s60, 0x7ff
  s_mov_b32 s57, 65536
  s_mov_b32 s58, 0
  s_mov_b32 s59, 32768
  s_mov_b32 s96, 13312
  s_mov_b32 m0, s63
  s_mov_b64 exec, s[4:5]
  buffer_load_dwordx4 v238, s[12:15], s61 offen lds
  buffer_load_dwordx4 v239, s[12:15], s61 offen offset:768 lds
  s_mov_b64 exec, -1
  s_add_u32 s63, s63, 13312
  s_add_u32 s61, s61, 196608
  s_cmp_eq_u32 s61, 6291456
  s_cselect_b32 s61, 0, s61
  s_add_u32 m0, s57, s62
  s_nop 0
  buffer_load_dwordx4 v236, s[8:11], s60 offen lds
  buffer_load_dwordx4 v237, s[8:11], s60 offen offset:1024 lds
  s_mov_b32 m0, s63
  s_mov_b64 exec, s[4:5]
  buffer_load_dwordx4 v238, s[12:15], s61 offen lds
  buffer_load_dwordx4 v239, s[12:15], s61 offen offset:768 lds
  s_mov_b64 exec, -1
  s_add_u32 s63, s63, 13312
  s_add_u32 s61, s61, 196608
  s_cmp_eq_u32 s61, 6291456
  s_cselect_b32 s61, 0, s61
  s_sub_u32 s63, s63, 53248
  v_add_u32 v240, 32768, v240
  v_add_u32 v242, 13312, v242
  v_add_u32 v243, 13312, v243
  s_mov_b32 s97, 0
  s_lshl_b32 s52, s47, 1
  s_lshl_b32 s99, 3, s52
  s_or_b32 s98, s99, 0x1300
  s_waitcnt vmcnt(11) lgkmcnt(0)
  s_barrier
  v_mfma_f32_16x16x32_bf16 v[4:7], v[144:147], v[200:203], v[4:7]
  ds_read_b64_tr_b16 v[172:173], v242 offset:0
  v_mfma_f32_16x16x32_bf16 v[8:11], v[144:147], v[204:207], v[8:11]
  ds_read_b64_tr_b16 v[174:175], v242 offset:1536
L_loop_A:
  s_bitcmp1_b32 s98, s97
  s_cbranch_scc1 L_hk_A0
L_hkr_A0:
  v_mfma_f32_16x16x32_bf16 v[12:15], v[144:147], v[208:211], v[12:15]
  ds_read_b128 v[216:219], v241 offset:0
  s_add_u32 s51, s60, 32768
  s_add_u32 m0, s57, s6
  s_nop 0
  buffer_load_dwordx4 v236, s[8:11], s51 offen lds
  v_mfma_f32_16x16x32_bf16 v[16:19], v[144:147], v[212:215], v[16:19]
  ds_read_b128 v[220:223], v241 offset:2048
  v_mfma_f32_16x16x32_bf16 v[20:23], v[148:151], v[200:203], v[20:23]
  ds_read_b128 v[224:227], v241 offset:4096
  v_mfma_f32_16x16x32_bf16 v[24:27], v[148:151], v[204:207], v[24:27]
  ds_read_b128 v[228:231], v241 offset:6144
  v_mfma_f32_16x16x32_bf16 v[28:31], v[148:151], v[208:211], v[28:31]
  ds_read_b64_tr_b16 v[176:177], v243 offset:0
  buffer_load_dwordx4 v237, s[8:11], s51 offen offset:1024 lds
  v_mfma_f32_16x16x32_bf16 v[32:35], v[148:151], v[212:215], v[32:35]
  ds_read_b64_tr_b16 v[178:179], v243 offset:1536
  v_mfma_f32_16x16x32_bf16 v[36:39], v[152:155], v[200:203], v[36:39]
  ds_read_b64_tr_b16 v[180:181], v242 offset:64
  v_mfma_f32_16x16x32_bf16 v[40:43], v[152:155], v[204:207], v[40:43]
  ds_read_b64_tr_b16 v[182:183], v242 offset:1600
  v_mfma_f32_16x16x32_bf16 v[44:47], v[152:155], v[208:211], v[44:47]
  ds_read_b64_tr_b16 v[184:185], v243 offset:64
  s_mov_b32 m0, s63
  s_mov_b64 exec, s[4:5]
  buffer_load_dwordx4 v238, s[12:15], s61 offen lds
  buffer_load_dwordx4 v239, s[12:15], s61 offen offset:768 lds
  s_mov_b64 exec, -1
  v_mfma_f32_16x16x32_bf16 v[48:51], v[152:155], v[212:215], v[48:51]
  ds_read_b64_tr_b16 v[186:187], v243 offset:1600
  v_mfma_f32_16x16x32_bf16 v[52:55], v[156:159], v[200:203], v[52:55]
  ds_read_b64_tr_b16 v[188:189], v242 offset:128
  v_mfma_f32_16x16x32_bf16 v[56:59], v[156:159], v[204:207], v[56:59]
  ds_read_b64_tr_b16 v[190:191], v242 offset:1664
  v_mfma_f32_16x16x32_bf16 v[60:63], v[156:159], v[208:211], v[60:63]
  ds_read_b64_tr_b16 v[192:193], v243 offset:128
  s_add_u32 s61, s61, 196608
  s_cmp_eq_u32 s61, 6291456
  s_cselect_b32 s61, 0, s61
  s_add_u32 s63, s63, 13312
  v_mfma_f32_16x16x32_bf16 v[64:67], v[156:159], v[212:215], v[64:67]
  ds_read_b64_tr_b16 v[194:195], v243 offset:1664
  v_mfma_f32_16x16x32_bf16 v[68:71], v[160:163], v[200:203], v[68:71]
  v_mfma_f32_16x16x32_bf16 v[72:75], v[160:163], v[204:207], v[72:75]
  s_sub_u32 s52, s59, s58
  v_add_u32 v241, s52, v241
  v_mfma_f32_16x16x32_bf16 v[76:79], v[160:163], v[208:211], v[76:79]
  v_mfma_f32_16x16x32_bf16 v[80:83], v[160:163], v[212:215], v[80:83]
  v_add_u32 v242, s96, v242
  v_add_u32 v243, s96, v243
  v_mfma_f32_16x16x32_bf16 v[84:87], v[164:167], v[200:203], v[84:87]
  v_mfma_f32_16x16x32_bf16 v[88:91], v[164:167], v[204:207], v[88:91]
  v_mfma_f32_16x16x32_bf16 v[92:95], v[164:167], v[208:211], v[92:95]
  v_mfma_f32_16x16x32_bf16 v[96:99], v[164:167], v[212:215], v[96:99]
  s_waitcnt vmcnt(8) lgkmcnt(0)
  s_barrier
  v_mfma_f32_16x16x32_bf16 v[4:7], v[172:175], v[216:219], v[4:7]
  ds_read_b64_tr_b16 v[144:145], v242 offset:0
  v_mfma_f32_16x16x32_bf16 v[8:11], v[172:175], v[220:223], v[8:11]
  ds_read_b64_tr_b16 v[146:147], v242 offset:1536
  s_bitcmp1_b32 s99, s97
  s_cbranch_scc1 L_hk_A1
L_hkr_A1:
  v_mfma_f32_16x16x32_bf16 v[12:15], v[172:175], v[224:227], v[12:15]
  ds_read_b128 v[200:203], v240 offset:0
  s_add_u32 s60, s60, 128
  s_and_b32 s60, s60, 0x7ff
  s_add_u32 m0, s58, s62
  s_nop 0
  buffer_load_dwordx4 v236, s[8:11], s60 offen lds
  v_mfma_f32_16x16x32_bf16 v[16:19], v[172:175], v[228:231], v[16:19]
  ds_read_b128 v[204:207], v240 offset:2048
  v_mfma_f32_16x16x32_bf16 v[20:23], v[176:179], v[216:219], v[20:23]
  ds_read_b128 v[208:211], v240 offset:4096
  v_mfma_f32_16x16x32_bf16 v[24:27], v[176:179], v[220:223], v[24:27]
  ds_read_b128 v[212:215], v240 offset:6144
  v_mfma_f32_16x16x32_bf16 v[28:31], v[176:179], v[224:227], v[28:31]
  ds_read_b64_tr_b16 v[148:149], v243 offset:0
  buffer_load_dwordx4 v237, s[8:11], s60 offen offset:1024 lds
  v_mfma_f32_16x16x32_bf16 v[32:35], v[176:179], v[228:231], v[32:35]
  ds_read_b64_tr_b16 v[150:151], v243 offset:1536
  v_mfma_f32_16x16x32_bf16 v[36:39], v[180:183], v[216:219], v[36:39]
  ds_read_b64_tr_b16 v[152:153], v242 offset:64
  v_mfma_f32_16x16x32_bf16 v[40:43], v[180:183], v[220:223], v[40:43]
  ds_read_b64_tr_b16 v[154:155], v242 offset:1600
  v_mfma_f32_16x16x32_bf16 v[44:47], v[180:183], v[224:227], v[44:47]
  ds_read_b64_tr_b16 v[156:157], v243 offset:64
  s_mov_b32 m0, s63
  s_mov_b64 exec, s[4:5]
  buffer_load_dwordx4 v238, s[12:15], s61 offen lds
  buffer_load_dwordx4 v239, s[12:15], s61 offen offset:768 lds
  s_mov_b64 exec, -1
  v_mfma_f32_16x16x32_bf16 v[48:51], v[180:183], v[228:231], v[48:51]
  ds_read_b64_tr_b16 v[158:159], v243 offset:1600
  v_mfma_f32_16x16x32_bf16 v[52:55], v[184:187], v[216:219], v[52:55]
  ds_read_b64_tr_b16 v[160:161], v242 offset:128
  v_mfma_f32_16x16x32_bf16 v[56:59], v[184:187], v[220:223], v[56:59]
  ds_read_b64_tr_b16 v[162:163], v242 offset:1664
  v_mfma_f32_16x16x32_bf16 v[60:63], v[184:187], v[224:227], v[60:63]
  ds_read_b64_tr_b16 v[164:165], v243 offset:128
  s_add_u32 s61, s61, 196608
  s_cmp_eq_u32 s61, 6291456
  s_cselect_b32 s61, 0, s61
  s_add_u32 s63, s63, s96
  v_mfma_f32_16x16x32_bf16 v[64:67], v[184:187], v[228:231], v[64:67]
  ds_read_b64_tr_b16 v[166:167], v243 offset:1664
  v_mfma_f32_16x16x32_bf16 v[68:71], v[188:191], v[216:219], v[68:71]
  v_mfma_f32_16x16x32_bf16 v[72:75], v[188:191], v[220:223], v[72:75]
  s_sub_u32 s52, s57, s59
  v_add_u32 v240, s52, v240
  v_mfma_f32_16x16x32_bf16 v[76:79], v[188:191], v[224:227], v[76:79]
  v_mfma_f32_16x16x32_bf16 v[80:83], v[188:191], v[228:231], v[80:83]
  v_add_u32 v242, 0x3400, v242
  v_add_u32 v243, 0x3400, v243
  v_mfma_f32_16x16x32_bf16 v[84:87], v[192:195], v[216:219], v[84:87]
  s_mov_b32 s53, s57
  s_mov_b32 s57, s58
  s_mov_b32 s58, s59
  s_mov_b32 s59, s53
  s_xor_b32 s96, s96, 0xffff5000
  s_add_u32 s97, s97, 1
  v_mfma_f32_16x16x32_bf16 v[88:91], v[192:195], v[220:223], v[88:91]
  v_mfma_f32_16x16x32_bf16 v[92:95], v[192:195], v[224:227], v[92:95]
  v_mfma_f32_16x16x32_bf16 v[96:99], v[192:195], v[228:231], v[96:99]
  s_waitcnt vmcnt(8) lgkmcnt(0)
  s_barrier
  v_mfma_f32_16x16x32_bf16 v[4:7], v[144:147], v[200:203], v[4:7]
  ds_read_b64_tr_b16 v[172:173], v242 offset:0
  v_mfma_f32_16x16x32_bf16 v[8:11], v[144:147], v[204:207], v[8:11]
  ds_read_b64_tr_b16 v[174:175], v242 offset:1536
  s_cmp_lg_u32 s97, 13
  s_cbranch_scc1 L_loop_A
  s_branch L_tail_A
L_hk_A1:
  v_mfma_f32_16x16x32_bf16 v[116:119], v[172:175], v[232:235], v[116:119]
  v_mfma_f32_16x16x32_bf16 v[120:123], v[176:179], v[232:235], v[120:123]
  v_mfma_f32_16x16x32_bf16 v[124:127], v[180:183], v[232:235], v[124:127]
  v_mfma_f32_16x16x32_bf16 v[128:131], v[184:187], v[232:235], v[128:131]
  v_mfma_f32_16x16x32_bf16 v[132:135], v[188:191], v[232:235], v[132:135]
  v_mfma_f32_16x16x32_bf16 v[136:139], v[192:195], v[232:235], v[136:139]
  s_branch L_hkr_A1
L_hk_A0:
  s_bitcmp1_b32 s99, s97
  s_cbranch_scc0 L_hk_A_ncs
  v_mfma_f32_16x16x32_bf16 v[116:119], v[144:147], v[232:235], v[116:119]
  v_mfma_f32_16x16x32_bf16 v[120:123], v[148:151], v[232:235], v[120:123]
  v_mfma_f32_16x16x32_bf16 v[124:127], v[152:155], v[232:235], v[124:127]
  v_mfma_f32_16x16x32_bf16 v[128:131], v[156:159], v[232:235], v[128:131]
  v_mfma_f32_16x16x32_bf16 v[132:135], v[160:163], v[232:235], v[132:135]
  v_mfma_f32_16x16x32_bf16 v[136:139], v[164:167], v[232:235], v[136:139]
  s_branch L_hkr_A0
L_hk_A_ncs:
  s_cmp_eq_u32 s97, 9
  s_cbranch_scc1 L_hk_A_9
  s_cmp_eq_u32 s97, 12
  s_cbranch_scc1 L_hk_A_12
  s_cmp_lg_u32 s45, 0
  s_cbranch_scc1 L_hkr_A0
  s_lshl_b32 s51, s50, 3
  s_add_u32 s51, s51, s46
  s_lshl_b32 s51, s51, 10
  s_add_u32 s51, s51, 0x10000
  v_lshrrev_b32 v1, 4, v0
  v_lshlrev_b32 v1, 4, v1
  v_and_b32 v2, 15, v0
  v_lshl_add_u32 v1, v2, 6, v1
  s_mov_b32 exec_lo, 0x20002
  s_mov_b32 exec_hi, 0x20002
  v_mov_b64 v[116:117], v[120:121]
  v_mov_b64 v[118:119], v[122:123]
  s_mov_b32 exec_lo, 0x40004
  s_mov_b32 exec_hi, 0x40004
  v_mov_b64 v[116:117], v[124:125]
  v_mov_b64 v[118:119], v[126:127]
  s_mov_b32 exec_lo, 0x80008
  s_mov_b32 exec_hi, 0x80008
  v_mov_b64 v[116:117], v[128:129]
  v_mov_b64 v[118:119], v[130:131]
  s_mov_b32 exec_lo, 0x100010
  s_mov_b32 exec_hi, 0x100010
  v_mov_b64 v[116:117], v[132:133]
  v_mov_b64 v[118:119], v[134:135]
  s_mov_b32 exec_lo, 0x200020
  s_mov_b32 exec_hi, 0x200020
  v_mov_b64 v[116:117], v[136:137]
  v_mov_b64 v[118:119], v[138:139]
  s_mov_b32 exec_lo, 0x3f003f
  s_mov_b32 exec_hi, 0x3f003f
  buffer_store_dwordx4 v[116:119], v1, s[16:19], s51 offen sc1
  s_mov_b64 exec, -1
  s_branch L_hkr_A0
L_hk_A_9:
  s_cmp_lg_u32 s44, 0
  s_cbranch_scc1 L_hkr_A0
  s_and_b32 s51, s46, 1
  s_lshl_b32 s51, s51, 7
  s_lshr_b32 s52, s46, 1
  s_lshl_b32 s52, s52, 2
  s_add_u32 s51, s51, s52
  v_mov_b32 v1, 1
  v_mov_b32 v2, 0
  s_mov_b64 exec, 1
  buffer_atomic_add v1, v2, s[20:23], s51 offen sc1
  s_branch L_tover_0
L_touch_0:
  s_branch L_tret_A0
L_tover_0:
  s_mov_b64 exec, -1
  s_branch L_hkr_A0
L_hk_A_12:
  v_and_b32 v1, 1, v0
  v_lshlrev_b32 v1, 7, v1
  v_bfe_u32 v2, v0, 1, 2
  v_lshl_add_u32 v1, v2, 2, v1
  buffer_load_dword v254, v1, s[20:23], 0 offen sc1
  s_branch L_hkr_A0
L_exit0:
  s_endpgm
L_tail_A:
  v_mfma_f32_16x16x32_bf16 v[12:15], v[144:147], v[208:211], v[12:15]
  ds_read_b128 v[216:219], v241 offset:0
  s_add_u32 s51, s60, 32768
  s_add_u32 m0, s57, s6
  s_nop 0
  buffer_load_dwordx4 v236, s[8:11], s51 offen lds
  v_cmp_gt_u32 vcc, 32, v254
  v_mfma_f32_16x16x32_bf16 v[16:19], v[144:147], v[212:215], v[16:19]
  ds_read_b128 v[220:223], v241 offset:2048
  s_nop 0
  s_cmp_eq_u64 vcc, 0
  s_cbranch_scc0 L_spin_s1A
L_spinr_s1A:
  v_mfma_f32_16x16x32_bf16 v[20:23], v[148:151], v[200:203], v[20:23]
  ds_read_b128 v[224:227], v241 offset:4096
  v_and_b32 v1, 31, v0
  v_mfma_f32_16x16x32_bf16 v[24:27], v[148:151], v[204:207], v[24:27]
  ds_read_b128 v[228:231], v241 offset:6144
  v_mfma_f32_16x16x32_bf16 v[28:31], v[148:151], v[208:211], v[28:31]
  ds_read_b64_tr_b16 v[176:177], v243 offset:0
  buffer_load_dwordx4 v237, s[8:11], s51 offen offset:1024 lds
  v_lshlrev_b32 v1, 4, v1
  v_mfma_f32_16x16x32_bf16 v[32:35], v[148:151], v[212:215], v[32:35]
  ds_read_b64_tr_b16 v[178:179], v243 offset:1536
  v_lshrrev_b32 v2, 5, v0
  v_mfma_f32_16x16x32_bf16 v[36:39], v[152:155], v[200:203], v[36:39]
  ds_read_b64_tr_b16 v[180:181], v242 offset:64
  v_mfma_f32_16x16x32_bf16 v[40:43], v[152:155], v[204:207], v[40:43]
  ds_read_b64_tr_b16 v[182:183], v242 offset:1600
  v_lshl_add_u32 v1, v2, 10, v1
  v_mfma_f32_16x16x32_bf16 v[44:47], v[152:155], v[208:211], v[44:47]
  ds_read_b64_tr_b16 v[184:185], v243 offset:64
  s_mov_b32 m0, s63
  s_mov_b64 exec, s[4:5]
  buffer_load_dwordx4 v238, s[12:15], s61 offen lds
  buffer_load_dwordx4 v239, s[12:15], s61 offen offset:768 lds
  s_mov_b64 exec, -1
  s_lshl_b32 s54, s50, 13
  s_add_u32 s54, s54, 0x10000
  v_mfma_f32_16x16x32_bf16 v[48:51], v[152:155], v[212:215], v[48:51]
  ds_read_b64_tr_b16 v[186:187], v243 offset:1600
  v_mfma_f32_16x16x32_bf16 v[52:55], v[156:159], v[200:203], v[52:55]
  ds_read_b64_tr_b16 v[188:189], v242 offset:128
  buffer_load_dwordx4 v[116:119], v1, s[16:19], s54 offen offset:0 sc1
  v_mfma_f32_16x16x32_bf16 v[56:59], v[156:159], v[204:207], v[56:59]
  ds_read_b64_tr_b16 v[190:191], v242 offset:1664
  v_mfma_f32_16x16x32_bf16 v[60:63], v[156:159], v[208:211], v[60:63]
  ds_read_b64_tr_b16 v[192:193], v243 offset:128
  s_add_u32 s61, s61, 196608
  s_cmp_eq_u32 s61, 6291456
  s_cselect_b32 s61, 0, s61
  s_add_u32 s63, s63, 13312
  buffer_load_dwordx4 v[120:123], v1, s[16:19], s54 offen offset:2048 sc1
  s_add_u32 s54, s54, 4096
  v_mfma_f32_16x16x32_bf16 v[64:67], v[156:159], v[212:215], v[64:67]
  ds_read_b64_tr_b16 v[194:195], v243 offset:1664
  v_mfma_f32_16x16x32_bf16 v[68:71], v[160:163], v[200:203], v[68:71]
  v_mfma_f32_16x16x32_bf16 v[72:75], v[160:163], v[204:207], v[72:75]
  s_sub_u32 s52, s59, s58
  v_add_u32 v241, s52, v241
  buffer_load_dwordx4 v[124:127], v1, s[16:19], s54 offen offset:0 sc1
  v_mfma_f32_16x16x32_bf16 v[76:79], v[160:163], v[208:211], v[76:79]
  v_mfma_f32_16x16x32_bf16 v[80:83], v[160:163], v[212:215], v[80:83]
  v_add_u32 v242, s96, v242
  v_add_u32 v243, s96, v243
  buffer_load_dwordx4 v[128:131], v1, s[16:19], s54 offen offset:2048 sc1
  v_mfma_f32_16x16x32_bf16 v[84:87], v[164:167], v[200:203], v[84:87]
  v_mfma_f32_16x16x32_bf16 v[88:91], v[164:167], v[204:207], v[88:91]
  v_mfma_f32_16x16x32_bf16 v[92:95], v[164:167], v[208:211], v[92:95]
  v_mfma_f32_16x16x32_bf16 v[96:99], v[164:167], v[212:215], v[96:99]
  s_waitcnt vmcnt(12) lgkmcnt(0)
  s_barrier
  v_mfma_f32_16x16x32_bf16 v[4:7], v[172:175], v[216:219], v[4:7]
  ds_read_b64_tr_b16 v[144:145], v242 offset:0
  v_mfma_f32_16x16x32_bf16 v[8:11], v[172:175], v[220:223], v[8:11]
  ds_read_b64_tr_b16 v[146:147], v242 offset:1536
  v_mfma_f32_16x16x32_bf16 v[12:15], v[172:175], v[224:227], v[12:15]
  ds_read_b128 v[200:203], v240 offset:0
  s_lshl_b32 s51, s46, 8
  s_lshl_b32 s52, s45, 6
  s_add_u32 s51, s51, s52
  s_lshl_b32 s51, s51, 3
  v_mfma_f32_16x16x32_bf16 v[16:19], v[172:175], v[228:231], v[16:19]
  ds_read_b128 v[204:207], v240 offset:2048
  v_lshlrev_b32 v1, 3, v0
  v_mfma_f32_16x16x32_bf16 v[20:23], v[176:179], v[216:219], v[20:23]
  ds_read_b128 v[208:211], v240 offset:4096
  v_mfma_f32_16x16x32_bf16 v[24:27], v[176:179], v[220:223], v[24:27]
  ds_read_b128 v[212:215], v240 offset:6144
  buffer_load_dwordx2 v[244:245], v1, s[16:19], s51 offen offset:0 sc1
  v_mfma_f32_16x16x32_bf16 v[28:31], v[176:179], v[224:227], v[28:31]
  ds_read_b64_tr_b16 v[148:149], v243 offset:0
  v_mfma_f32_16x16x32_bf16 v[32:35], v[176:179], v[228:231], v[32:35]
  ds_read_b64_tr_b16 v[150:151], v243 offset:1536
  v_mfma_f32_16x16x32_bf16 v[36:39], v[180:183], v[216:219], v[36:39]
  ds_read_b64_tr_b16 v[152:153], v242 offset:64
  v_mfma_f32_16x16x32_bf16 v[40:43], v[180:183], v[220:223], v[40:43]
  ds_read_b64_tr_b16 v[154:155], v242 offset:1600
  v_mfma_f32_16x16x32_bf16 v[44:47], v[180:183], v[224:227], v[44:47]
  ds_read_b64_tr_b16 v[156:157], v243 offset:64
  s_mov_b32 m0, s63
  s_mov_b64 exec, s[4:5]
  buffer_load_dwordx4 v238, s[12:15], s61 offen lds
  buffer_load_dwordx4 v239, s[12:15], s61 offen offset:768 lds
  s_mov_b64 exec, -1
  v_mfma_f32_16x16x32_bf16 v[48:51], v[180:183], v[228:231], v[48:51]
  ds_read_b64_tr_b16 v[158:159], v243 offset:1600
  v_mfma_f32_16x16x32_bf16 v[52:55], v[184:187], v[216:219], v[52:55]
  ds_read_b64_tr_b16 v[160:161], v242 offset:128
  v_mfma_f32_16x16x32_bf16 v[56:59], v[184:187], v[220:223], v[56:59]
  ds_read_b64_tr_b16 v[162:163], v242 offset:1664
  v_mfma_f32_16x16x32_bf16 v[60:63], v[184:187], v[224:227], v[60:63]
  ds_read_b64_tr_b16 v[164:165], v243 offset:128
  v_mfma_f32_16x16x32_bf16 v[64:67], v[184:187], v[228:231], v[64:67]
  ds_read_b64_tr_b16 v[166:167], v243 offset:1664
  v_mfma_f32_16x16x32_bf16 v[68:71], v[188:191], v[216:219], v[68:71]
  v_mfma_f32_16x16x32_bf16 v[72:75], v[188:191], v[220:223], v[72:75]
  s_sub_u32 s52, s57, s59
  v_add_u32 v240, s52, v240
  v_mfma_f32_16x16x32_bf16 v[76:79], v[188:191], v[224:227], v[76:79]
  v_mfma_f32_16x16x32_bf16 v[80:83], v[188:191], v[228:231], v[80:83]
  v_add_u32 v242, 0x3400, v242
  v_add_u32 v243, 0x3400, v243
  v_mfma_f32_16x16x32_bf16 v[84:87], v[192:195], v[216:219], v[84:87]
  s_mov_b32 s53, s57
  s_mov_b32 s57, s58
  s_mov_b32 s58, s59
  s_mov_b32 s59, s53
  s_xor_b32 s96, s96, 0xffff5000
  v_mfma_f32_16x16x32_bf16 v[88:91], v[192:195], v[220:223], v[88:91]
  v_mfma_f32_16x16x32_bf16 v[92:95], v[192:195], v[224:227], v[92:95]
  v_mfma_f32_16x16x32_bf16 v[96:99], v[192:195], v[228:231], v[96:99]
  s_waitcnt vmcnt(11) lgkmcnt(0)
  s_barrier
  v_mfma_f32_16x16x32_bf16 v[4:7], v[144:147], v[200:203], v[4:7]
  ds_read_b64_tr_b16 v[172:173], v242 offset:0
  v_mfma_f32_16x16x32_bf16 v[8:11], v[144:147], v[204:207], v[8:11]
  ds_read_b64_tr_b16 v[174:175], v242 offset:1536
  s_lshr_b32 s54, s2, 2
  s_mul_i32 s54, s54, 28672
  s_mul_i32 s55, s49, 1835008
  s_add_u32 s54, s54, s55
  v_mfma_f32_16x16x32_bf16 v[12:15], v[144:147], v[208:211], v[12:15]
  ds_read_b128 v[216:219], v241 offset:0
  s_mul_i32 s55, s44, 3584
  s_add_u32 s54, s54, s55
  v_mfma_f32_16x16x32_bf16 v[16:19], v[144:147], v[212:215], v[16:19]
  ds_read_b128 v[220:223], v241 offset:2048
  v_mfma_f32_16x16x32_bf16 v[20:23], v[148:151], v[200:203], v[20:23]
  ds_read_b128 v[224:227], v241 offset:4096
  v_min_u32 v1, 27, v0
  v_mfma_f32_16x16x32_bf16 v[24:27], v[148:151], v[204:207], v[24:27]
  ds_read_b128 v[228:231], v241 offset:6144
  v_lshlrev_b32 v1, 7, v1
  v_mfma_f32_16x16x32_bf16 v[28:31], v[148:151], v[208:211], v[28:31]
  ds_read_b64_tr_b16 v[176:177], v243 offset:0
  v_mfma_f32_16x16x32_bf16 v[32:35], v[148:151], v[212:215], v[32:35]
  ds_read_b64_tr_b16 v[178:179], v243 offset:1536
  buffer_load_dword v255, v1, s[28:31], s54 offen
  v_mfma_f32_16x16x32_bf16 v[36:39], v[152:155], v[200:203], v[36:39]
  ds_read_b64_tr_b16 v[180:181], v242 offset:64
  v_mfma_f32_16x16x32_bf16 v[40:43], v[152:155], v[204:207], v[40:43]
  ds_read_b64_tr_b16 v[182:183], v242 offset:1600
  s_lshl_b32 s55, s2, 3
  s_add_u32 s55, s55, s44
  s_lshl_b32 s55, s55, 10
  v_mfma_f32_16x16x32_bf16 v[44:47], v[152:155], v[208:211], v[44:47]
  ds_read_b64_tr_b16 v[184:185], v243 offset:64
  v_min_u32 v2, 7, v0
  v_mfma_f32_16x16x32_bf16 v[48:51], v[152:155], v[212:215], v[48:51]
  ds_read_b64_tr_b16 v[186:187], v243 offset:1600
  v_mfma_f32_16x16x32_bf16 v[52:55], v[156:159], v[200:203], v[52:55]
  ds_read_b64_tr_b16 v[188:189], v242 offset:128
  v_lshlrev_b32 v2, 7, v2
  v_mfma_f32_16x16x32_bf16 v[56:59], v[156:159], v[204:207], v[56:59]
  ds_read_b64_tr_b16 v[190:191], v242 offset:1664
  buffer_load_dword v255, v2, s[32:35], s55 offen
  v_mfma_f32_16x16x32_bf16 v[60:63], v[156:159], v[208:211], v[60:63]
  ds_read_b64_tr_b16 v[192:193], v243 offset:128
  v_mfma_f32_16x16x32_bf16 v[64:67], v[156:159], v[212:215], v[64:67]
  ds_read_b64_tr_b16 v[194:195], v243 offset:1664
  s_lshl_b32 s54, s44, 8
  v_mfma_f32_16x16x32_bf16 v[68:71], v[160:163], v[200:203], v[68:71]
  v_mfma_f32_16x16x32_bf16 v[72:75], v[160:163], v[204:207], v[72:75]
  s_sub_u32 s52, s59, s58
  v_add_u32 v241, s52, v241
  v_min_u32 v1, 1, v0
  v_mfma_f32_16x16x32_bf16 v[76:79], v[160:163], v[208:211], v[76:79]
  v_lshlrev_b32 v1, 7, v1
  v_mfma_f32_16x16x32_bf16 v[80:83], v[160:163], v[212:215], v[80:83]
  v_add_u32 v242, s96, v242
  v_add_u32 v243, s96, v243
  v_mfma_f32_16x16x32_bf16 v[84:87], v[164:167], v[200:203], v[84:87]
  buffer_load_dword v255, v1, s[40:43], s54 offen
  v_mfma_f32_16x16x32_bf16 v[88:91], v[164:167], v[204:207], v[88:91]
  v_mfma_f32_16x16x32_bf16 v[92:95], v[164:167], v[208:211], v[92:95]
  v_mfma_f32_16x16x32_bf16 v[96:99], v[164:167], v[212:215], v[96:99]
  s_waitcnt vmcnt(6) lgkmcnt(0)
  s_barrier
  v_mfma_f32_16x16x32_bf16 v[4:7], v[172:175], v[216:219], v[4:7]
  ds_read_b64_tr_b16 v[144:145], v242 offset:0
  v_add_f32 v116, v116, v120
  v_add_f32 v117, v117, v121
  v_mfma_f32_16x16x32_bf16 v[8:11], v[172:175], v[220:223], v[8:11]
  ds_read_b64_tr_b16 v[146:147], v242 offset:1536
  v_add_f32 v118, v118, v122
  v_mfma_f32_16x16x32_bf16 v[12:15], v[172:175], v[224:227], v[12:15]
  ds_read_b128 v[200:203], v240 offset:0
  v_add_f32 v119, v119, v123
  v_mfma_f32_16x16x32_bf16 v[16:19], v[172:175], v[228:231], v[16:19]
  ds_read_b128 v[204:207], v240 offset:2048
  v_add_f32 v124, v124, v128
  v_mfma_f32_16x16x32_bf16 v[20:23], v[176:179], v[216:219], v[20:23]
  ds_read_b128 v[208:211], v240 offset:4096
  v_add_f32 v125, v125, v129
  v_mfma_f32_16x16x32_bf16 v[24:27], v[176:179], v[220:223], v[24:27]
  ds_read_b128 v[212:215], v240 offset:6144
  v_add_f32 v126, v126, v130
  v_mfma_f32_16x16x32_bf16 v[28:31], v[176:179], v[224:227], v[28:31]
  ds_read_b64_tr_b16 v[148:149], v243 offset:0
  v_add_f32 v127, v127, v131
  v_mfma_f32_16x16x32_bf16 v[32:35], v[176:179], v[228:231], v[32:35]
  ds_read_b64_tr_b16 v[150:151], v243 offset:1536
  v_add_f32 v116, v116, v124
  v_mfma_f32_16x16x32_bf16 v[36:39], v[180:183], v[216:219], v[36:39]
  ds_read_b64_tr_b16 v[152:153], v242 offset:64
  v_add_f32 v117, v117, v125
  v_mfma_f32_16x16x32_bf16 v[40:43], v[180:183], v[220:223], v[40:43]
  ds_read_b64_tr_b16 v[154:155], v242 offset:1600
  v_add_f32 v118, v118, v126
  v_mfma_f32_16x16x32_bf16 v[44:47], v[180:183], v[224:227], v[44:47]
  ds_read_b64_tr_b16 v[156:157], v243 offset:64
  v_add_f32 v119, v119, v127
  v_mfma_f32_16x16x32_bf16 v[48:51], v[180:183], v[228:231], v[48:51]
  ds_read_b64_tr_b16 v[158:159], v243 offset:1600
  v_mov_b64 v[120:121], v[116:117]
  v_mfma_f32_16x16x32_bf16 v[52:55], v[184:187], v[216:219], v[52:55]
  ds_read_b64_tr_b16 v[160:161], v242 offset:128
  v_mov_b64 v[122:123], v[118:119]
  v_and_b32 v1, 31, v0
  v_mfma_f32_16x16x32_bf16 v[56:59], v[184:187], v[220:223], v[56:59]
  ds_read_b64_tr_b16 v[162:163], v242 offset:1664
  v_lshlrev_b32 v1, 4, v1
  v_mfma_f32_16x16x32_bf16 v[60:63], v[184:187], v[224:227], v[60:63]
  ds_read_b64_tr_b16 v[164:165], v243 offset:128
  v_add_u32 v1, 157696, v1
  v_mfma_f32_16x16x32_bf16 v[64:67], v[184:187], v[228:231], v[64:67]
  ds_read_b64_tr_b16 v[166:167], v243 offset:1664
  v_permlane32_swap_b32 v116, v120
  v_mfma_f32_16x16x32_bf16 v[68:71], v[188:191], v[216:219], v[68:71]
  v_permlane32_swap_b32 v117, v121
  v_mfma_f32_16x16x32_bf16 v[72:75], v[188:191], v[220:223], v[72:75]
  v_permlane32_swap_b32 v118, v122
  v_mfma_f32_16x16x32_bf16 v[76:79], v[188:191], v[224:227], v[76:79]
  v_permlane32_swap_b32 v119, v123
  v_mfma_f32_16x16x32_bf16 v[80:83], v[188:191], v[228:231], v[80:83]
  v_add_u32 v242, 0x3400, v242
  v_add_u32 v243, 0x3400, v243
  v_add_f32 v116, v116, v120
  v_mfma_f32_16x16x32_bf16 v[84:87], v[192:195], v[216:219], v[84:87]
  v_add_f32 v117, v117, v121
  v_mfma_f32_16x16x32_bf16 v[88:91], v[192:195], v[220:223], v[88:91]
  v_add_f32 v118, v118, v122
  v_mfma_f32_16x16x32_bf16 v[92:95], v[192:195], v[224:227], v[92:95]
  v_add_f32 v119, v119, v123
  v_mfma_f32_16x16x32_bf16 v[96:99], v[192:195], v[228:231], v[96:99]
  ds_write_b128 v1, v[116:119] offset:0
  s_waitcnt vmcnt(3) lgkmcnt(0)
  s_barrier
  v_mfma_f32_16x16x32_bf16 v[4:7], v[144:147], v[200:203], v[4:7]
  ds_read_b64_tr_b16 v[172:173], v242 offset:0
  v_mfma_f32_16x16x32_bf16 v[8:11], v[144:147], v[204:207], v[8:11]
  ds_read_b64_tr_b16 v[174:175], v242 offset:1536
  v_mfma_f32_16x16x32_bf16 v[12:15], v[144:147], v[208:211], v[12:15]
  ds_read_b128 v[216:219], v241 offset:0
  v_mfma_f32_16x16x32_bf16 v[16:19], v[144:147], v[212:215], v[16:19]
  ds_read_b128 v[220:223], v241 offset:2048
  v_mfma_f32_16x16x32_bf16 v[20:23], v[148:151], v[200:203], v[20:23]
  ds_read_b128 v[224:227], v241 offset:4096
  v_mfma_f32_16x16x32_bf16 v[24:27], v[148:151], v[204:207], v[24:27]
  ds_read_b128 v[228:231], v241 offset:6144
  v_mfma_f32_16x16x32_bf16 v[28:31], v[148:151], v[208:211], v[28:31]
  ds_read_b64_tr_b16 v[176:177], v243 offset:0
  v_mfma_f32_16x16x32_bf16 v[32:35], v[148:151], v[212:215], v[32:35]
  ds_read_b64_tr_b16 v[178:179], v243 offset:1536
  v_mfma_f32_16x16x32_bf16 v[36:39], v[152:155], v[200:203], v[36:39]
  ds_read_b64_tr_b16 v[180:181], v242 offset:64
  v_mfma_f32_16x16x32_bf16 v[40:43], v[152:155], v[204:207], v[40:43]
  ds_read_b64_tr_b16 v[182:183], v242 offset:1600
  v_mfma_f32_16x16x32_bf16 v[44:47], v[152:155], v[208:211], v[44:47]
  ds_read_b64_tr_b16 v[184:185], v243 offset:64
  v_lshrrev_b32 v2, 4, v0
  v_mfma_f32_16x16x32_bf16 v[48:51], v[152:155], v[212:215], v[48:51]
  ds_read_b64_tr_b16 v[186:187], v243 offset:1600
  v_lshlrev_b32 v2, 4, v2
  v_mfma_f32_16x16x32_bf16 v[52:55], v[156:159], v[200:203], v[52:55]
  ds_read_b64_tr_b16 v[188:189], v242 offset:128
  v_add_u32 v2, 157696, v2
  v_mfma_f32_16x16x32_bf16 v[56:59], v[156:159], v[204:207], v[56:59]
  ds_read_b64_tr_b16 v[190:191], v242 offset:1664
  ds_read_b128 v[116:119], v2 offset:0
  v_mfma_f32_16x16x32_bf16 v[60:63], v[156:159], v[208:211], v[60:63]
  ds_read_b64_tr_b16 v[192:193], v243 offset:128
  ds_read_b128 v[120:123], v2 offset:64
  v_mfma_f32_16x16x32_bf16 v[64:67], v[156:159], v[212:215], v[64:67]
  ds_read_b64_tr_b16 v[194:195], v243 offset:1664
  ds_read_b128 v[124:127], v2 offset:128
  v_mfma_f32_16x16x32_bf16 v[68:71], v[160:163], v[200:203], v[68:71]
  ds_read_b128 v[128:131], v2 offset:192
  v_mfma_f32_16x16x32_bf16 v[72:75], v[160:163], v[204:207], v[72:75]
  ds_read_b128 v[132:135], v2 offset:256
  v_mfma_f32_16x16x32_bf16 v[76:79], v[160:163], v[208:211], v[76:79]
  ds_read_b128 v[136:139], v2 offset:320
  v_mfma_f32_16x16x32_bf16 v[80:83], v[160:163], v[212:215], v[80:83]
  ds_read_b64_tr_b16 v[100:101], v141 offset:0
  v_mfma_f32_16x16x32_bf16 v[84:87], v[164:167], v[200:203], v[84:87]
  ds_read_b64_tr_b16 v[102:103], v141 offset:1024
  v_mfma_f32_16x16x32_bf16 v[88:91], v[164:167], v[204:207], v[88:91]
  ds_read_b64_tr_b16 v[104:105], v141 offset:32
  v_mfma_f32_16x16x32_bf16 v[92:95], v[164:167], v[208:211], v[92:95]
  ds_read_b64_tr_b16 v[106:107], v141 offset:1056
  v_mfma_f32_16x16x32_bf16 v[96:99], v[164:167], v[212:215], v[96:99]
  s_waitcnt vmcnt(5) lgkmcnt(0)
  v_mfma_f32_16x16x32_bf16 v[4:7], v[172:175], v[216:219], v[4:7]
  v_mov_b32 v1, v245
  v_mfma_f32_16x16x32_bf16 v[8:11], v[172:175], v[220:223], v[8:11]
  v_mov_b32 v246, v244
  v_mfma_f32_16x16x32_bf16 v[12:15], v[172:175], v[224:227], v[12:15]
  v_mfma_f32_16x16x32_bf16 v[16:19], v[172:175], v[228:231], v[16:19]
  v_permlane16_swap_b32 v244, v246
  v_mfma_f32_16x16x32_bf16 v[20:23], v[176:179], v[216:219], v[20:23]
  v_mfma_f32_16x16x32_bf16 v[24:27], v[176:179], v[220:223], v[24:27]
  v_mov_b32 v248, v244
  v_mfma_f32_16x16x32_bf16 v[28:31], v[176:179], v[224:227], v[28:31]
  v_mov_b32 v250, v246
  v_mfma_f32_16x16x32_bf16 v[32:35], v[176:179], v[228:231], v[32:35]
  v_mfma_f32_16x16x32_bf16 v[36:39], v[180:183], v[216:219], v[36:39]
  v_permlane32_swap_b32 v244, v248
  v_mfma_f32_16x16x32_bf16 v[40:43], v[180:183], v[220:223], v[40:43]
  v_mfma_f32_16x16x32_bf16 v[44:47], v[180:183], v[224:227], v[44:47]
  v_permlane32_swap_b32 v246, v250
  v_mfma_f32_16x16x32_bf16 v[48:51], v[180:183], v[228:231], v[48:51]
  v_mfma_f32_16x16x32_bf16 v[52:55], v[184:187], v[216:219], v[52:55]
  v_mov_b32 v245, v1
  v_mfma_f32_16x16x32_bf16 v[56:59], v[184:187], v[220:223], v[56:59]
  v_mov_b32 v247, v245
  v_mfma_f32_16x16x32_bf16 v[60:63], v[184:187], v[224:227], v[60:63]
  v_mfma_f32_16x16x32_bf16 v[64:67], v[184:187], v[228:231], v[64:67]
  v_permlane16_swap_b32 v245, v247
  v_mfma_f32_16x16x32_bf16 v[68:71], v[188:191], v[216:219], v[68:71]
  v_mfma_f32_16x16x32_bf16 v[72:75], v[188:191], v[220:223], v[72:75]
  v_mov_b32 v249, v245
  v_mfma_f32_16x16x32_bf16 v[76:79], v[188:191], v[224:227], v[76:79]
  v_mov_b32 v251, v247
  v_mfma_f32_16x16x32_bf16 v[80:83], v[188:191], v[228:231], v[80:83]
  v_mfma_f32_16x16x32_bf16 v[84:87], v[192:195], v[216:219], v[84:87]
  v_permlane32_swap_b32 v245, v249
  v_mfma_f32_16x16x32_bf16 v[88:91], v[192:195], v[220:223], v[88:91]
  v_mfma_f32_16x16x32_bf16 v[92:95], v[192:195], v[224:227], v[92:95]
  v_permlane32_swap_b32 v247, v251
  v_mfma_f32_16x16x32_bf16 v[96:99], v[192:195], v[228:231], v[96:99]
  s_waitcnt lgkmcnt(0)
  s_barrier
L_epi_A:
  s_setprio 1
  v_pk_fma_f32 v[36:37], v[124:125], v[244:245], v[36:37] op_sel:[0,0,0] op_sel_hi:[1,0,1] neg_lo:[0,1,0] neg_hi:[0,1,0]
  v_pk_fma_f32 v[38:39], v[126:127], v[244:245], v[38:39] op_sel:[0,0,0] op_sel_hi:[1,0,1] neg_lo:[0,1,0] neg_hi:[0,1,0]
  v_pk_fma_f32 v[52:53], v[128:129], v[244:245], v[52:53] op_sel:[0,0,0] op_sel_hi:[1,0,1] neg_lo:[0,1,0] neg_hi:[0,1,0]
  v_pk_fma_f32 v[54:55], v[130:131], v[244:245], v[54:55] op_sel:[0,0,0] op_sel_hi:[1,0,1] neg_lo:[0,1,0] neg_hi:[0,1,0]
  v_cvt_pk_bf16_f32 v144, v36, v37
  v_cvt_pk_bf16_f32 v145, v38, v39
  v_cvt_pk_bf16_f32 v146, v52, v53
  v_cvt_pk_bf16_f32 v147, v54, v55
  v_pk_fma_f32 v[40:41], v[124:125], v[246:247], v[40:41] op_sel:[0,0,0] op_sel_hi:[1,0,1] neg_lo:[0,1,0] neg_hi:[0,1,0]
  v_pk_fma_f32 v[42:43], v[126:127], v[246:247], v[42:43] op_sel:[0,0,0] op_sel_hi:[1,0,1] neg_lo:[0,1,0] neg_hi:[0,1,0]
  v_pk_fma_f32 v[56:57], v[128:129], v[246:247], v[56:57] op_sel:[0,0,0] op_sel_hi:[1,0,1] neg_lo:[0,1,0] neg_hi:[0,1,0]
  v_pk_fma_f32 v[58:59], v[130:131], v[246:247], v[58:59] op_sel:[0,0,0] op_sel_hi:[1,0,1] neg_lo:[0,1,0] neg_hi:[0,1,0]
  v_cvt_pk_bf16_f32 v148, v40, v41
  v_cvt_pk_bf16_f32 v149, v42, v43
  v_cvt_pk_bf16_f32 v150, v56, v57
  v_cvt_pk_bf16_f32 v151, v58, v59
  v_pk_fma_f32 v[44:45], v[124:125], v[248:249], v[44:45] op_sel:[0,0,0] op_sel_hi:[1,0,1] neg_lo:[0,1,0] neg_hi:[0,1,0]
  v_pk_fma_f32 v[46:47], v[126:127], v[248:249], v[46:47] op_sel:[0,0,0] op_sel_hi:[1,0,1] neg_lo:[0,1,0] neg_hi:[0,1,0]
  v_pk_fma_f32 v[60:61], v[128:129], v[248:249], v[60:61] op_sel:[0,0,0] op_sel_hi:[1,0,1] neg_lo:[0,1,0] neg_hi:[0,1,0]
  v_pk_fma_f32 v[62:63], v[130:131], v[248:249], v[62:63] op_sel:[0,0,0] op_sel_hi:[1,0,1] neg_lo:[0,1,0] neg_hi:[0,1,0]
  v_cvt_pk_bf16_f32 v152, v44, v45
  v_cvt_pk_bf16_f32 v153, v46, v47
  v_cvt_pk_bf16_f32 v154, v60, v61
  v_cvt_pk_bf16_f32 v155, v62, v63
  v_pk_fma_f32 v[48:49], v[124:125], v[250:251], v[48:49] op_sel:[0,0,0] op_sel_hi:[1,0,1] neg_lo:[0,1,0] neg_hi:[0,1,0]
  v_pk_fma_f32 v[50:51], v[126:127], v[250:251], v[50:51] op_sel:[0,0,0] op_sel_hi:[1,0,1] neg_lo:[0,1,0] neg_hi:[0,1,0]
  v_pk_fma_f32 v[64:65], v[128:129], v[250:251], v[64:65] op_sel:[0,0,0] op_sel_hi:[1,0,1] neg_lo:[0,1,0] neg_hi:[0,1,0]
  v_pk_fma_f32 v[66:67], v[130:131], v[250:251], v[66:67] op_sel:[0,0,0] op_sel_hi:[1,0,1] neg_lo:[0,1,0] neg_hi:[0,1,0]
  v_cvt_pk_bf16_f32 v156, v48, v49
  v_cvt_pk_bf16_f32 v157, v50, v51
  v_cvt_pk_bf16_f32 v158, v64, v65
  v_cvt_pk_bf16_f32 v159, v66, v67
  v_mfma_f32_16x16x32_bf16 v[180:183], v[100:103], v[144:147], 0
  v_mfma_f32_16x16x32_bf16 v[196:199], v[104:107], v[144:147], 0
  v_mfma_f32_16x16x32_bf16 v[184:187], v[100:103], v[148:151], 0
  v_mfma_f32_16x16x32_bf16 v[200:203], v[104:107], v[148:151], 0
  v_mfma_f32_16x16x32_bf16 v[188:191], v[100:103], v[152:155], 0
  v_mfma_f32_16x16x32_bf16 v[204:207], v[104:107], v[152:155], 0
  v_mfma_f32_16x16x32_bf16 v[192:195], v[100:103], v[156:159], 0
  v_mfma_f32_16x16x32_bf16 v[208:211], v[104:107], v[156:159], 0
  v_pk_fma_f32 v[4:5], v[116:117], v[244:245], v[4:5] op_sel:[0,0,0] op_sel_hi:[1,0,1] neg_lo:[0,1,0] neg_hi:[0,1,0]
  v_pk_fma_f32 v[6:7], v[118:119], v[244:245], v[6:7] op_sel:[0,0,0] op_sel_hi:[1,0,1] neg_lo:[0,1,0] neg_hi:[0,1,0]
  v_pk_fma_f32 v[20:21], v[120:121], v[244:245], v[20:21] op_sel:[0,0,0] op_sel_hi:[1,0,1] neg_lo:[0,1,0] neg_hi:[0,1,0]
  v_pk_fma_f32 v[22:23], v[122:123], v[244:245], v[22:23] op_sel:[0,0,0] op_sel_hi:[1,0,1] neg_lo:[0,1,0] neg_hi:[0,1,0]
  v_cvt_pk_bf16_f32 v160, v4, v5
  v_cvt_pk_bf16_f32 v161, v6, v7
  v_cvt_pk_bf16_f32 v162, v20, v21
  v_cvt_pk_bf16_f32 v163, v22, v23
  v_pk_fma_f32 v[8:9], v[116:117], v[246:247], v[8:9] op_sel:[0,0,0] op_sel_hi:[1,0,1] neg_lo:[0,1,0] neg_hi:[0,1,0]
  v_pk_fma_f32 v[10:11], v[118:119], v[246:247], v[10:11] op_sel:[0,0,0] op_sel_hi:[1,0,1] neg_lo:[0,1,0] neg_hi:[0,1,0]
  v_pk_fma_f32 v[24:25], v[120:121], v[246:247], v[24:25] op_sel:[0,0,0] op_sel_hi:[1,0,1] neg_lo:[0,1,0] neg_hi:[0,1,0]
  v_pk_fma_f32 v[26:27], v[122:123], v[246:247], v[26:27] op_sel:[0,0,0] op_sel_hi:[1,0,1] neg_lo:[0,1,0] neg_hi:[0,1,0]
  v_cvt_pk_bf16_f32 v164, v8, v9
  v_cvt_pk_bf16_f32 v165, v10, v11
  v_cvt_pk_bf16_f32 v166, v24, v25
  v_cvt_pk_bf16_f32 v167, v26, v27
  v_pk_fma_f32 v[12:13], v[116:117], v[248:249], v[12:13] op_sel:[0,0,0] op_sel_hi:[1,0,1] neg_lo:[0,1,0] neg_hi:[0,1,0]
  v_pk_fma_f32 v[14:15], v[118:119], v[248:249], v[14:15] op_sel:[0,0,0] op_sel_hi:[1,0,1] neg_lo:[0,1,0] neg_hi:[0,1,0]
  v_pk_fma_f32 v[28:29], v[120:121], v[248:249], v[28:29] op_sel:[0,0,0] op_sel_hi:[1,0,1] neg_lo:[0,1,0] neg_hi:[0,1,0]
  v_pk_fma_f32 v[30:31], v[122:123], v[248:249], v[30:31] op_sel:[0,0,0] op_sel_hi:[1,0,1] neg_lo:[0,1,0] neg_hi:[0,1,0]
  v_cvt_pk_bf16_f32 v168, v12, v13
  v_cvt_pk_bf16_f32 v169, v14, v15
  v_cvt_pk_bf16_f32 v170, v28, v29
  v_cvt_pk_bf16_f32 v171, v30, v31
  v_pk_fma_f32 v[16:17], v[116:117], v[250:251], v[16:17] op_sel:[0,0,0] op_sel_hi:[1,0,1] neg_lo:[0,1,0] neg_hi:[0,1,0]
  v_pk_fma_f32 v[18:19], v[118:119], v[250:251], v[18:19] op_sel:[0,0,0] op_sel_hi:[1,0,1] neg_lo:[0,1,0] neg_hi:[0,1,0]
  v_pk_fma_f32 v[32:33], v[120:121], v[250:251], v[32:33] op_sel:[0,0,0] op_sel_hi:[1,0,1] neg_lo:[0,1,0] neg_hi:[0,1,0]
  v_pk_fma_f32 v[34:35], v[122:123], v[250:251], v[34:35] op_sel:[0,0,0] op_sel_hi:[1,0,1] neg_lo:[0,1,0] neg_hi:[0,1,0]
  v_cvt_pk_bf16_f32 v172, v16, v17
  v_cvt_pk_bf16_f32 v173, v18, v19
  v_cvt_pk_bf16_f32 v174, v32, v33
  v_cvt_pk_bf16_f32 v175, v34, v35
  v_mfma_f32_16x16x32_bf16 v[4:7], v[100:103], v[160:163], 0
  v_mfma_f32_16x16x32_bf16 v[20:23], v[104:107], v[160:163], 0
  v_mfma_f32_16x16x32_bf16 v[8:11], v[100:103], v[164:167], 0
  v_mfma_f32_16x16x32_bf16 v[24:27], v[104:107], v[164:167], 0
  v_mfma_f32_16x16x32_bf16 v[12:15], v[100:103], v[168:171], 0
  v_mfma_f32_16x16x32_bf16 v[28:31], v[104:107], v[168:171], 0
  v_mfma_f32_16x16x32_bf16 v[16:19], v[100:103], v[172:175], 0
  v_mfma_f32_16x16x32_bf16 v[32:35], v[104:107], v[172:175], 0
  v_mov_b32 v212, v245
  v_mov_b32 v214, v247
  v_mov_b32 v216, v249
  v_mov_b32 v218, v251
  v_pk_fma_f32 v[68:69], v[132:133], v[244:245], v[68:69] op_sel:[0,0,0] op_sel_hi:[1,0,1] neg_lo:[0,1,0] neg_hi:[0,1,0]
  v_pk_fma_f32 v[70:71], v[134:135], v[244:245], v[70:71] op_sel:[0,0,0] op_sel_hi:[1,0,1] neg_lo:[0,1,0] neg_hi:[0,1,0]
  v_pk_fma_f32 v[84:85], v[136:137], v[244:245], v[84:85] op_sel:[0,0,0] op_sel_hi:[1,0,1] neg_lo:[0,1,0] neg_hi:[0,1,0]
  v_pk_fma_f32 v[86:87], v[138:139], v[244:245], v[86:87] op_sel:[0,0,0] op_sel_hi:[1,0,1] neg_lo:[0,1,0] neg_hi:[0,1,0]
  v_pk_mul_f32 v[68:69], v[68:69], v[212:213] op_sel:[0,0] op_sel_hi:[1,0]
  v_pk_mul_f32 v[70:71], v[70:71], v[212:213] op_sel:[0,0] op_sel_hi:[1,0]
  v_pk_mul_f32 v[84:85], v[84:85], v[212:213] op_sel:[0,0] op_sel_hi:[1,0]
  v_pk_mul_f32 v[86:87], v[86:87], v[212:213] op_sel:[0,0] op_sel_hi:[1,0]
  v_cvt_pk_bf16_f32 v176, v68, v69
  v_cvt_pk_bf16_f32 v177, v70, v71
  ds_write_b64 v108, v[176:177] offset:0
  v_cvt_pk_bf16_f32 v178, v84, v85
  v_cvt_pk_bf16_f32 v179, v86, v87
  ds_write_b64 v109, v[178:179] offset:0
  v_pk_fma_f32 v[72:73], v[132:133], v[246:247], v[72:73] op_sel:[0,0,0] op_sel_hi:[1,0,1] neg_lo:[0,1,0] neg_hi:[0,1,0]
  v_pk_fma_f32 v[74:75], v[134:135], v[246:247], v[74:75] op_sel:[0,0,0] op_sel_hi:[1,0,1] neg_lo:[0,1,0] neg_hi:[0,1,0]
  v_pk_fma_f32 v[88:89], v[136:137], v[246:247], v[88:89] op_sel:[0,0,0] op_sel_hi:[1,0,1] neg_lo:[0,1,0] neg_hi:[0,1,0]
  v_pk_fma_f32 v[90:91], v[138:139], v[246:247], v[90:91] op_sel:[0,0,0] op_sel_hi:[1,0,1] neg_lo:[0,1,0] neg_hi:[0,1,0]
  v_pk_mul_f32 v[72:73], v[72:73], v[214:215] op_sel:[0,0] op_sel_hi:[1,0]
  v_pk_mul_f32 v[74:75], v[74:75], v[214:215] op_sel:[0,0] op_sel_hi:[1,0]
  v_pk_mul_f32 v[88:89], v[88:89], v[214:215] op_sel:[0,0] op_sel_hi:[1,0]
  v_pk_mul_f32 v[90:91], v[90:91], v[214:215] op_sel:[0,0] op_sel_hi:[1,0]
  v_cvt_pk_bf16_f32 v176, v72, v73
  v_cvt_pk_bf16_f32 v177, v74, v75
  ds_write_b64 v108, v[176:177] offset:1024
  v_cvt_pk_bf16_f32 v178, v88, v89
  v_cvt_pk_bf16_f32 v179, v90, v91
  ds_write_b64 v109, v[178:179] offset:1024
  v_pk_fma_f32 v[76:77], v[132:133], v[248:249], v[76:77] op_sel:[0,0,0] op_sel_hi:[1,0,1] neg_lo:[0,1,0] neg_hi:[0,1,0]
  v_pk_fma_f32 v[78:79], v[134:135], v[248:249], v[78:79] op_sel:[0,0,0] op_sel_hi:[1,0,1] neg_lo:[0,1,0] neg_hi:[0,1,0]
  v_pk_fma_f32 v[92:93], v[136:137], v[248:249], v[92:93] op_sel:[0,0,0] op_sel_hi:[1,0,1] neg_lo:[0,1,0] neg_hi:[0,1,0]
  v_pk_fma_f32 v[94:95], v[138:139], v[248:249], v[94:95] op_sel:[0,0,0] op_sel_hi:[1,0,1] neg_lo:[0,1,0] neg_hi:[0,1,0]
  v_pk_mul_f32 v[76:77], v[76:77], v[216:217] op_sel:[0,0] op_sel_hi:[1,0]
  v_pk_mul_f32 v[78:79], v[78:79], v[216:217] op_sel:[0,0] op_sel_hi:[1,0]
  v_pk_mul_f32 v[92:93], v[92:93], v[216:217] op_sel:[0,0] op_sel_hi:[1,0]
  v_pk_mul_f32 v[94:95], v[94:95], v[216:217] op_sel:[0,0] op_sel_hi:[1,0]
  v_cvt_pk_bf16_f32 v176, v76, v77
  v_cvt_pk_bf16_f32 v177, v78, v79
  ds_write_b64 v108, v[176:177] offset:2048
  v_cvt_pk_bf16_f32 v178, v92, v93
  v_cvt_pk_bf16_f32 v179, v94, v95
  ds_write_b64 v109, v[178:179] offset:2048
  v_pk_fma_f32 v[80:81], v[132:133], v[250:251], v[80:81] op_sel:[0,0,0] op_sel_hi:[1,0,1] neg_lo:[0,1,0] neg_hi:[0,1,0]
  v_pk_fma_f32 v[82:83], v[134:135], v[250:251], v[82:83] op_sel:[0,0,0] op_sel_hi:[1,0,1] neg_lo:[0,1,0] neg_hi:[0,1,0]
  v_pk_fma_f32 v[96:97], v[136:137], v[250:251], v[96:97] op_sel:[0,0,0] op_sel_hi:[1,0,1] neg_lo:[0,1,0] neg_hi:[0,1,0]
  v_pk_fma_f32 v[98:99], v[138:139], v[250:251], v[98:99] op_sel:[0,0,0] op_sel_hi:[1,0,1] neg_lo:[0,1,0] neg_hi:[0,1,0]
  v_pk_mul_f32 v[80:81], v[80:81], v[218:219] op_sel:[0,0] op_sel_hi:[1,0]
  v_pk_mul_f32 v[82:83], v[82:83], v[218:219] op_sel:[0,0] op_sel_hi:[1,0]
  v_pk_mul_f32 v[96:97], v[96:97], v[218:219] op_sel:[0,0] op_sel_hi:[1,0]
  v_pk_mul_f32 v[98:99], v[98:99], v[218:219] op_sel:[0,0] op_sel_hi:[1,0]
  v_cvt_pk_bf16_f32 v176, v80, v81
  v_cvt_pk_bf16_f32 v177, v82, v83
  ds_write_b64 v108, v[176:177] offset:3072
  v_cvt_pk_bf16_f32 v178, v96, v97
  v_cvt_pk_bf16_f32 v179, v98, v99
  ds_write_b64 v109, v[178:179] offset:3072
  v_mul_f32 v220, 0x3fb8aa3b, v245
  v_mul_f32 v236, 0x3fb8aa3b, v247
  v_mul_f32 v222, 0x3fb8aa3b, v249
  v_mul_f32 v238, 0x3fb8aa3b, v251
  s_lshl_b32 s51, s45, 13
  v_lshlrev_b32 v3, 4, v0
  v_add_u32 v3, s51, v3
  v_add_u32 v3, 122880, v3
  ds_write_b128 v3, v[4:7] offset:0
  ds_write_b128 v3, v[8:11] offset:1024
  ds_write_b128 v3, v[12:15] offset:2048
  ds_write_b128 v3, v[16:19] offset:3072
  ds_write_b128 v3, v[20:23] offset:4096
  ds_write_b128 v3, v[24:27] offset:5120
  ds_write_b128 v3, v[28:31] offset:6144
  ds_write_b128 v3, v[32:35] offset:7168
  v_max3_f32 v212, v180, v181, v182
  v_min3_f32 v216, v180, v181, v182
  v_max3_f32 v213, v184, v185, v186
  v_min3_f32 v217, v184, v185, v186
  v_max3_f32 v214, v188, v189, v190
  v_min3_f32 v218, v188, v189, v190
  v_max3_f32 v215, v192, v193, v194
  v_min3_f32 v219, v192, v193, v194
  v_max3_f32 v212, v212, v183, v196
  v_min3_f32 v216, v216, v183, v196
  v_max3_f32 v213, v213, v187, v200
  v_min3_f32 v217, v217, v187, v200
  v_max3_f32 v214, v214, v191, v204
  v_min3_f32 v218, v218, v191, v204
  v_max3_f32 v215, v215, v195, v208
  v_min3_f32 v219, v219, v195, v208
  v_max3_f32 v212, v212, v197, v198
  v_min3_f32 v216, v216, v197, v198
  v_max3_f32 v213, v213, v201, v202
  v_min3_f32 v217, v217, v201, v202
  v_max3_f32 v214, v214, v205, v206
  v_min3_f32 v218, v218, v205, v206
  v_max3_f32 v215, v215, v209, v210
  v_min3_f32 v219, v219, v209, v210
  v_max_f32 v212, v212, v199
  v_min_f32 v216, v216, v199
  v_max_f32 v213, v213, v203
  v_min_f32 v217, v217, v203
  v_max_f32 v214, v214, v207
  v_min_f32 v218, v218, v207
  v_max_f32 v215, v215, v211
  v_min_f32 v219, v219, v211
  v_permlane32_swap_b32 v212, v213
  v_permlane32_swap_b32 v214, v215
  v_permlane32_swap_b32 v216, v217
  v_permlane32_swap_b32 v218, v219
  v_max_f32 v212, v212, v213
  v_max_f32 v214, v214, v215
  v_min_f32 v216, v216, v217
  v_min_f32 v218, v218, v219
  v_permlane16_swap_b32 v212, v214
  s_nop 0
  v_permlane16_swap_b32 v216, v218
  v_max_f32 v212, v212, v214
  v_min_f32 v216, v216, v218
  v_mov_b32 v214, v212
  v_mov_b32 v218, v216
  s_nop 0
  v_permlane16_swap_b32 v212, v214
  v_permlane16_swap_b32 v216, v218
  v_mov_b32 v213, v212
  v_mov_b32 v215, v214
  v_mov_b32 v217, v216
  v_mov_b32 v219, v218
  v_permlane32_swap_b32 v212, v213
  s_branch L_tover_1
L_touch_1:
  s_branch L_tret_A0
L_tover_1:
  v_permlane32_swap_b32 v214, v215
  v_permlane32_swap_b32 v216, v217
  v_permlane32_swap_b32 v218, v219
  v_mul_f32 v212, v212, v220
  v_mul_f32 v240, v213, v236
  v_mul_f32 v214, v214, v222
  v_mul_f32 v242, v215, v238
  v_mul_f32 v216, v216, v220
  v_mul_f32 v176, v217, v236
  v_mul_f32 v218, v218, v222
  v_mul_f32 v178, v219, v238
  s_waitcnt lgkmcnt(0)
  v_mov_b32 v1, 161984
  v_mov_b32 v2, 1
  s_mov_b64 exec, 1
  ds_add_u32 v1, v2
  s_mov_b64 exec, -1
  v_pk_fma_f32 v[36:37], v[180:181], v[220:221], v[212:213] op_sel:[0,0,0] op_sel_hi:[1,0,0] neg_lo:[0,0,1] neg_hi:[0,0,1]
  v_pk_fma_f32 v[180:181], v[180:181], v[220:221], v[216:217] op_sel:[0,0,0] op_sel_hi:[1,0,0] neg_lo:[0,1,0] neg_hi:[0,1,0]
  v_pk_fma_f32 v[38:39], v[182:183], v[220:221], v[212:213] op_sel:[0,0,0] op_sel_hi:[1,0,0] neg_lo:[0,0,1] neg_hi:[0,0,1]
  v_pk_fma_f32 v[182:183], v[182:183], v[220:221], v[216:217] op_sel:[0,0,0] op_sel_hi:[1,0,0] neg_lo:[0,1,0] neg_hi:[0,1,0]
  v_pk_fma_f32 v[52:53], v[196:197], v[220:221], v[212:213] op_sel:[0,0,0] op_sel_hi:[1,0,0] neg_lo:[0,0,1] neg_hi:[0,0,1]
  v_pk_fma_f32 v[196:197], v[196:197], v[220:221], v[216:217] op_sel:[0,0,0] op_sel_hi:[1,0,0] neg_lo:[0,1,0] neg_hi:[0,1,0]
  v_pk_fma_f32 v[54:55], v[198:199], v[220:221], v[212:213] op_sel:[0,0,0] op_sel_hi:[1,0,0] neg_lo:[0,0,1] neg_hi:[0,0,1]
  v_pk_fma_f32 v[198:199], v[198:199], v[220:221], v[216:217] op_sel:[0,0,0] op_sel_hi:[1,0,0] neg_lo:[0,1,0] neg_hi:[0,1,0]
  v_exp_f32 v36, v36
  v_exp_f32 v180, v180
  v_exp_f32 v37, v37
  v_exp_f32 v181, v181
  v_exp_f32 v38, v38
  v_exp_f32 v182, v182
  v_exp_f32 v39, v39
  v_exp_f32 v183, v183
  v_exp_f32 v52, v52
  v_exp_f32 v196, v196
  v_exp_f32 v53, v53
  v_exp_f32 v197, v197
  v_exp_f32 v54, v54
  v_exp_f32 v198, v198
  v_exp_f32 v55, v55
  v_exp_f32 v199, v199
  v_pk_fma_f32 v[40:41], v[184:185], v[236:237], v[240:241] op_sel:[0,0,0] op_sel_hi:[1,0,0] neg_lo:[0,0,1] neg_hi:[0,0,1]
  v_pk_fma_f32 v[184:185], v[184:185], v[236:237], v[176:177] op_sel:[0,0,0] op_sel_hi:[1,0,0] neg_lo:[0,1,0] neg_hi:[0,1,0]
  v_pk_fma_f32 v[42:43], v[186:187], v[236:237], v[240:241] op_sel:[0,0,0] op_sel_hi:[1,0,0] neg_lo:[0,0,1] neg_hi:[0,0,1]
  v_pk_fma_f32 v[186:187], v[186:187], v[236:237], v[176:177] op_sel:[0,0,0] op_sel_hi:[1,0,0] neg_lo:[0,1,0] neg_hi:[0,1,0]
  v_pk_fma_f32 v[56:57], v[200:201], v[236:237], v[240:241] op_sel:[0,0,0] op_sel_hi:[1,0,0] neg_lo:[0,0,1] neg_hi:[0,0,1]
  v_pk_fma_f32 v[200:201], v[200:201], v[236:237], v[176:177] op_sel:[0,0,0] op_sel_hi:[1,0,0] neg_lo:[0,1,0] neg_hi:[0,1,0]
  v_pk_fma_f32 v[58:59], v[202:203], v[236:237], v[240:241] op_sel:[0,0,0] op_sel_hi:[1,0,0] neg_lo:[0,0,1] neg_hi:[0,0,1]
  v_pk_fma_f32 v[202:203], v[202:203], v[236:237], v[176:177] op_sel:[0,0,0] op_sel_hi:[1,0,0] neg_lo:[0,1,0] neg_hi:[0,1,0]
  v_exp_f32 v40, v40
  v_exp_f32 v184, v184
  v_exp_f32 v41, v41
  v_exp_f32 v185, v185
  v_exp_f32 v42, v42
  v_exp_f32 v186, v186
  v_exp_f32 v43, v43
  v_exp_f32 v187, v187
  v_exp_f32 v56, v56
  v_exp_f32 v200, v200
  v_exp_f32 v57, v57
  v_exp_f32 v201, v201
  v_exp_f32 v58, v58
  v_exp_f32 v202, v202
  v_exp_f32 v59, v59
  v_exp_f32 v203, v203
  v_pk_fma_f32 v[44:45], v[188:189], v[222:223], v[214:215] op_sel:[0,0,0] op_sel_hi:[1,0,0] neg_lo:[0,0,1] neg_hi:[0,0,1]
  v_pk_fma_f32 v[188:189], v[188:189], v[222:223], v[218:219] op_sel:[0,0,0] op_sel_hi:[1,0,0] neg_lo:[0,1,0] neg_hi:[0,1,0]
  v_pk_fma_f32 v[46:47], v[190:191], v[222:223], v[214:215] op_sel:[0,0,0] op_sel_hi:[1,0,0] neg_lo:[0,0,1] neg_hi:[0,0,1]
  v_pk_fma_f32 v[190:191], v[190:191], v[222:223], v[218:219] op_sel:[0,0,0] op_sel_hi:[1,0,0] neg_lo:[0,1,0] neg_hi:[0,1,0]
  v_pk_fma_f32 v[60:61], v[204:205], v[222:223], v[214:215] op_sel:[0,0,0] op_sel_hi:[1,0,0] neg_lo:[0,0,1] neg_hi:[0,0,1]
  v_pk_fma_f32 v[204:205], v[204:205], v[222:223], v[218:219] op_sel:[0,0,0] op_sel_hi:[1,0,0] neg_lo:[0,1,0] neg_hi:[0,1,0]
  v_pk_fma_f32 v[62:63], v[206:207], v[222:223], v[214:215] op_sel:[0,0,0] op_sel_hi:[1,0,0] neg_lo:[0,0,1] neg_hi:[0,0,1]
  v_pk_fma_f32 v[206:207], v[206:207], v[222:223], v[218:219] op_sel:[0,0,0] op_sel_hi:[1,0,0] neg_lo:[0,1,0] neg_hi:[0,1,0]
  v_exp_f32 v44, v44
  v_exp_f32 v188, v188
  v_exp_f32 v45, v45
  v_exp_f32 v189, v189
  v_exp_f32 v46, v46
  v_exp_f32 v190, v190
  v_exp_f32 v47, v47
  v_exp_f32 v191, v191
  v_exp_f32 v60, v60
  v_exp_f32 v204, v204
  v_exp_f32 v61, v61
  v_exp_f32 v205, v205
  v_exp_f32 v62, v62
  v_exp_f32 v206, v206
  v_exp_f32 v63, v63
  v_exp_f32 v207, v207
  v_pk_fma_f32 v[48:49], v[192:193], v[238:239], v[242:243] op_sel:[0,0,0] op_sel_hi:[1,0,0] neg_lo:[0,0,1] neg_hi:[0,0,1]
  v_pk_fma_f32 v[192:193], v[192:193], v[238:239], v[178:179] op_sel:[0,0,0] op_sel_hi:[1,0,0] neg_lo:[0,1,0] neg_hi:[0,1,0]
  v_pk_fma_f32 v[50:51], v[194:195], v[238:239], v[242:243] op_sel:[0,0,0] op_sel_hi:[1,0,0] neg_lo:[0,0,1] neg_hi:[0,0,1]
  v_pk_fma_f32 v[194:195], v[194:195], v[238:239], v[178:179] op_sel:[0,0,0] op_sel_hi:[1,0,0] neg_lo:[0,1,0] neg_hi:[0,1,0]
  v_pk_fma_f32 v[64:65], v[208:209], v[238:239], v[242:243] op_sel:[0,0,0] op_sel_hi:[1,0,0] neg_lo:[0,0,1] neg_hi:[0,0,1]
  v_pk_fma_f32 v[208:209], v[208:209], v[238:239], v[178:179] op_sel:[0,0,0] op_sel_hi:[1,0,0] neg_lo:[0,1,0] neg_hi:[0,1,0]
  v_pk_fma_f32 v[66:67], v[210:211], v[238:239], v[242:243] op_sel:[0,0,0] op_sel_hi:[1,0,0] neg_lo:[0,0,1] neg_hi:[0,0,1]
  v_pk_fma_f32 v[210:211], v[210:211], v[238:239], v[178:179] op_sel:[0,0,0] op_sel_hi:[1,0,0] neg_lo:[0,1,0] neg_hi:[0,1,0]
  v_exp_f32 v48, v48
  v_exp_f32 v192, v192
  v_exp_f32 v49, v49
  v_exp_f32 v193, v193
  v_exp_f32 v50, v50
  v_exp_f32 v194, v194
  v_exp_f32 v51, v51
  v_exp_f32 v195, v195
  v_exp_f32 v64, v64
  v_exp_f32 v208, v208
  v_exp_f32 v65, v65
  v_exp_f32 v209, v209
  v_exp_f32 v66, v66
  v_exp_f32 v210, v210
  v_exp_f32 v67, v67
  v_exp_f32 v211, v211
  v_pk_add_f32 v[160:161], v[36:37], v[38:39]
  v_pk_add_f32 v[162:163], v[52:53], v[54:55]
  v_pk_add_f32 v[164:165], v[40:41], v[42:43]
  v_pk_add_f32 v[166:167], v[56:57], v[58:59]
  v_pk_add_f32 v[168:169], v[44:45], v[46:47]
  v_pk_add_f32 v[170:171], v[60:61], v[62:63]
  v_pk_add_f32 v[172:173], v[48:49], v[50:51]
  v_pk_add_f32 v[174:175], v[64:65], v[66:67]
  v_pk_add_f32 v[160:161], v[160:161], v[162:163]
  v_pk_add_f32 v[164:165], v[164:165], v[166:167]
  v_pk_add_f32 v[168:169], v[168:169], v[170:171]
  v_pk_add_f32 v[172:173], v[172:173], v[174:175]
  v_add_f32 v224, v160, v161
  v_add_f32 v225, v164, v165
  v_add_f32 v226, v168, v169
  v_add_f32 v227, v172, v173
  v_pk_add_f32 v[160:161], v[180:181], v[182:183]
  v_pk_add_f32 v[162:163], v[196:197], v[198:199]
  v_pk_add_f32 v[164:165], v[184:185], v[186:187]
  v_pk_add_f32 v[166:167], v[200:201], v[202:203]
  v_pk_add_f32 v[168:169], v[188:189], v[190:191]
  v_pk_add_f32 v[170:171], v[204:205], v[206:207]
  v_pk_add_f32 v[172:173], v[192:193], v[194:195]
  v_pk_add_f32 v[174:175], v[208:209], v[210:211]
  v_pk_add_f32 v[160:161], v[160:161], v[162:163]
  v_pk_add_f32 v[164:165], v[164:165], v[166:167]
  v_pk_add_f32 v[168:169], v[168:169], v[170:171]
  v_pk_add_f32 v[172:173], v[172:173], v[174:175]
  v_add_f32 v228, v160, v161
  v_add_f32 v229, v164, v165
  v_add_f32 v230, v168, v169
  v_add_f32 v231, v172, v173
  v_permlane32_swap_b32 v224, v225
  v_permlane32_swap_b32 v226, v227
  v_permlane32_swap_b32 v228, v229
  v_permlane32_swap_b32 v230, v231
  v_add_f32 v224, v224, v225
  v_add_f32 v226, v226, v227
  v_add_f32 v228, v228, v229
  v_add_f32 v230, v230, v231
  v_permlane16_swap_b32 v224, v226
  s_nop 0
  v_permlane16_swap_b32 v228, v230
  v_add_f32 v224, v224, v226
  v_add_f32 v228, v228, v230
  v_mov_b32 v226, v224
  v_mov_b32 v230, v228
  s_nop 0
  v_permlane16_swap_b32 v224, v226
  v_permlane16_swap_b32 v228, v230
  v_mov_b32 v225, v224
  v_mov_b32 v227, v226
  v_mov_b32 v229, v228
  v_mov_b32 v231, v230
  v_permlane32_swap_b32 v224, v225
  v_permlane32_swap_b32 v226, v227
  v_permlane32_swap_b32 v228, v229
  v_permlane32_swap_b32 v230, v231
  v_rcp_f32 v224, v224
  v_rcp_f32 v116, v225
  v_rcp_f32 v226, v226
  v_rcp_f32 v118, v227
  v_rcp_f32 v228, v228
  v_rcp_f32 v132, v229
  v_rcp_f32 v230, v230
  v_rcp_f32 v134, v231
  v_pk_mul_f32 v[36:37], v[36:37], v[224:225] op_sel:[0,0] op_sel_hi:[1,0]
  v_pk_mul_f32 v[38:39], v[38:39], v[224:225] op_sel:[0,0] op_sel_hi:[1,0]
  v_cvt_pk_bf16_f32 v144, v36, v37
  v_cvt_pk_bf16_f32 v145, v38, v39
  ds_write_b64 v110, v[144:145] offset:0
  v_pk_mul_f32 v[52:53], v[52:53], v[224:225] op_sel:[0,0] op_sel_hi:[1,0]
  v_pk_mul_f32 v[54:55], v[54:55], v[224:225] op_sel:[0,0] op_sel_hi:[1,0]
  v_cvt_pk_bf16_f32 v146, v52, v53
  v_cvt_pk_bf16_f32 v147, v54, v55
  ds_write_b64 v111, v[146:147] offset:0
  v_pk_mul_f32 v[180:181], v[180:181], v[228:229] op_sel:[0,0] op_sel_hi:[1,0]
  v_pk_mul_f32 v[182:183], v[182:183], v[228:229] op_sel:[0,0] op_sel_hi:[1,0]
  v_cvt_pk_bf16_f32 v148, v180, v181
  v_cvt_pk_bf16_f32 v149, v182, v183
  ds_write_b64 v112, v[148:149] offset:0
  v_pk_mul_f32 v[196:197], v[196:197], v[228:229] op_sel:[0,0] op_sel_hi:[1,0]
  v_pk_mul_f32 v[198:199], v[198:199], v[228:229] op_sel:[0,0] op_sel_hi:[1,0]
  v_cvt_pk_bf16_f32 v150, v196, v197
  v_cvt_pk_bf16_f32 v151, v198, v199
  ds_write_b64 v113, v[150:151] offset:0
  v_pk_mul_f32 v[40:41], v[40:41], v[116:117] op_sel:[0,0] op_sel_hi:[1,0]
  v_pk_mul_f32 v[42:43], v[42:43], v[116:117] op_sel:[0,0] op_sel_hi:[1,0]
  v_cvt_pk_bf16_f32 v152, v40, v41
  v_cvt_pk_bf16_f32 v153, v42, v43
  ds_write_b64 v110, v[152:153] offset:2048
  v_pk_mul_f32 v[56:57], v[56:57], v[116:117] op_sel:[0,0] op_sel_hi:[1,0]
  v_pk_mul_f32 v[58:59], v[58:59], v[116:117] op_sel:[0,0] op_sel_hi:[1,0]
  v_cvt_pk_bf16_f32 v154, v56, v57
  v_cvt_pk_bf16_f32 v155, v58, v59
  ds_write_b64 v111, v[154:155] offset:2048
  v_pk_mul_f32 v[184:185], v[184:185], v[132:133] op_sel:[0,0] op_sel_hi:[1,0]
  v_pk_mul_f32 v[186:187], v[186:187], v[132:133] op_sel:[0,0] op_sel_hi:[1,0]
  v_cvt_pk_bf16_f32 v156, v184, v185
  v_cvt_pk_bf16_f32 v157, v186, v187
  ds_write_b64 v112, v[156:157] offset:2048
  v_pk_mul_f32 v[200:201], v[200:201], v[132:133] op_sel:[0,0] op_sel_hi:[1,0]
  v_pk_mul_f32 v[202:203], v[202:203], v[132:133] op_sel:[0,0] op_sel_hi:[1,0]
  v_cvt_pk_bf16_f32 v158, v200, v201
  v_cvt_pk_bf16_f32 v159, v202, v203
  ds_write_b64 v113, v[158:159] offset:2048
  v_pk_mul_f32 v[44:45], v[44:45], v[226:227] op_sel:[0,0] op_sel_hi:[1,0]
  v_pk_mul_f32 v[46:47], v[46:47], v[226:227] op_sel:[0,0] op_sel_hi:[1,0]
  v_cvt_pk_bf16_f32 v144, v44, v45
  v_cvt_pk_bf16_f32 v145, v46, v47
  ds_write_b64 v110, v[144:145] offset:4096
  v_pk_mul_f32 v[60:61], v[60:61], v[226:227] op_sel:[0,0] op_sel_hi:[1,0]
  v_pk_mul_f32 v[62:63], v[62:63], v[226:227] op_sel:[0,0] op_sel_hi:[1,0]
  v_cvt_pk_bf16_f32 v146, v60, v61
  v_cvt_pk_bf16_f32 v147, v62, v63
  ds_write_b64 v111, v[146:147] offset:4096
  v_pk_mul_f32 v[188:189], v[188:189], v[230:231] op_sel:[0,0] op_sel_hi:[1,0]
  v_pk_mul_f32 v[190:191], v[190:191], v[230:231] op_sel:[0,0] op_sel_hi:[1,0]
  v_cvt_pk_bf16_f32 v148, v188, v189
  v_cvt_pk_bf16_f32 v149, v190, v191
  ds_write_b64 v112, v[148:149] offset:4096
  v_pk_mul_f32 v[204:205], v[204:205], v[230:231] op_sel:[0,0] op_sel_hi:[1,0]
  v_pk_mul_f32 v[206:207], v[206:207], v[230:231] op_sel:[0,0] op_sel_hi:[1,0]
  v_cvt_pk_bf16_f32 v150, v204, v205
  v_cvt_pk_bf16_f32 v151, v206, v207
  ds_write_b64 v113, v[150:151] offset:4096
  v_pk_mul_f32 v[48:49], v[48:49], v[118:119] op_sel:[0,0] op_sel_hi:[1,0]
  v_pk_mul_f32 v[50:51], v[50:51], v[118:119] op_sel:[0,0] op_sel_hi:[1,0]
  v_cvt_pk_bf16_f32 v152, v48, v49
  v_cvt_pk_bf16_f32 v153, v50, v51
  ds_write_b64 v110, v[152:153] offset:6144
  v_pk_mul_f32 v[64:65], v[64:65], v[118:119] op_sel:[0,0] op_sel_hi:[1,0]
  v_pk_mul_f32 v[66:67], v[66:67], v[118:119] op_sel:[0,0] op_sel_hi:[1,0]
  v_cvt_pk_bf16_f32 v154, v64, v65
  v_cvt_pk_bf16_f32 v155, v66, v67
  ds_write_b64 v111, v[154:155] offset:6144
  v_pk_mul_f32 v[192:193], v[192:193], v[134:135] op_sel:[0,0] op_sel_hi:[1,0]
  v_pk_mul_f32 v[194:195], v[194:195], v[134:135] op_sel:[0,0] op_sel_hi:[1,0]
  v_cvt_pk_bf16_f32 v156, v192, v193
  v_cvt_pk_bf16_f32 v157, v194, v195
  ds_write_b64 v112, v[156:157] offset:6144
  v_pk_mul_f32 v[208:209], v[208:209], v[134:135] op_sel:[0,0] op_sel_hi:[1,0]
  v_pk_mul_f32 v[210:211], v[210:211], v[134:135] op_sel:[0,0] op_sel_hi:[1,0]
  v_cvt_pk_bf16_f32 v158, v208, v209
  v_cvt_pk_bf16_f32 v159, v210, v211
  ds_write_b64 v113, v[158:159] offset:6144
  s_waitcnt lgkmcnt(0)
  v_mov_b32 v1, 161856
  v_mov_b32 v2, 1
  s_mov_b64 exec, 1
  ds_add_u32 v1, v2
  s_mov_b64 exec, -1
  v_lshlrev_b32 v144, 4, v0
  v_lshrrev_b32 v1, 4, v0
  v_and_b32 v2, 15, v0
  s_lshl_b32 s53, s48, 8
  s_and_b32 s51, s44, 1
  s_lshl_b32 s51, s51, 2
  v_add_u32 v3, s51, v1
  v_lshlrev_b32 v3, 1, v3
  v_xor_b32 v3, v3, v2
  s_lshl_b32 s52, s44, 2
  v_add_u32 v4, s52, v1
  v_lshlrev_b32 v4, 11, v4
  v_lshl_add_u32 v4, v3, 4, v4
  v_add_u32 v147, s53, v4
  s_lshl_b32 s52, s44, 3
  v_add_u32 v4, s52, v1
  v_lshlrev_b32 v4, 11, v4
  v_add_u32 v4, s53, v4
  v_lshlrev_b32 v3, 1, v1
  v_xor_b32 v3, v3, v2
  v_lshl_add_u32 v148, v3, 4, v4
  v_xor_b32 v149, 0x80, v148
  v_add_u32 v149, 7168, v149
  s_lshl_b32 s51, s45, 12
  v_add_u32 v150, s51, v144
  s_and_b32 s51, s44, 1
  s_lshl_b32 s51, s51, 11
  s_add_u32 s51, s51, 73728
  v_add_u32 v155, s51, v144
  v_lshrrev_b32 v3, 2, v2
  v_lshl_add_u32 v3, v1, 2, v3
  v_and_b32 v4, 7, v3
  v_lshlrev_b32 v3, 8, v3
  v_and_b32 v5, 3, v2
  v_lshl_add_u32 v3, v5, 3, v3
  s_lshr_b32 s51, s44, 2
  s_lshl_b32 s51, s51, 2
  v_xor_b32 v5, s51, v4
  v_lshl_add_u32 v5, v5, 5, v3
  v_add_u32 v151, 16384, v5
  v_xor_b32 v152, 32, v151
  v_xor_b32 v153, 64, v151
  v_xor_b32 v154, 96, v151
  v_add_u32 v161, 73728, v150
  v_add_u32 v162, 73728, v151
  v_add_u32 v163, 73728, v152
  v_add_u32 v164, 73728, v153
  v_add_u32 v165, 73728, v154
  s_lshr_b32 s51, s44, 1
  s_lshl_b32 s51, s51, 1
  v_xor_b32 v5, s51, v4
  v_lshl_add_u32 v5, v5, 5, v3
  v_add_u32 v156, 81920, v5
  v_xor_b32 v157, 32, v156
  s_mul_i32 s51, s46, 112
  s_mul_i32 s52, s49, 28
  s_add_u32 s51, s51, s52
  s_lshl_b32 s51, s51, 14
  s_lshl_b32 s61, s44, 11
  s_add_u32 s51, s51, s61
  s_add_u32 s59, s51, 0x400000
  s_mul_i32 s60, s49, 1835008
  s_lshr_b32 s51, s48, 1
  s_mul_i32 s51, s51, 7
  s_and_b32 s52, s48, 1
  s_lshl_b32 s52, s52, 2
  s_add_u32 s51, s51, s52
  s_lshl_b32 s52, s51, 14
  s_add_u32 s63, s59, s52
  s_add_u32 s58, s63, 49152
  s_lshl_b32 s52, s51, 16
  s_add_u32 s98, s60, s52
  s_add_u32 s96, s98, 196608
  s_cmp_eq_u32 s51, 0
  s_cselect_b32 s59, s58, s59
  s_cselect_b32 s60, s96, s60
  s_bfm_b32 s52, s51, 0
  s_and_b32 s53, s52, 0x1020408
  s_lshl_b32 s53, s53, 3
  s_andn2_b32 s97, 0x1020408, s52
  s_or_b32 s97, s97, s53
  s_lshr_b32 s52, s44, 1
  s_mov_b32 s47, 0
  s_cmp_eq_u32 s52, 1
  s_cselect_b32 s47, 16384, s47
  s_cmp_eq_u32 s52, 2
  s_cselect_b32 s47, 0xffffc000, s47
  s_lshl_b32 s62, s44, 10
  s_add_u32 s62, s62, 16384
  s_lshl_b32 s3, s46, 3
  s_add_u32 s3, s3, s48
  s_mov_b32 s12, s16
  s_mov_b32 s13, s17
  s_mov_b32 s14, 0
  s_mov_b32 s15, 0x20000
  v_mov_b32 v1, 161856
  s_mov_b32 s7, 0x100000
L_lw_2:
  ds_read_b32 v2, v1
  s_waitcnt lgkmcnt(0)
  v_readfirstlane_b32 s56, v2
  s_cmp_ge_u32 s56, 4
  s_cbranch_scc1 L_lw_2_done
  s_sub_u32 s7, s7, 1
  s_cmp_eq_u32 s7, 0
  s_cbranch_scc1 L_lw_2_done
  s_sleep 1
  s_branch L_lw_2
L_lw_2_done:
  ds_read_b64_tr_b16 v[36:37], v114 offset:0
  ds_read_b64_tr_b16 v[38:39], v114 offset:2048
  ds_read_b64_tr_b16 v[68:69], v115 offset:0
  ds_read_b64_tr_b16 v[70:71], v115 offset:1024
  ds_read_b64_tr_b16 v[72:73], v140 offset:0
  ds_read_b64_tr_b16 v[74:75], v140 offset:1024
  ds_read_b64_tr_b16 v[40:41], v114 offset:4096
  ds_read_b64_tr_b16 v[42:43], v114 offset:6144
  ds_read_b64_tr_b16 v[76:77], v115 offset:2048
  ds_read_b64_tr_b16 v[78:79], v115 offset:3072
  ds_read_b64_tr_b16 v[80:81], v140 offset:2048
  ds_read_b64_tr_b16 v[82:83], v140 offset:3072
  s_waitcnt lgkmcnt(6)
  v_mfma_f32_16x16x32_bf16 v[120:123], v[36:39], v[68:71], 0
  v_mfma_f32_16x16x32_bf16 v[124:127], v[36:39], v[72:75], 0
  v_mfma_f32_16x16x32_bf16 v[128:131], v[36:39], v[232:235], 0
  ds_read_b64_tr_b16 v[44:45], v114 offset:8192
  ds_read_b64_tr_b16 v[46:47], v114 offset:10240
  ds_read_b64_tr_b16 v[84:85], v115 offset:4096
  ds_read_b64_tr_b16 v[86:87], v115 offset:5120
  ds_read_b64_tr_b16 v[88:89], v140 offset:4096
  ds_read_b64_tr_b16 v[90:91], v140 offset:5120
  s_waitcnt lgkmcnt(6)
  v_mfma_f32_16x16x32_bf16 v[120:123], v[40:43], v[76:79], v[120:123]
  v_mfma_f32_16x16x32_bf16 v[124:127], v[40:43], v[80:83], v[124:127]
  v_mfma_f32_16x16x32_bf16 v[128:131], v[40:43], v[232:235], v[128:131]
  ds_read_b64_tr_b16 v[48:49], v114 offset:12288
  ds_read_b64_tr_b16 v[50:51], v114 offset:14336
  ds_read_b64_tr_b16 v[92:93], v115 offset:6144
  ds_read_b64_tr_b16 v[94:95], v115 offset:7168
  ds_read_b64_tr_b16 v[96:97], v140 offset:6144
  ds_read_b64_tr_b16 v[98:99], v140 offset:7168
  s_waitcnt lgkmcnt(6)
  v_mfma_f32_16x16x32_bf16 v[120:123], v[44:47], v[84:87], v[120:123]
  v_mfma_f32_16x16x32_bf16 v[124:127], v[44:47], v[88:91], v[124:127]
  v_mfma_f32_16x16x32_bf16 v[128:131], v[44:47], v[232:235], v[128:131]
  ds_read_b64_tr_b16 v[52:53], v114 offset:16384
  ds_read_b64_tr_b16 v[54:55], v114 offset:18432
  ds_read_b64_tr_b16 v[180:181], v115 offset:8192
  ds_read_b64_tr_b16 v[182:183], v115 offset:9216
  ds_read_b64_tr_b16 v[184:185], v140 offset:8192
  ds_read_b64_tr_b16 v[186:187], v140 offset:9216
  s_waitcnt lgkmcnt(6)
  v_mfma_f32_16x16x32_bf16 v[120:123], v[48:51], v[92:95], v[120:123]
  v_mfma_f32_16x16x32_bf16 v[124:127], v[48:51], v[96:99], v[124:127]
  v_mfma_f32_16x16x32_bf16 v[128:131], v[48:51], v[232:235], v[128:131]
  ds_read_b64_tr_b16 v[56:57], v114 offset:20480
  ds_read_b64_tr_b16 v[58:59], v114 offset:22528
  ds_read_b64_tr_b16 v[188:189], v115 offset:10240
  ds_read_b64_tr_b16 v[190:191], v115 offset:11264
  ds_read_b64_tr_b16 v[192:193], v140 offset:10240
  ds_read_b64_tr_b16 v[194:195], v140 offset:11264
  s_waitcnt lgkmcnt(6)
  v_mfma_f32_16x16x32_bf16 v[120:123], v[52:55], v[180:183], v[120:123]
  v_mfma_f32_16x16x32_bf16 v[124:127], v[52:55], v[184:187], v[124:127]
  v_mfma_f32_16x16x32_bf16 v[128:131], v[52:55], v[232:235], v[128:131]
  ds_read_b64_tr_b16 v[60:61], v114 offset:24576
  ds_read_b64_tr_b16 v[62:63], v114 offset:26624
  ds_read_b64_tr_b16 v[196:197], v115 offset:12288
  ds_read_b64_tr_b16 v[198:199], v115 offset:13312
  ds_read_b64_tr_b16 v[200:201], v140 offset:12288
  ds_read_b64_tr_b16 v[202:203], v140 offset:13312
  s_waitcnt lgkmcnt(6)
  v_mfma_f32_16x16x32_bf16 v[120:123], v[56:59], v[188:191], v[120:123]
  v_mfma_f32_16x16x32_bf16 v[124:127], v[56:59], v[192:195], v[124:127]
  v_mfma_f32_16x16x32_bf16 v[128:131], v[56:59], v[232:235], v[128:131]
  ds_read_b64_tr_b16 v[64:65], v114 offset:28672
  ds_read_b64_tr_b16 v[66:67], v114 offset:30720
  ds_read_b64_tr_b16 v[204:205], v115 offset:14336
  ds_read_b64_tr_b16 v[206:207], v115 offset:15360
  ds_read_b64_tr_b16 v[208:209], v140 offset:14336
  ds_read_b64_tr_b16 v[210:211], v140 offset:15360
  s_waitcnt lgkmcnt(6)
  v_mfma_f32_16x16x32_bf16 v[120:123], v[60:63], v[196:199], v[120:123]
  v_mfma_f32_16x16x32_bf16 v[124:127], v[60:63], v[200:203], v[124:127]
  v_mfma_f32_16x16x32_bf16 v[128:131], v[60:63], v[232:235], v[128:131]
  s_waitcnt lgkmcnt(0)
  v_mfma_f32_16x16x32_bf16 v[120:123], v[64:67], v[204:207], v[120:123]
  v_mfma_f32_16x16x32_bf16 v[124:127], v[64:67], v[208:211], v[124:127]
  v_mfma_f32_16x16x32_bf16 v[128:131], v[64:67], v[232:235], v[128:131]
  s_lshl_b32 s51, s50, 3
  s_add_u32 s51, s51, s46
  s_lshl_b32 s51, s51, 2
  s_add_u32 s51, s51, s45
  s_lshl_b32 s51, s51, 10
  s_add_u32 s51, s51, 0x100000
  s_lshl_b32 s52, s50, 2
  s_add_u32 s52, s52, s45
  s_lshl_b32 s52, s52, 3
  s_add_u32 s52, s52, s46
  s_lshl_b32 s52, s52, 6
  s_add_u32 s52, s52, 0x300000
  v_lshlrev_b32 v1, 4, v0
  v_lshrrev_b32 v3, 4, v0
  v_lshlrev_b32 v3, 4, v3
  v_cvt_pk_bf16_f32 v132, v120, v121
  v_cvt_pk_bf16_f32 v133, v122, v123
  v_cvt_pk_bf16_f32 v134, v124, v125
  v_cvt_pk_bf16_f32 v135, v126, v127
  buffer_store_dwordx4 v[132:135], v1, s[16:19], s51 offen sc1
  s_mov_b32 exec_lo, 0x00010001
  s_mov_b32 exec_hi, 0x00010001
  buffer_store_dwordx4 v[128:131], v3, s[16:19], s52 offen sc1
  s_mov_b64 exec, -1
  s_waitcnt lgkmcnt(0)
  s_setprio 0
  s_branch L_p2_join
  .p2align 12
L_role_B:
  s_load_dwordx2 s[12:13], s[0:1], 40
  s_load_dwordx2 s[24:25], s[0:1], 48
  s_mov_b32 s14, 0x700000
  s_mov_b32 s26, 0x1c00
  s_and_b32 s49, s2, 3
  s_bfe_u32 s51, s2, 0x10002
  s_lshr_b32 s47, s2, 6
  s_lshl_b32 s52, s51, 2
  s_add_u32 s46, s52, s47
  s_bfe_u32 s48, s2, 0x30003
  s_lshl_b32 s50, s49, 3
  s_add_u32 s50, s50, s48
  s_and_b32 s45, s44, 3
  s_mov_b32 s10, 0x400000
  s_mov_b32 s11, 0x20000
  s_mov_b32 s18, 0x10000000
  s_mov_b32 s19, 0x20000
  s_mov_b32 s22, 0x100
  s_mov_b32 s23, 0x20000
  s_mov_b32 s30, 0x700000
  s_mov_b32 s31, 0x20000
  s_mov_b32 s34, 0x200000
  s_mov_b32 s35, 0x20000
  s_mov_b32 s38, 0x400000
  s_mov_b32 s39, 0x20000
  s_mov_b32 s42, 0x800
  s_mov_b32 s43, 0x20000
  s_mov_b32 s15, 0x20000
  s_mov_b32 s27, 0x20000
  s_lshl_b32 s52, s46, 8
  s_lshl_b32 s53, s44, 5
  s_add_u32 s52, s52, s53
  v_lshrrev_b32 v2, 3, v0
  v_add_u32 v2, s52, v2
  v_lshlrev_b32 v2, 11, v2
  v_lshrrev_b32 v3, 4, v0
  v_and_b32 v4, 7, v0
  v_xor_b32 v5, v4, v3
  v_lshl_add_u32 v236, v5, 4, v2
  v_add_u32 v3, 4, v3
  v_xor_b32 v5, v4, v3
  v_lshl_add_u32 v237, v5, 4, v2
  v_add_u32 v237, 0x3c00, v237
  s_lshl_b32 s62, s44, 12
  s_add_u32 s6, s62, 2048
  s_lshl_b32 s60, s51, 10
  s_lshl_b32 s3, s46, 5
  s_add_u32 s3, s3, s50
  s_lshl_b32 s3, s3, 3
  s_add_u32 s3, s3, s44
  s_lshl_b32 s54, s3, 11
  v_lshlrev_b32 v1, 4, v0
  s_waitcnt lgkmcnt(0)
  buffer_load_dwordx4 v[216:219], v1, s[8:11], s54 offen
  buffer_load_dwordx4 v[220:223], v1, s[8:11], s54 offen offset:1024
  s_add_u32 s52, s60, 0
  s_and_b32 s52, s52, 0x7ff
  s_mov_b32 s53, 0
  s_add_u32 m0, s53, s62
  s_nop 0
  buffer_load_dwordx4 v236, s[8:11], s52 offen lds
  buffer_load_dwordx4 v237, s[8:11], s52 offen offset:1024 lds
  s_mov_b32 s4, 0xffffffff
  s_mov_b32 s5, 0xffffff
  v_mul_u32_u24 v2, 37, v0
  v_lshrrev_b32 v2, 9, v2
  v_mul_u32_u24 v3, 14, v2
  v_sub_u32 v3, v0, v3
  s_lshr_b32 s52, s45, 1
  s_lshl_b32 s52, s52, 4
  s_and_b32 s53, s45, 1
  s_lshl_b32 s53, s53, 2
  s_add_u32 s52, s52, s53
  v_add_u32 v2, s52, v2
  v_mul_u32_u24 v2, 0x1c00, v2
  s_and_b32 s53, s50, 1
  v_lshrrev_b32 v4, 1, v3
  v_add_u32 v4, s53, v4
  v_cmp_eq_u32 vcc, 7, v4
  s_nop 1
  v_cndmask_b32 v4, v4, 0, vcc
  v_and_b32 v3, 1, v3
  v_lshl_add_u32 v3, v4, 1, v3
  s_mul_i32 s52, s50, 224
  v_add_u32 v2, s52, v2
  v_lshl_add_u32 v238, v3, 4, v2
  v_mov_b32 v239, v238
  v_add_u32 v239, 0xdc80, v239
  s_mul_i32 s63, s45, 1792
  s_add_u32 s63, s63, 104448
  s_lshr_b32 s52, s60, 1
  s_mul_i32 s61, s52, 7168
  v_and_b32 v2, 15, v0
  v_lshrrev_b32 v3, 4, v0
  v_lshrrev_b32 v4, 1, v3
  v_lshlrev_b32 v4, 4, v4
  v_and_b32 v5, 1, v3
  v_lshl_add_u32 v4, v5, 2, v4
  v_lshrrev_b32 v6, 2, v2
  v_add_u32 v4, v4, v6
  v_mul_u32_u24 v4, 224, v4
  v_and_b32 v6, 3, v2
  v_lshl_add_u32 v4, v6, 3, v4
  v_add_u32 v4, 104448, v4
  v_mov_b32 v242, v4
  v_lshrrev_b32 v4, 1, v2
  v_xor_b32 v4, v4, v3
  s_lshl_b32 s52, s45, 6
  v_add_u32 v2, s52, v2
  v_lshlrev_b32 v2, 7, v2
  v_lshl_add_u32 v240, v4, 4, v2
  v_xor_b32 v241, 64, v240
  s_mov_b32 m0, s63
  s_mov_b64 exec, s[4:5]
  buffer_load_dwordx4 v238, s[12:15], s61 offen lds
  buffer_load_dwordx4 v239, s[12:15], s61 offen offset:896 lds
  s_mov_b64 exec, -1
  s_add_u32 s63, s63, 13312
  s_add_u32 s61, s61, 229376
  s_cmp_eq_u32 s61, 7340032
  s_cselect_b32 s61, 0, s61
  v_mov_b64 v[4:5], 0
  v_mov_b64 v[6:7], 0
  v_mov_b64 v[8:9], 0
  v_mov_b64 v[10:11], 0
  v_mov_b64 v[16:17], 0
  v_mov_b64 v[18:19], 0
  v_mov_b64 v[20:21], 0
  v_mov_b64 v[22:23], 0
  v_mov_b64 v[24:25], 0
  v_mov_b64 v[26:27], 0
  v_mov_b64 v[28:29], 0
  v_mov_b64 v[30:31], 0
  v_mov_b64 v[32:33], 0
  v_mov_b64 v[34:35], 0
  v_mov_b64 v[36:37], 0
  v_mov_b64 v[38:39], 0
  v_mov_b64 v[40:41], 0
  v_mov_b64 v[42:43], 0
  v_mov_b64 v[44:45], 0
  v_mov_b64 v[46:47], 0
  v_mov_b64 v[48:49], 0
  v_mov_b64 v[50:51], 0
  v_mov_b64 v[52:53], 0
  v_mov_b64 v[54:55], 0
  v_mov_b64 v[56:57], 0
  v_mov_b64 v[58:59], 0
  v_mov_b64 v[60:61], 0
  v_mov_b64 v[62:63], 0
  v_mov_b64 v[64:65], 0
  v_mov_b64 v[66:67], 0
  v_mov_b64 v[68:69], 0
  v_mov_b64 v[70:71], 0
  v_mov_b64 v[72:73], 0
  v_mov_b64 v[74:75], 0
  v_mov_b64 v[76:77], 0
  s_add_u32 s52, s60, 0
  s_and_b32 s52, s52, 0x7ff
  s_add_u32 s52, s52, 32768
  s_mov_b32 s53, 0
  s_add_u32 m0, s53, s6
  s_nop 0
  buffer_load_dwordx4 v236, s[8:11], s52 offen lds
  buffer_load_dwordx4 v237, s[8:11], s52 offen offset:1024 lds
  s_waitcnt vmcnt(6)
  v_mov_b32 v12, 0
  s_mov_b32 s52, 0x3f803f80
  v_dot2c_f32_bf16 v12, s52, v216
  v_dot2c_f32_bf16 v12, s52, v217
  v_dot2c_f32_bf16 v12, s52, v218
  v_dot2c_f32_bf16 v12, s52, v219
  v_dot2c_f32_bf16 v12, s52, v220
  v_dot2c_f32_bf16 v12, s52, v221
  v_dot2c_f32_bf16 v12, s52, v222
  v_dot2c_f32_bf16 v12, s52, v223
  s_nop 2
  v_add_f32_dpp v12, v12, v12 row_ror:8 row_mask:0xf bank_mask:0xf
  s_nop 1
  v_add_f32_dpp v12, v12, v12 row_ror:4 row_mask:0xf bank_mask:0xf
  s_nop 1
  v_add_f32_dpp v12, v12, v12 row_ror:2 row_mask:0xf bank_mask:0xf
  s_nop 1
  v_add_f32_dpp v12, v12, v12 row_ror:1 row_mask:0xf bank_mask:0xf
  v_mov_b32 v13, v12
  s_nop 1
  v_permlane16_swap_b32 v12, v13
  v_add_f32 v12, v12, v13
  v_mov_b32 v13, v12
  s_nop 1
  v_permlane32_swap_b32 v12, v13
  v_add_f32 v12, v12, v13
  v_mul_f32 v12, 0x3a800000, v12
  v_lshlrev_b32 v172, 16, v216
  v_and_b32 v173, 0xffff0000, v216
  v_lshlrev_b32 v174, 16, v217
  v_and_b32 v175, 0xffff0000, v217
  v_lshlrev_b32 v176, 16, v218
  v_and_b32 v177, 0xffff0000, v218
  v_lshlrev_b32 v178, 16, v219
  v_and_b32 v179, 0xffff0000, v219
  v_lshlrev_b32 v180, 16, v220
  v_and_b32 v181, 0xffff0000, v220
  v_lshlrev_b32 v182, 16, v221
  v_and_b32 v183, 0xffff0000, v221
  v_lshlrev_b32 v184, 16, v222
  v_and_b32 v185, 0xffff0000, v222
  v_lshlrev_b32 v186, 16, v223
  v_and_b32 v187, 0xffff0000, v223
  v_sub_f32 v172, v172, v12
  v_sub_f32 v173, v173, v12
  v_sub_f32 v174, v174, v12
  v_sub_f32 v175, v175, v12
  v_sub_f32 v176, v176, v12
  v_sub_f32 v177, v177, v12
  v_sub_f32 v178, v178, v12
  v_sub_f32 v179, v179, v12
  v_sub_f32 v180, v180, v12
  v_sub_f32 v181, v181, v12
  v_sub_f32 v182, v182, v12
  v_sub_f32 v183, v183, v12
  v_sub_f32 v184, v184, v12
  v_sub_f32 v185, v185, v12
  v_sub_f32 v186, v186, v12
  v_sub_f32 v187, v187, v12
  v_mul_f32 v14, v172, v172
  v_mul_f32 v15, v173, v173
  v_fmac_f32 v14, v174, v174
  v_fmac_f32 v15, v175, v175
  v_fmac_f32 v14, v176, v176
  v_fmac_f32 v15, v177, v177
  v_fmac_f32 v14, v178, v178
  v_fmac_f32 v15, v179, v179
  v_fmac_f32 v14, v180, v180
  v_fmac_f32 v15, v181, v181
  v_fmac_f32 v14, v182, v182
  v_fmac_f32 v15, v183, v183
  v_fmac_f32 v14, v184, v184
  v_fmac_f32 v15, v185, v185
  v_fmac_f32 v14, v186, v186
  v_fmac_f32 v15, v187, v187
  v_add_f32 v14, v14, v15
  s_nop 1
  v_add_f32_dpp v14, v14, v14 row_ror:8 row_mask:0xf bank_mask:0xf
  s_nop 1
  v_add_f32_dpp v14, v14, v14 row_ror:4 row_mask:0xf bank_mask:0xf
  s_nop 1
  v_add_f32_dpp v14, v14, v14 row_ror:2 row_mask:0xf bank_mask:0xf
  s_nop 1
  v_add_f32_dpp v14, v14, v14 row_ror:1 row_mask:0xf bank_mask:0xf
  v_mov_b32 v13, v14
  s_nop 1
  v_permlane16_swap_b32 v14, v13
  v_add_f32 v14, v14, v13
  v_mov_b32 v13, v14
  s_nop 1
  v_permlane32_swap_b32 v14, v13
  v_add_f32 v14, v14, v13
  v_mul_f32 v14, 0x3a800000, v14
  v_cvt_pk_bf16_f32 v12, v12, v12
  v_lshlrev_b32 v12, 16, v12
  v_cvt_pk_bf16_f32 v14, v14, v14
  v_lshlrev_b32 v14, 16, v14
  v_add_f32 v14, 0x3727c5ac, v14
  v_cvt_pk_bf16_f32 v14, v14, v14
  v_lshlrev_b32 v14, 16, v14
  v_sqrt_f32 v14, v14
  s_nop 0
  v_cvt_pk_bf16_f32 v14, v14, v14
  v_lshlrev_b32 v14, 16, v14
  v_rcp_f32 v13, v14
  s_lshl_b32 s52, s3, 3
  v_mov_b32 v14, 0
  s_mov_b64 exec, 1
  buffer_store_dwordx2 v[12:13], v14, s[16:19], s52 offen offset:0 sc1
  s_mov_b64 exec, -1
  s_mov_b32 m0, s63
  s_mov_b64 exec, s[4:5]
  buffer_load_dwordx4 v238, s[12:15], s61 offen lds
  buffer_load_dwordx4 v239, s[12:15], s61 offen offset:896 lds
  s_mov_b64 exec, -1
  s_add_u32 s63, s63, 13312
  s_add_u32 s61, s61, 229376
  s_cmp_eq_u32 s61, 7340032
  s_cselect_b32 s61, 0, s61
L_main_B:
  v_mov_b64 v[78:79], 0
  v_mov_b64 v[80:81], 0
  v_mov_b64 v[82:83], 0
  v_mov_b64 v[84:85], 0
  v_mov_b64 v[86:87], 0
  v_mov_b64 v[88:89], 0
  v_mov_b64 v[90:91], 0
  v_mov_b64 v[92:93], 0
  v_mov_b64 v[94:95], 0
  v_mov_b64 v[96:97], 0
  v_mov_b64 v[98:99], 0
  v_mov_b64 v[100:101], 0
  v_mov_b64 v[102:103], 0
  v_mov_b64 v[104:105], 0
  v_mov_b64 v[106:107], 0
  v_mov_b64 v[108:109], 0
  v_mov_b64 v[110:111], 0
  v_mov_b64 v[112:113], 0
  v_mov_b64 v[114:115], 0
  v_mov_b64 v[116:117], 0
  v_mov_b64 v[118:119], 0
  v_mov_b64 v[120:121], 0
  v_mov_b64 v[122:123], 0
  v_mov_b64 v[124:125], 0
  v_mov_b64 v[126:127], 0
  v_mov_b64 v[128:129], 0
  v_mov_b64 v[130:131], 0
  v_mov_b64 v[132:133], 0
  v_mov_b64 v[134:135], 0
  v_mov_b64 v[136:137], 0
  v_mov_b64 v[138:139], 0
  v_mov_b64 v[140:141], 0
  v_mov_b64 v[142:143], 0
  v_mov_b64 v[12:13], 0
  v_mov_b64 v[14:15], 0
  v_mov_b32 v232, 0x3f803f80
  v_mov_b32 v233, 0x3f803f80
  v_mov_b32 v234, 0x3f803f80
  v_mov_b32 v235, 0x3f803f80
  s_add_u32 s52, s60, 128
  s_and_b32 s52, s52, 0x7ff
  s_mov_b32 s53, 32768
  s_add_u32 m0, s53, s62
  s_nop 0
  buffer_load_dwordx4 v236, s[8:11], s52 offen lds
  buffer_load_dwordx4 v237, s[8:11], s52 offen offset:1024 lds
  s_cmp_eq_u32 s45, 0
  s_cbranch_scc1 L_touch_2
  s_cmp_eq_u32 s45, 1
  s_cbranch_scc1 L_touch_3
  s_cmp_eq_u32 s45, 2
  s_cbranch_scc1 L_touch_6
  s_branch L_touch_7
L_tret_B0:
  s_cmp_eq_u32 s45, 0
  s_cbranch_scc1 L_touch_8
L_tret_B1:
  s_waitcnt vmcnt(5)
  s_barrier
  ds_read_b128 v[200:203], v240 offset:0
  ds_read_b128 v[204:207], v240 offset:2048
  ds_read_b128 v[208:211], v240 offset:4096
  ds_read_b128 v[212:215], v240 offset:6144
  ds_read_b64_tr_b16 v[144:145], v242 offset:0
  ds_read_b64_tr_b16 v[146:147], v242 offset:1792
  ds_read_b64_tr_b16 v[148:149], v242 offset:32
  ds_read_b64_tr_b16 v[150:151], v242 offset:1824
  ds_read_b64_tr_b16 v[152:153], v242 offset:64
  ds_read_b64_tr_b16 v[154:155], v242 offset:1856
  ds_read_b64_tr_b16 v[156:157], v242 offset:96
  ds_read_b64_tr_b16 v[158:159], v242 offset:1888
  ds_read_b64_tr_b16 v[160:161], v242 offset:128
  ds_read_b64_tr_b16 v[162:163], v242 offset:1920
  ds_read_b64_tr_b16 v[164:165], v242 offset:160
  ds_read_b64_tr_b16 v[166:167], v242 offset:1952
  ds_read_b64_tr_b16 v[168:169], v242 offset:192
  ds_read_b64_tr_b16 v[170:171], v242 offset:1984
  s_add_u32 s52, s60, 128
  s_and_b32 s52, s52, 0x7ff
  s_add_u32 s52, s52, 32768
  s_mov_b32 s53, 32768
  s_add_u32 m0, s53, s6
  s_nop 0
  buffer_load_dwordx4 v236, s[8:11], s52 offen lds
  buffer_load_dwordx4 v237, s[8:11], s52 offen offset:1024 lds
  v_lshrrev_b32 v1, 2, v0
  v_min_u32 v1, 6, v1
  s_and_b32 s53, s50, 1
  v_add_u32 v1, s53, v1
  v_cmp_eq_u32 vcc, 7, v1
  s_nop 1
  v_cndmask_b32 v1, v1, 0, vcc
  v_lshlrev_b32 v1, 5, v1
  v_and_b32 v2, 3, v0
  v_lshl_add_u32 v1, v2, 3, v1
  s_mul_i32 s51, s50, 224
  buffer_load_dwordx2 v[252:253], v1, s[24:27], s51 offen
  s_cmp_lg_u32 s44, 0
  s_cbranch_scc1 L_mi_3
  v_mov_b32 v2, 0
  s_lshl_b32 s52, s46, 2
  s_add_u32 s52, s52, s49
  s_lshl_b32 s52, s52, 8
  s_add_u32 s52, s52, 0x80000
  s_lshl_b32 s56, s48, 2
  s_add_u32 s52, s52, s56
  v_writelane_b32 v2, s52, 0
  s_lshl_b32 s52, s50, 8
  s_add_u32 s52, s52, 0x84000
  s_lshl_b32 s56, s46, 2
  s_add_u32 s52, s52, s56
  v_writelane_b32 v2, s52, 1
  s_lshl_b32 s52, s46, 8
  s_add_u32 s52, s52, 0x88000
  s_lshl_b32 s56, s50, 2
  s_add_u32 s52, s52, s56
  v_writelane_b32 v2, s52, 2
  s_lshl_b32 s52, s46, 3
  s_add_u32 s52, s52, s48
  s_lshl_b32 s52, s52, 8
  s_add_u32 s52, s52, 0x8c000
  s_lshl_b32 s56, s49, 2
  s_add_u32 s52, s52, s56
  v_writelane_b32 v2, s52, 3
  v_mov_b32 v3, 0
  s_mov_b64 exec, 15
  buffer_store_dword v3, v2, s[16:19], 0 offen sc1
  s_mov_b64 exec, -1
  v_lshlrev_b32 v2, 2, v0
  v_add_u32 v2, 161792, v2
  ds_write_b32 v2, v3
L_mi_3:
  s_add_u32 s60, s60, 256
  s_and_b32 s60, s60, 0x7ff
  s_mov_b32 s57, 65536
  s_mov_b32 s58, 0
  s_mov_b32 s59, 32768
  s_mov_b32 s96, 13312
  s_mov_b32 m0, s63
  s_mov_b64 exec, s[4:5]
  buffer_load_dwordx4 v238, s[12:15], s61 offen lds
  buffer_load_dwordx4 v239, s[12:15], s61 offen offset:896 lds
  s_mov_b64 exec, -1
  s_add_u32 s63, s63, 13312
  s_add_u32 s61, s61, 229376
  s_cmp_eq_u32 s61, 7340032
  s_cselect_b32 s61, 0, s61
  s_add_u32 m0, s57, s62
  s_nop 0
  buffer_load_dwordx4 v236, s[8:11], s60 offen lds
  buffer_load_dwordx4 v237, s[8:11], s60 offen offset:1024 lds
  s_mov_b32 m0, s63
  s_mov_b64 exec, s[4:5]
  buffer_load_dwordx4 v238, s[12:15], s61 offen lds
  buffer_load_dwordx4 v239, s[12:15], s61 offen offset:896 lds
  s_mov_b64 exec, -1
  s_add_u32 s63, s63, 13312
  s_add_u32 s61, s61, 229376
  s_cmp_eq_u32 s61, 7340032
  s_cselect_b32 s61, 0, s61
  s_sub_u32 s63, s63, 53248
  v_add_u32 v240, 32768, v240
  v_add_u32 v242, 13312, v242
  s_mov_b32 s97, 0
  s_lshl_b32 s52, s47, 1
  s_lshl_b32 s99, 3, s52
  s_or_b32 s98, s99, 0x1100
  s_waitcnt vmcnt(11) lgkmcnt(0)
  s_barrier
  v_mfma_f32_16x16x32_bf16 v[4:7], v[144:147], v[200:203], v[4:7]
  ds_read_b64_tr_b16 v[172:173], v242 offset:0
  v_mfma_f32_16x16x32_bf16 v[8:11], v[144:147], v[204:207], v[8:11]
  ds_read_b64_tr_b16 v[174:175], v242 offset:1792
L_loop_B:
  s_bitcmp1_b32 s98, s97
  s_cbranch_scc1 L_hk_B0
L_hkr_B0:
  v_mfma_f32_16x16x32_bf16 v[12:15], v[144:147], v[208:211], v[12:15]
  ds_read_b128 v[216:219], v241 offset:0
  s_add_u32 s51, s60, 32768
  s_add_u32 m0, s57, s6
  s_nop 0
  buffer_load_dwordx4 v236, s[8:11], s51 offen lds
  v_mfma_f32_16x16x32_bf16 v[16:19], v[144:147], v[212:215], v[16:19]
  ds_read_b128 v[220:223], v241 offset:2048
  v_mfma_f32_16x16x32_bf16 v[20:23], v[148:151], v[200:203], v[20:23]
  ds_read_b128 v[224:227], v241 offset:4096
  v_mfma_f32_16x16x32_bf16 v[24:27], v[148:151], v[204:207], v[24:27]
  ds_read_b128 v[228:231], v241 offset:6144
  v_mfma_f32_16x16x32_bf16 v[28:31], v[148:151], v[208:211], v[28:31]
  ds_read_b64_tr_b16 v[176:177], v242 offset:32
  buffer_load_dwordx4 v237, s[8:11], s51 offen offset:1024 lds
  v_mfma_f32_16x16x32_bf16 v[32:35], v[148:151], v[212:215], v[32:35]
  ds_read_b64_tr_b16 v[178:179], v242 offset:1824
  v_mfma_f32_16x16x32_bf16 v[36:39], v[152:155], v[200:203], v[36:39]
  ds_read_b64_tr_b16 v[180:181], v242 offset:64
  v_mfma_f32_16x16x32_bf16 v[40:43], v[152:155], v[204:207], v[40:43]
  ds_read_b64_tr_b16 v[182:183], v242 offset:1856
  v_mfma_f32_16x16x32_bf16 v[44:47], v[152:155], v[208:211], v[44:47]
  ds_read_b64_tr_b16 v[184:185], v242 offset:96
  s_mov_b32 m0, s63
  s_mov_b64 exec, s[4:5]
  buffer_load_dwordx4 v238, s[12:15], s61 offen lds
  buffer_load_dwordx4 v239, s[12:15], s61 offen offset:896 lds
  s_mov_b64 exec, -1
  v_mfma_f32_16x16x32_bf16 v[48:51], v[152:155], v[212:215], v[48:51]
  ds_read_b64_tr_b16 v[186:187], v242 offset:1888
  v_mfma_f32_16x16x32_bf16 v[52:55], v[156:159], v[200:203], v[52:55]
  ds_read_b64_tr_b16 v[188:189], v242 offset:128
  v_mfma_f32_16x16x32_bf16 v[56:59], v[156:159], v[204:207], v[56:59]
  ds_read_b64_tr_b16 v[190:191], v242 offset:1920
  v_mfma_f32_16x16x32_bf16 v[60:63], v[156:159], v[208:211], v[60:63]
  ds_read_b64_tr_b16 v[192:193], v242 offset:160
  s_add_u32 s61, s61, 229376
  s_cmp_eq_u32 s61, 7340032
  s_cselect_b32 s61, 0, s61
  s_add_u32 s63, s63, 13312
  v_mfma_f32_16x16x32_bf16 v[64:67], v[156:159], v[212:215], v[64:67]
  ds_read_b64_tr_b16 v[194:195], v242 offset:1952
  v_mfma_f32_16x16x32_bf16 v[68:71], v[160:163], v[200:203], v[68:71]
  ds_read_b64_tr_b16 v[196:197], v242 offset:192
  v_mfma_f32_16x16x32_bf16 v[72:75], v[160:163], v[204:207], v[72:75]
  ds_read_b64_tr_b16 v[198:199], v242 offset:1984
  v_mfma_f32_16x16x32_bf16 v[76:79], v[160:163], v[208:211], v[76:79]
  v_mfma_f32_16x16x32_bf16 v[80:83], v[160:163], v[212:215], v[80:83]
  s_sub_u32 s52, s59, s58
  v_add_u32 v241, s52, v241
  v_mfma_f32_16x16x32_bf16 v[84:87], v[164:167], v[200:203], v[84:87]
  v_mfma_f32_16x16x32_bf16 v[88:91], v[164:167], v[204:207], v[88:91]
  v_add_u32 v242, s96, v242
  v_mfma_f32_16x16x32_bf16 v[92:95], v[164:167], v[208:211], v[92:95]
  v_mfma_f32_16x16x32_bf16 v[96:99], v[164:167], v[212:215], v[96:99]
  v_mfma_f32_16x16x32_bf16 v[100:103], v[168:171], v[200:203], v[100:103]
  v_mfma_f32_16x16x32_bf16 v[104:107], v[168:171], v[204:207], v[104:107]
  v_mfma_f32_16x16x32_bf16 v[108:111], v[168:171], v[208:211], v[108:111]
  v_mfma_f32_16x16x32_bf16 v[112:115], v[168:171], v[212:215], v[112:115]
  s_waitcnt vmcnt(8) lgkmcnt(0)
  s_barrier
  v_mfma_f32_16x16x32_bf16 v[4:7], v[172:175], v[216:219], v[4:7]
  ds_read_b64_tr_b16 v[144:145], v242 offset:0
  v_mfma_f32_16x16x32_bf16 v[8:11], v[172:175], v[220:223], v[8:11]
  ds_read_b64_tr_b16 v[146:147], v242 offset:1792
  s_bitcmp1_b32 s99, s97
  s_cbranch_scc1 L_hk_B1
L_hkr_B1:
  v_mfma_f32_16x16x32_bf16 v[12:15], v[172:175], v[224:227], v[12:15]
  ds_read_b128 v[200:203], v240 offset:0
  s_add_u32 s60, s60, 128
  s_and_b32 s60, s60, 0x7ff
  s_add_u32 m0, s58, s62
  s_nop 0
  buffer_load_dwordx4 v236, s[8:11], s60 offen lds
  v_mfma_f32_16x16x32_bf16 v[16:19], v[172:175], v[228:231], v[16:19]
  ds_read_b128 v[204:207], v240 offset:2048
  v_mfma_f32_16x16x32_bf16 v[20:23], v[176:179], v[216:219], v[20:23]
  ds_read_b128 v[208:211], v240 offset:4096
  v_mfma_f32_16x16x32_bf16 v[24:27], v[176:179], v[220:223], v[24:27]
  ds_read_b128 v[212:215], v240 offset:6144
  v_mfma_f32_16x16x32_bf16 v[28:31], v[176:179], v[224:227], v[28:31]
  ds_read_b64_tr_b16 v[148:149], v242 offset:32
  buffer_load_dwordx4 v237, s[8:11], s60 offen offset:1024 lds
  v_mfma_f32_16x16x32_bf16 v[32:35], v[176:179], v[228:231], v[32:35]
  ds_read_b64_tr_b16 v[150:151], v242 offset:1824
  v_mfma_f32_16x16x32_bf16 v[36:39], v[180:183], v[216:219], v[36:39]
  ds_read_b64_tr_b16 v[152:153], v242 offset:64
  v_mfma_f32_16x16x32_bf16 v[40:43], v[180:183], v[220:223], v[40:43]
  ds_read_b64_tr_b16 v[154:155], v242 offset:1856
  v_mfma_f32_16x16x32_bf16 v[44:47], v[180:183], v[224:227], v[44:47]
  ds_read_b64_tr_b16 v[156:157], v242 offset:96
  s_mov_b32 m0, s63
  s_mov_b64 exec, s[4:5]
  buffer_load_dwordx4 v238, s[12:15], s61 offen lds
  buffer_load_dwordx4 v239, s[12:15], s61 offen offset:896 lds
  s_mov_b64 exec, -1
  v_mfma_f32_16x16x32_bf16 v[48:51], v[180:183], v[228:231], v[48:51]
  ds_read_b64_tr_b16 v[158:159], v242 offset:1888
  v_mfma_f32_16x16x32_bf16 v[52:55], v[184:187], v[216:219], v[52:55]
  ds_read_b64_tr_b16 v[160:161], v242 offset:128
  v_mfma_f32_16x16x32_bf16 v[56:59], v[184:187], v[220:223], v[56:59]
  ds_read_b64_tr_b16 v[162:163], v242 offset:1920
  v_mfma_f32_16x16x32_bf16 v[60:63], v[184:187], v[224:227], v[60:63]
  ds_read_b64_tr_b16 v[164:165], v242 offset:160
  s_add_u32 s61, s61, 229376
  s_cmp_eq_u32 s61, 7340032
  s_cselect_b32 s61, 0, s61
  s_add_u32 s63, s63, s96
  v_mfma_f32_16x16x32_bf16 v[64:67], v[184:187], v[228:231], v[64:67]
  ds_read_b64_tr_b16 v[166:167], v242 offset:1952
  v_mfma_f32_16x16x32_bf16 v[68:71], v[188:191], v[216:219], v[68:71]
  ds_read_b64_tr_b16 v[168:169], v242 offset:192
  v_mfma_f32_16x16x32_bf16 v[72:75], v[188:191], v[220:223], v[72:75]
  ds_read_b64_tr_b16 v[170:171], v242 offset:1984
  v_mfma_f32_16x16x32_bf16 v[76:79], v[188:191], v[224:227], v[76:79]
  v_mfma_f32_16x16x32_bf16 v[80:83], v[188:191], v[228:231], v[80:83]
  s_sub_u32 s52, s57, s59
  v_add_u32 v240, s52, v240
  v_mfma_f32_16x16x32_bf16 v[84:87], v[192:195], v[216:219], v[84:87]
  v_mfma_f32_16x16x32_bf16 v[88:91], v[192:195], v[220:223], v[88:91]
  v_add_u32 v242, 0x3400, v242
  v_mfma_f32_16x16x32_bf16 v[92:95], v[192:195], v[224:227], v[92:95]
  s_mov_b32 s53, s57
  s_mov_b32 s57, s58
  s_mov_b32 s58, s59
  s_mov_b32 s59, s53
  s_xor_b32 s96, s96, 0xffff5000
  v_mfma_f32_16x16x32_bf16 v[96:99], v[192:195], v[228:231], v[96:99]
  v_mfma_f32_16x16x32_bf16 v[100:103], v[196:199], v[216:219], v[100:103]
  s_add_u32 s97, s97, 1
  v_mfma_f32_16x16x32_bf16 v[104:107], v[196:199], v[220:223], v[104:107]
  v_mfma_f32_16x16x32_bf16 v[108:111], v[196:199], v[224:227], v[108:111]
  v_mfma_f32_16x16x32_bf16 v[112:115], v[196:199], v[228:231], v[112:115]
  s_waitcnt vmcnt(8) lgkmcnt(0)
  s_barrier
  v_mfma_f32_16x16x32_bf16 v[4:7], v[144:147], v[200:203], v[4:7]
  ds_read_b64_tr_b16 v[172:173], v242 offset:0
  v_mfma_f32_16x16x32_bf16 v[8:11], v[144:147], v[204:207], v[8:11]
  ds_read_b64_tr_b16 v[174:175], v242 offset:1792
  s_cmp_lg_u32 s97, 13
  s_cbranch_scc1 L_loop_B
  s_branch L_tail_B
L_hk_B1:
  v_mfma_f32_16x16x32_bf16 v[116:119], v[172:175], v[232:235], v[116:119]
  v_mfma_f32_16x16x32_bf16 v[120:123], v[176:179], v[232:235], v[120:123]
  v_mfma_f32_16x16x32_bf16 v[124:127], v[180:183], v[232:235], v[124:127]
  v_mfma_f32_16x16x32_bf16 v[128:131], v[184:187], v[232:235], v[128:131]
  v_mfma_f32_16x16x32_bf16 v[132:135], v[188:191], v[232:235], v[132:135]
  v_mfma_f32_16x16x32_bf16 v[136:139], v[192:195], v[232:235], v[136:139]
  v_mfma_f32_16x16x32_bf16 v[140:143], v[196:199], v[232:235], v[140:143]
  s_branch L_hkr_B1
L_hk_B0:
  s_bitcmp1_b32 s99, s97
  s_cbranch_scc0 L_hk_B_ncs
  v_mfma_f32_16x16x32_bf16 v[116:119], v[144:147], v[232:235], v[116:119]
  v_mfma_f32_16x16x32_bf16 v[120:123], v[148:151], v[232:235], v[120:123]
  v_mfma_f32_16x16x32_bf16 v[124:127], v[152:155], v[232:235], v[124:127]
  v_mfma_f32_16x16x32_bf16 v[128:131], v[156:159], v[232:235], v[128:131]
  v_mfma_f32_16x16x32_bf16 v[132:135], v[160:163], v[232:235], v[132:135]
  v_mfma_f32_16x16x32_bf16 v[136:139], v[164:167], v[232:235], v[136:139]
  v_mfma_f32_16x16x32_bf16 v[140:143], v[168:171], v[232:235], v[140:143]
  s_branch L_hkr_B0
L_hk_B_ncs:
  s_cmp_eq_u32 s97, 12
  s_cbranch_scc1 L_hk_B_12
  s_cmp_lg_u32 s45, 0
  s_cbranch_scc1 L_hkr_B0
  s_lshl_b32 s51, s50, 3
  s_add_u32 s51, s51, s46
  s_lshl_b32 s51, s51, 10
  s_add_u32 s51, s51, 0x10200
  v_lshrrev_b32 v1, 4, v0
  v_lshlrev_b32 v1, 4, v1
  v_and_b32 v2, 15, v0
  v_lshl_add_u32 v1, v2, 6, v1
  s_mov_b32 exec_lo, 0x20002
  s_mov_b32 exec_hi, 0x20002
  v_mov_b64 v[116:117], v[120:121]
  v_mov_b64 v[118:119], v[122:123]
  s_mov_b32 exec_lo, 0x40004
  s_mov_b32 exec_hi, 0x40004
  v_mov_b64 v[116:117], v[124:125]
  v_mov_b64 v[118:119], v[126:127]
  s_mov_b32 exec_lo, 0x80008
  s_mov_b32 exec_hi, 0x80008
  v_mov_b64 v[116:117], v[128:129]
  v_mov_b64 v[118:119], v[130:131]
  s_mov_b32 exec_lo, 0x100010
  s_mov_b32 exec_hi, 0x100010
  v_mov_b64 v[116:117], v[132:133]
  v_mov_b64 v[118:119], v[134:135]
  s_mov_b32 exec_lo, 0x200020
  s_mov_b32 exec_hi, 0x200020
  v_mov_b64 v[116:117], v[136:137]
  v_mov_b64 v[118:119], v[138:139]
  s_mov_b32 exec_lo, 0x400040
  s_mov_b32 exec_hi, 0x400040
  v_mov_b64 v[116:117], v[140:141]
  v_mov_b64 v[118:119], v[142:143]
  s_mov_b32 exec_lo, 0x7f007f
  s_mov_b32 exec_hi, 0x7f007f
  buffer_store_dwordx4 v[116:119], v1, s[16:19], s51 offen sc1
  s_mov_b64 exec, -1
  s_branch L_hkr_B0
L_hk_B_12:
  v_and_b32 v1, 1, v0
  v_lshlrev_b32 v1, 7, v1
  v_bfe_u32 v2, v0, 1, 2
  v_lshl_add_u32 v1, v2, 2, v1
  buffer_load_dword v254, v1, s[20:23], 0 offen sc1
  s_branch L_hkr_B0
L_tail_B:
  v_mfma_f32_16x16x32_bf16 v[12:15], v[144:147], v[208:211], v[12:15]
  ds_read_b128 v[216:219], v241 offset:0
  s_add_u32 s51, s60, 32768
  s_add_u32 m0, s57, s6
  s_nop 0
  buffer_load_dwordx4 v236, s[8:11], s51 offen lds
  v_cmp_gt_u32 vcc, 32, v254
  v_mfma_f32_16x16x32_bf16 v[16:19], v[144:147], v[212:215], v[16:19]
  ds_read_b128 v[220:223], v241 offset:2048
  s_nop 0
  s_cmp_eq_u64 vcc, 0
  s_cbranch_scc0 L_spin_s1B
L_spinr_s1B:
  v_mfma_f32_16x16x32_bf16 v[20:23], v[148:151], v[200:203], v[20:23]
  ds_read_b128 v[224:227], v241 offset:4096
  v_and_b32 v1, 31, v0
  v_mfma_f32_16x16x32_bf16 v[24:27], v[148:151], v[204:207], v[24:27]
  ds_read_b128 v[228:231], v241 offset:6144
  v_mfma_f32_16x16x32_bf16 v[28:31], v[148:151], v[208:211], v[28:31]
  ds_read_b64_tr_b16 v[176:177], v242 offset:32
  buffer_load_dwordx4 v237, s[8:11], s51 offen offset:1024 lds
  v_lshlrev_b32 v1, 4, v1
  v_mfma_f32_16x16x32_bf16 v[32:35], v[148:151], v[212:215], v[32:35]
  ds_read_b64_tr_b16 v[178:179], v242 offset:1824
  v_lshrrev_b32 v2, 5, v0
  v_mfma_f32_16x16x32_bf16 v[36:39], v[152:155], v[200:203], v[36:39]
  ds_read_b64_tr_b16 v[180:181], v242 offset:64
  v_mfma_f32_16x16x32_bf16 v[40:43], v[152:155], v[204:207], v[40:43]
  ds_read_b64_tr_b16 v[182:183], v242 offset:1856
  v_lshl_add_u32 v1, v2, 10, v1
  v_mfma_f32_16x16x32_bf16 v[44:47], v[152:155], v[208:211], v[44:47]
  ds_read_b64_tr_b16 v[184:185], v242 offset:96
  s_mov_b32 m0, s63
  s_mov_b64 exec, s[4:5]
  buffer_load_dwordx4 v238, s[12:15], s61 offen lds
  buffer_load_dwordx4 v239, s[12:15], s61 offen offset:896 lds
  s_branch L_tover_2
L_touch_2:
  s_branch L_tret_B0
L_tover_2:
  s_mov_b64 exec, -1
  s_lshl_b32 s54, s50, 13
  s_add_u32 s54, s54, 0x10200
  v_mfma_f32_16x16x32_bf16 v[48:51], v[152:155], v[212:215], v[48:51]
  ds_read_b64_tr_b16 v[186:187], v242 offset:1888
  v_mfma_f32_16x16x32_bf16 v[52:55], v[156:159], v[200:203], v[52:55]
  ds_read_b64_tr_b16 v[188:189], v242 offset:128
  buffer_load_dwordx4 v[116:119], v1, s[16:19], s54 offen offset:0 sc1
  v_mfma_f32_16x16x32_bf16 v[56:59], v[156:159], v[204:207], v[56:59]
  ds_read_b64_tr_b16 v[190:191], v242 offset:1920
  v_mfma_f32_16x16x32_bf16 v[60:63], v[156:159], v[208:211], v[60:63]
  ds_read_b64_tr_b16 v[192:193], v242 offset:160
  s_add_u32 s61, s61, 229376
  s_cmp_eq_u32 s61, 7340032
  s_cselect_b32 s61, 0, s61
  s_add_u32 s63, s63, 13312
  v_mfma_f32_16x16x32_bf16 v[64:67], v[156:159], v[212:215], v[64:67]
  ds_read_b64_tr_b16 v[194:195], v242 offset:1952
  buffer_load_dwordx4 v[120:123], v1, s[16:19], s54 offen offset:2048 sc1
  s_add_u32 s54, s54, 4096
  v_mfma_f32_16x16x32_bf16 v[68:71], v[160:163], v[200:203], v[68:71]
  ds_read_b64_tr_b16 v[196:197], v242 offset:192
  v_mfma_f32_16x16x32_bf16 v[72:75], v[160:163], v[204:207], v[72:75]
  ds_read_b64_tr_b16 v[198:199], v242 offset:1984
  v_mfma_f32_16x16x32_bf16 v[76:79], v[160:163], v[208:211], v[76:79]
  v_mfma_f32_16x16x32_bf16 v[80:83], v[160:163], v[212:215], v[80:83]
  s_sub_u32 s52, s59, s58
  v_add_u32 v241, s52, v241
  buffer_load_dwordx4 v[124:127], v1, s[16:19], s54 offen offset:0 sc1
  v_mfma_f32_16x16x32_bf16 v[84:87], v[164:167], v[200:203], v[84:87]
  v_mfma_f32_16x16x32_bf16 v[88:91], v[164:167], v[204:207], v[88:91]
  v_add_u32 v242, s96, v242
  v_mfma_f32_16x16x32_bf16 v[92:95], v[164:167], v[208:211], v[92:95]
  buffer_load_dwordx4 v[128:131], v1, s[16:19], s54 offen offset:2048 sc1
  v_mfma_f32_16x16x32_bf16 v[96:99], v[164:167], v[212:215], v[96:99]
  v_mfma_f32_16x16x32_bf16 v[100:103], v[168:171], v[200:203], v[100:103]
  v_mfma_f32_16x16x32_bf16 v[104:107], v[168:171], v[204:207], v[104:107]
  v_mfma_f32_16x16x32_bf16 v[108:111], v[168:171], v[208:211], v[108:111]
  v_mfma_f32_16x16x32_bf16 v[112:115], v[168:171], v[212:215], v[112:115]
  s_waitcnt vmcnt(12) lgkmcnt(0)
  s_barrier
  v_mfma_f32_16x16x32_bf16 v[4:7], v[172:175], v[216:219], v[4:7]
  ds_read_b64_tr_b16 v[144:145], v242 offset:0
  v_mfma_f32_16x16x32_bf16 v[8:11], v[172:175], v[220:223], v[8:11]
  ds_read_b64_tr_b16 v[146:147], v242 offset:1792
  v_mfma_f32_16x16x32_bf16 v[12:15], v[172:175], v[224:227], v[12:15]
  ds_read_b128 v[200:203], v240 offset:0
  s_lshl_b32 s51, s46, 8
  s_lshl_b32 s52, s45, 6
  s_add_u32 s51, s51, s52
  s_lshl_b32 s51, s51, 3
  v_mfma_f32_16x16x32_bf16 v[16:19], v[172:175], v[228:231], v[16:19]
  ds_read_b128 v[204:207], v240 offset:2048
  v_lshlrev_b32 v1, 3, v0
  v_mfma_f32_16x16x32_bf16 v[20:23], v[176:179], v[216:219], v[20:23]
  ds_read_b128 v[208:211], v240 offset:4096
  v_mfma_f32_16x16x32_bf16 v[24:27], v[176:179], v[220:223], v[24:27]
  ds_read_b128 v[212:215], v240 offset:6144
  buffer_load_dwordx2 v[244:245], v1, s[16:19], s51 offen offset:0 sc1
  v_mfma_f32_16x16x32_bf16 v[28:31], v[176:179], v[224:227], v[28:31]
  ds_read_b64_tr_b16 v[148:149], v242 offset:32
  v_mfma_f32_16x16x32_bf16 v[32:35], v[176:179], v[228:231], v[32:35]
  ds_read_b64_tr_b16 v[150:151], v242 offset:1824
  v_mfma_f32_16x16x32_bf16 v[36:39], v[180:183], v[216:219], v[36:39]
  ds_read_b64_tr_b16 v[152:153], v242 offset:64
  v_mfma_f32_16x16x32_bf16 v[40:43], v[180:183], v[220:223], v[40:43]
  ds_read_b64_tr_b16 v[154:155], v242 offset:1856
  v_mfma_f32_16x16x32_bf16 v[44:47], v[180:183], v[224:227], v[44:47]
  ds_read_b64_tr_b16 v[156:157], v242 offset:96
  s_mov_b32 m0, s63
  s_mov_b64 exec, s[4:5]
  buffer_load_dwordx4 v238, s[12:15], s61 offen lds
  buffer_load_dwordx4 v239, s[12:15], s61 offen offset:896 lds
  s_mov_b64 exec, -1
  v_mfma_f32_16x16x32_bf16 v[48:51], v[180:183], v[228:231], v[48:51]
  ds_read_b64_tr_b16 v[158:159], v242 offset:1888
  v_mfma_f32_16x16x32_bf16 v[52:55], v[184:187], v[216:219], v[52:55]
  ds_read_b64_tr_b16 v[160:161], v242 offset:128
  v_mfma_f32_16x16x32_bf16 v[56:59], v[184:187], v[220:223], v[56:59]
  ds_read_b64_tr_b16 v[162:163], v242 offset:1920
  v_mfma_f32_16x16x32_bf16 v[60:63], v[184:187], v[224:227], v[60:63]
  ds_read_b64_tr_b16 v[164:165], v242 offset:160
  v_mfma_f32_16x16x32_bf16 v[64:67], v[184:187], v[228:231], v[64:67]
  ds_read_b64_tr_b16 v[166:167], v242 offset:1952
  v_mfma_f32_16x16x32_bf16 v[68:71], v[188:191], v[216:219], v[68:71]
  ds_read_b64_tr_b16 v[168:169], v242 offset:192
  v_mfma_f32_16x16x32_bf16 v[72:75], v[188:191], v[220:223], v[72:75]
  ds_read_b64_tr_b16 v[170:171], v242 offset:1984
  v_mfma_f32_16x16x32_bf16 v[76:79], v[188:191], v[224:227], v[76:79]
  v_mfma_f32_16x16x32_bf16 v[80:83], v[188:191], v[228:231], v[80:83]
  s_sub_u32 s52, s57, s59
  v_add_u32 v240, s52, v240
  v_mfma_f32_16x16x32_bf16 v[84:87], v[192:195], v[216:219], v[84:87]
  v_mfma_f32_16x16x32_bf16 v[88:91], v[192:195], v[220:223], v[88:91]
  v_add_u32 v242, 0x3400, v242
  v_mfma_f32_16x16x32_bf16 v[92:95], v[192:195], v[224:227], v[92:95]
  s_mov_b32 s53, s57
  s_mov_b32 s57, s58
  s_mov_b32 s58, s59
  s_mov_b32 s59, s53
  s_xor_b32 s96, s96, 0xffff5000
  v_mfma_f32_16x16x32_bf16 v[96:99], v[192:195], v[228:231], v[96:99]
  v_mfma_f32_16x16x32_bf16 v[100:103], v[196:199], v[216:219], v[100:103]
  v_mfma_f32_16x16x32_bf16 v[104:107], v[196:199], v[220:223], v[104:107]
  v_mfma_f32_16x16x32_bf16 v[108:111], v[196:199], v[224:227], v[108:111]
  v_mfma_f32_16x16x32_bf16 v[112:115], v[196:199], v[228:231], v[112:115]
  s_waitcnt vmcnt(11) lgkmcnt(0)
  s_barrier
  v_mfma_f32_16x16x32_bf16 v[4:7], v[144:147], v[200:203], v[4:7]
  ds_read_b64_tr_b16 v[172:173], v242 offset:0
  v_mfma_f32_16x16x32_bf16 v[8:11], v[144:147], v[204:207], v[8:11]
  ds_read_b64_tr_b16 v[174:175], v242 offset:1792
  s_lshr_b32 s54, s2, 2
  s_mul_i32 s54, s54, 28672
  s_mul_i32 s55, s49, 1835008
  s_add_u32 s54, s54, s55
  v_mfma_f32_16x16x32_bf16 v[12:15], v[144:147], v[208:211], v[12:15]
  ds_read_b128 v[216:219], v241 offset:0
  s_mul_i32 s55, s44, 3584
  s_add_u32 s54, s54, s55
  v_mfma_f32_16x16x32_bf16 v[16:19], v[144:147], v[212:215], v[16:19]
  ds_read_b128 v[220:223], v241 offset:2048
  v_mfma_f32_16x16x32_bf16 v[20:23], v[148:151], v[200:203], v[20:23]
  ds_read_b128 v[224:227], v241 offset:4096
  v_min_u32 v1, 27, v0
  v_mfma_f32_16x16x32_bf16 v[24:27], v[148:151], v[204:207], v[24:27]
  ds_read_b128 v[228:231], v241 offset:6144
  v_mfma_f32_16x16x32_bf16 v[28:31], v[148:151], v[208:211], v[28:31]
  ds_read_b64_tr_b16 v[176:177], v242 offset:32
  v_lshlrev_b32 v1, 7, v1
  v_mfma_f32_16x16x32_bf16 v[32:35], v[148:151], v[212:215], v[32:35]
  ds_read_b64_tr_b16 v[178:179], v242 offset:1824
  v_mfma_f32_16x16x32_bf16 v[36:39], v[152:155], v[200:203], v[36:39]
  ds_read_b64_tr_b16 v[180:181], v242 offset:64
  buffer_load_dword v255, v1, s[28:31], s54 offen
  v_mfma_f32_16x16x32_bf16 v[40:43], v[152:155], v[204:207], v[40:43]
  ds_read_b64_tr_b16 v[182:183], v242 offset:1856
  v_mfma_f32_16x16x32_bf16 v[44:47], v[152:155], v[208:211], v[44:47]
  ds_read_b64_tr_b16 v[184:185], v242 offset:96
  s_lshl_b32 s55, s2, 3
  s_add_u32 s55, s55, s44
  s_lshl_b32 s55, s55, 10
  v_mfma_f32_16x16x32_bf16 v[48:51], v[152:155], v[212:215], v[48:51]
  ds_read_b64_tr_b16 v[186:187], v242 offset:1888
  v_mfma_f32_16x16x32_bf16 v[52:55], v[156:159], v[200:203], v[52:55]
  ds_read_b64_tr_b16 v[188:189], v242 offset:128
  v_min_u32 v2, 7, v0
  v_mfma_f32_16x16x32_bf16 v[56:59], v[156:159], v[204:207], v[56:59]
  ds_read_b64_tr_b16 v[190:191], v242 offset:1920
  v_mfma_f32_16x16x32_bf16 v[60:63], v[156:159], v[208:211], v[60:63]
  ds_read_b64_tr_b16 v[192:193], v242 offset:160
  v_lshlrev_b32 v2, 7, v2
  v_mfma_f32_16x16x32_bf16 v[64:67], v[156:159], v[212:215], v[64:67]
  ds_read_b64_tr_b16 v[194:195], v242 offset:1952
  v_mfma_f32_16x16x32_bf16 v[68:71], v[160:163], v[200:203], v[68:71]
  ds_read_b64_tr_b16 v[196:197], v242 offset:192
  buffer_load_dword v255, v2, s[32:35], s55 offen
  v_mfma_f32_16x16x32_bf16 v[72:75], v[160:163], v[204:207], v[72:75]
  ds_read_b64_tr_b16 v[198:199], v242 offset:1984
  v_mfma_f32_16x16x32_bf16 v[76:79], v[160:163], v[208:211], v[76:79]
  s_lshl_b32 s54, s44, 8
  v_mfma_f32_16x16x32_bf16 v[80:83], v[160:163], v[212:215], v[80:83]
  s_sub_u32 s52, s59, s58
  v_add_u32 v241, s52, v241
  v_mfma_f32_16x16x32_bf16 v[84:87], v[164:167], v[200:203], v[84:87]
  v_min_u32 v1, 1, v0
  v_mfma_f32_16x16x32_bf16 v[88:91], v[164:167], v[204:207], v[88:91]
  v_add_u32 v242, s96, v242
  v_mfma_f32_16x16x32_bf16 v[92:95], v[164:167], v[208:211], v[92:95]
  v_lshlrev_b32 v1, 7, v1
  v_mfma_f32_16x16x32_bf16 v[96:99], v[164:167], v[212:215], v[96:99]
  v_mfma_f32_16x16x32_bf16 v[100:103], v[168:171], v[200:203], v[100:103]
  buffer_load_dword v255, v1, s[40:43], s54 offen
  v_mfma_f32_16x16x32_bf16 v[104:107], v[168:171], v[204:207], v[104:107]
  v_mfma_f32_16x16x32_bf16 v[108:111], v[168:171], v[208:211], v[108:111]
  v_mfma_f32_16x16x32_bf16 v[112:115], v[168:171], v[212:215], v[112:115]
  s_waitcnt vmcnt(6) lgkmcnt(0)
  s_barrier
  v_mfma_f32_16x16x32_bf16 v[4:7], v[172:175], v[216:219], v[4:7]
  ds_read_b64_tr_b16 v[144:145], v242 offset:0
  v_add_f32 v116, v116, v120
  v_add_f32 v117, v117, v121
  v_mfma_f32_16x16x32_bf16 v[8:11], v[172:175], v[220:223], v[8:11]
  ds_read_b64_tr_b16 v[146:147], v242 offset:1792
  v_add_f32 v118, v118, v122
  v_mfma_f32_16x16x32_bf16 v[12:15], v[172:175], v[224:227], v[12:15]
  ds_read_b128 v[200:203], v240 offset:0
  v_add_f32 v119, v119, v123
  v_mfma_f32_16x16x32_bf16 v[16:19], v[172:175], v[228:231], v[16:19]
  ds_read_b128 v[204:207], v240 offset:2048
  v_add_f32 v124, v124, v128
  v_mfma_f32_16x16x32_bf16 v[20:23], v[176:179], v[216:219], v[20:23]
  ds_read_b128 v[208:211], v240 offset:4096
  v_add_f32 v125, v125, v129
  v_mfma_f32_16x16x32_bf16 v[24:27], v[176:179], v[220:223], v[24:27]
  ds_read_b128 v[212:215], v240 offset:6144
  v_add_f32 v126, v126, v130
  v_mfma_f32_16x16x32_bf16 v[28:31], v[176:179], v[224:227], v[28:31]
  ds_read_b64_tr_b16 v[148:149], v242 offset:32
  v_add_f32 v127, v127, v131
  v_mfma_f32_16x16x32_bf16 v[32:35], v[176:179], v[228:231], v[32:35]
  ds_read_b64_tr_b16 v[150:151], v242 offset:1824
  v_add_f32 v116, v116, v124
  v_mfma_f32_16x16x32_bf16 v[36:39], v[180:183], v[216:219], v[36:39]
  ds_read_b64_tr_b16 v[152:153], v242 offset:64
  v_add_f32 v117, v117, v125
  v_mfma_f32_16x16x32_bf16 v[40:43], v[180:183], v[220:223], v[40:43]
  ds_read_b64_tr_b16 v[154:155], v242 offset:1856
  v_add_f32 v118, v118, v126
  v_add_f32 v119, v119, v127
  v_mfma_f32_16x16x32_bf16 v[44:47], v[180:183], v[224:227], v[44:47]
  ds_read_b64_tr_b16 v[156:157], v242 offset:96
  v_mov_b64 v[120:121], v[116:117]
  v_mfma_f32_16x16x32_bf16 v[48:51], v[180:183], v[228:231], v[48:51]
  ds_read_b64_tr_b16 v[158:159], v242 offset:1888
  v_mov_b64 v[122:123], v[118:119]
  v_mfma_f32_16x16x32_bf16 v[52:55], v[184:187], v[216:219], v[52:55]
  ds_read_b64_tr_b16 v[160:161], v242 offset:128
  v_and_b32 v1, 31, v0
  v_mfma_f32_16x16x32_bf16 v[56:59], v[184:187], v[220:223], v[56:59]
  ds_read_b64_tr_b16 v[162:163], v242 offset:1920
  v_lshlrev_b32 v1, 4, v1
  v_mfma_f32_16x16x32_bf16 v[60:63], v[184:187], v[224:227], v[60:63]
  ds_read_b64_tr_b16 v[164:165], v242 offset:160
  v_add_u32 v1, 157696, v1
  v_mfma_f32_16x16x32_bf16 v[64:67], v[184:187], v[228:231], v[64:67]
  ds_read_b64_tr_b16 v[166:167], v242 offset:1952
  v_permlane32_swap_b32 v116, v120
  v_mfma_f32_16x16x32_bf16 v[68:71], v[188:191], v[216:219], v[68:71]
  ds_read_b64_tr_b16 v[168:169], v242 offset:192
  v_permlane32_swap_b32 v117, v121
  v_mfma_f32_16x16x32_bf16 v[72:75], v[188:191], v[220:223], v[72:75]
  ds_read_b64_tr_b16 v[170:171], v242 offset:1984
  v_permlane32_swap_b32 v118, v122
  v_mfma_f32_16x16x32_bf16 v[76:79], v[188:191], v[224:227], v[76:79]
  v_permlane32_swap_b32 v119, v123
  v_lshlrev_b32 v124, 16, v252
  v_mfma_f32_16x16x32_bf16 v[80:83], v[188:191], v[228:231], v[80:83]
  v_and_b32 v125, 0xffff0000, v252
  v_mfma_f32_16x16x32_bf16 v[84:87], v[192:195], v[216:219], v[84:87]
  v_lshlrev_b32 v126, 16, v253
  v_mfma_f32_16x16x32_bf16 v[88:91], v[192:195], v[220:223], v[88:91]
  v_add_u32 v242, 0x3400, v242
  v_and_b32 v127, 0xffff0000, v253
  v_mfma_f32_16x16x32_bf16 v[92:95], v[192:195], v[224:227], v[92:95]
  v_add_f32 v116, v116, v120
  v_mfma_f32_16x16x32_bf16 v[96:99], v[192:195], v[228:231], v[96:99]
  v_add_f32 v117, v117, v121
  v_mfma_f32_16x16x32_bf16 v[100:103], v[196:199], v[216:219], v[100:103]
  v_add_f32 v118, v118, v122
  v_mfma_f32_16x16x32_bf16 v[104:107], v[196:199], v[220:223], v[104:107]
  v_add_f32 v119, v119, v123
  v_mfma_f32_16x16x32_bf16 v[108:111], v[196:199], v[224:227], v[108:111]
  s_mov_b32 exec_hi, 0
  ds_write_b128 v1, v[124:127] offset:1024
  s_mov_b64 exec, -1
  v_mfma_f32_16x16x32_bf16 v[112:115], v[196:199], v[228:231], v[112:115]
  ds_write_b128 v1, v[116:119] offset:512
  s_waitcnt vmcnt(3) lgkmcnt(0)
  s_barrier
  v_mfma_f32_16x16x32_bf16 v[4:7], v[144:147], v[200:203], v[4:7]
  ds_read_b64_tr_b16 v[172:173], v242 offset:0
  v_mfma_f32_16x16x32_bf16 v[8:11], v[144:147], v[204:207], v[8:11]
  ds_read_b64_tr_b16 v[174:175], v242 offset:1792
  v_mfma_f32_16x16x32_bf16 v[12:15], v[144:147], v[208:211], v[12:15]
  ds_read_b128 v[216:219], v241 offset:0
  v_mfma_f32_16x16x32_bf16 v[16:19], v[144:147], v[212:215], v[16:19]
  ds_read_b128 v[220:223], v241 offset:2048
  v_mfma_f32_16x16x32_bf16 v[20:23], v[148:151], v[200:203], v[20:23]
  ds_read_b128 v[224:227], v241 offset:4096
  v_mfma_f32_16x16x32_bf16 v[24:27], v[148:151], v[204:207], v[24:27]
  ds_read_b128 v[228:231], v241 offset:6144
  v_mfma_f32_16x16x32_bf16 v[28:31], v[148:151], v[208:211], v[28:31]
  ds_read_b64_tr_b16 v[176:177], v242 offset:32
  v_mfma_f32_16x16x32_bf16 v[32:35], v[148:151], v[212:215], v[32:35]
  ds_read_b64_tr_b16 v[178:179], v242 offset:1824
  v_mfma_f32_16x16x32_bf16 v[36:39], v[152:155], v[200:203], v[36:39]
  ds_read_b64_tr_b16 v[180:181], v242 offset:64
  v_mfma_f32_16x16x32_bf16 v[40:43], v[152:155], v[204:207], v[40:43]
  ds_read_b64_tr_b16 v[182:183], v242 offset:1856
  v_mfma_f32_16x16x32_bf16 v[44:47], v[152:155], v[208:211], v[44:47]
  ds_read_b64_tr_b16 v[184:185], v242 offset:96
  v_lshrrev_b32 v2, 4, v0
  v_mfma_f32_16x16x32_bf16 v[48:51], v[152:155], v[212:215], v[48:51]
  ds_read_b64_tr_b16 v[186:187], v242 offset:1888
  v_lshlrev_b32 v2, 4, v2
  v_mfma_f32_16x16x32_bf16 v[52:55], v[156:159], v[200:203], v[52:55]
  ds_read_b64_tr_b16 v[188:189], v242 offset:128
  v_mfma_f32_16x16x32_bf16 v[56:59], v[156:159], v[204:207], v[56:59]
  ds_read_b64_tr_b16 v[190:191], v242 offset:1920
  v_add_u32 v2, 157696, v2
  v_mfma_f32_16x16x32_bf16 v[60:63], v[156:159], v[208:211], v[60:63]
  ds_read_b64_tr_b16 v[192:193], v242 offset:160
  v_mfma_f32_16x16x32_bf16 v[64:67], v[156:159], v[212:215], v[64:67]
  ds_read_b64_tr_b16 v[194:195], v242 offset:1952
  ds_read_b128 v[116:119], v2 offset:512
  v_mfma_f32_16x16x32_bf16 v[68:71], v[160:163], v[200:203], v[68:71]
  ds_read_b64_tr_b16 v[196:197], v242 offset:192
  v_mfma_f32_16x16x32_bf16 v[72:75], v[160:163], v[204:207], v[72:75]
  ds_read_b64_tr_b16 v[198:199], v242 offset:1984
  ds_read_b128 v[120:123], v2 offset:576
  v_mfma_f32_16x16x32_bf16 v[76:79], v[160:163], v[208:211], v[76:79]
  v_mfma_f32_16x16x32_bf16 v[80:83], v[160:163], v[212:215], v[80:83]
  ds_read_b128 v[124:127], v2 offset:640
  v_mfma_f32_16x16x32_bf16 v[84:87], v[164:167], v[200:203], v[84:87]
  ds_read_b128 v[128:131], v2 offset:704
  v_mfma_f32_16x16x32_bf16 v[88:91], v[164:167], v[204:207], v[88:91]
  v_mfma_f32_16x16x32_bf16 v[92:95], v[164:167], v[208:211], v[92:95]
  ds_read_b128 v[132:135], v2 offset:768
  v_mfma_f32_16x16x32_bf16 v[96:99], v[164:167], v[212:215], v[96:99]
  v_mfma_f32_16x16x32_bf16 v[100:103], v[168:171], v[200:203], v[100:103]
  ds_read_b128 v[136:139], v2 offset:832
  v_mfma_f32_16x16x32_bf16 v[104:107], v[168:171], v[204:207], v[104:107]
  v_mfma_f32_16x16x32_bf16 v[108:111], v[168:171], v[208:211], v[108:111]
  ds_read_b128 v[140:143], v2 offset:896
  v_mfma_f32_16x16x32_bf16 v[112:115], v[168:171], v[212:215], v[112:115]
  s_waitcnt vmcnt(5) lgkmcnt(0)
  v_mfma_f32_16x16x32_bf16 v[4:7], v[172:175], v[216:219], v[4:7]
  v_mov_b32 v1, v245
  v_mfma_f32_16x16x32_bf16 v[8:11], v[172:175], v[220:223], v[8:11]
  v_mfma_f32_16x16x32_bf16 v[12:15], v[172:175], v[224:227], v[12:15]
  v_mov_b32 v246, v244
  v_mfma_f32_16x16x32_bf16 v[16:19], v[172:175], v[228:231], v[16:19]
  v_mfma_f32_16x16x32_bf16 v[20:23], v[176:179], v[216:219], v[20:23]
  v_permlane16_swap_b32 v244, v246
  v_mfma_f32_16x16x32_bf16 v[24:27], v[176:179], v[220:223], v[24:27]
  v_mfma_f32_16x16x32_bf16 v[28:31], v[176:179], v[224:227], v[28:31]
  v_mov_b32 v248, v244
  v_mfma_f32_16x16x32_bf16 v[32:35], v[176:179], v[228:231], v[32:35]
  v_mfma_f32_16x16x32_bf16 v[36:39], v[180:183], v[216:219], v[36:39]
  v_mov_b32 v250, v246
  v_mfma_f32_16x16x32_bf16 v[40:43], v[180:183], v[220:223], v[40:43]
  v_mfma_f32_16x16x32_bf16 v[44:47], v[180:183], v[224:227], v[44:47]
  v_permlane32_swap_b32 v244, v248
  v_mfma_f32_16x16x32_bf16 v[48:51], v[180:183], v[228:231], v[48:51]
  v_mfma_f32_16x16x32_bf16 v[52:55], v[184:187], v[216:219], v[52:55]
  v_permlane32_swap_b32 v246, v250
  v_mfma_f32_16x16x32_bf16 v[56:59], v[184:187], v[220:223], v[56:59]
  v_mfma_f32_16x16x32_bf16 v[60:63], v[184:187], v[224:227], v[60:63]
  v_mov_b32 v245, v1
  v_mfma_f32_16x16x32_bf16 v[64:67], v[184:187], v[228:231], v[64:67]
  v_mfma_f32_16x16x32_bf16 v[68:71], v[188:191], v[216:219], v[68:71]
  v_mov_b32 v247, v245
  v_mfma_f32_16x16x32_bf16 v[72:75], v[188:191], v[220:223], v[72:75]
  v_mfma_f32_16x16x32_bf16 v[76:79], v[188:191], v[224:227], v[76:79]
  v_permlane16_swap_b32 v245, v247
  v_mfma_f32_16x16x32_bf16 v[80:83], v[188:191], v[228:231], v[80:83]
  v_mfma_f32_16x16x32_bf16 v[84:87], v[192:195], v[216:219], v[84:87]
  v_mov_b32 v249, v245
  v_mfma_f32_16x16x32_bf16 v[88:91], v[192:195], v[220:223], v[88:91]
  v_mfma_f32_16x16x32_bf16 v[92:95], v[192:195], v[224:227], v[92:95]
  v_mov_b32 v251, v247
  v_mfma_f32_16x16x32_bf16 v[96:99], v[192:195], v[228:231], v[96:99]
  v_mfma_f32_16x16x32_bf16 v[100:103], v[196:199], v[216:219], v[100:103]
  v_permlane32_swap_b32 v245, v249
  v_mfma_f32_16x16x32_bf16 v[104:107], v[196:199], v[220:223], v[104:107]
  v_mfma_f32_16x16x32_bf16 v[108:111], v[196:199], v[224:227], v[108:111]
  v_permlane32_swap_b32 v247, v251
  v_mfma_f32_16x16x32_bf16 v[112:115], v[196:199], v[228:231], v[112:115]
  s_waitcnt lgkmcnt(0)
  s_barrier
L_epi_B:
  s_setprio 2
  v_mov_b32 v172, v245
  v_mov_b32 v174, v247
  v_mov_b32 v176, v249
  v_mov_b32 v178, v251
  v_lshrrev_b32 v1, 4, v0
  v_lshlrev_b32 v2, 4, v1
  v_add_u32 v2, 158720, v2
  ds_read_b128 v[144:147], v2 offset:0
  ds_read_b128 v[148:151], v2 offset:64
  ds_read_b128 v[152:155], v2 offset:128
  ds_read_b128 v[156:159], v2 offset:192
  ds_read_b128 v[160:163], v2 offset:256
  ds_read_b128 v[164:167], v2 offset:320
  ds_read_b128 v[168:171], v2 offset:384
  v_and_b32 v232, 15, v0
  v_lshlrev_b32 v233, 1, v1
  v_xor_b32 v233, v233, v232
  s_lshl_b32 s52, s45, 3
  v_add_u32 v234, s52, v1
  v_lshlrev_b32 v234, 11, v234
  v_lshl_add_u32 v234, v233, 4, v234
  s_lshl_b32 s53, s48, 8
  v_add_u32 v234, s53, v234
  v_xor_b32 v235, 0x80, v234
  v_add_u32 v235, 7168, v235
  s_lshr_b32 s51, s48, 1
  s_mul_i32 s51, s51, 7
  s_and_b32 s52, s48, 1
  s_lshl_b32 s52, s52, 2
  s_add_u32 s51, s51, s52
  s_lshl_b32 s51, s51, 16
  s_mul_i32 s52, s49, 1835008
  s_add_u32 s52, s52, s51
  s_lshl_b32 s53, s45, 11
  s_add_u32 m0, s53, 16384
  s_nop 0
  buffer_load_dwordx4 v234, s[28:31], s52 offen sc1 lds
  buffer_load_dwordx4 v235, s[28:31], s52 offen offset:1024 sc1 lds
  s_add_u32 s52, s52, 65536
  s_add_u32 m0, s53, 40960
  s_nop 0
  buffer_load_dwordx4 v234, s[28:31], s52 offen sc1 lds
  buffer_load_dwordx4 v235, s[28:31], s52 offen offset:1024 sc1 lds
  s_add_u32 s52, s52, 65536
  s_add_u32 m0, s53, 65536
  s_nop 0
  buffer_load_dwordx4 v234, s[28:31], s52 offen sc1 lds
  buffer_load_dwordx4 v235, s[28:31], s52 offen offset:1024 sc1 lds
  s_mul_i32 s51, s46, 112
  s_lshr_b32 s52, s50, 1
  s_mul_i32 s52, s52, 7
  s_add_u32 s51, s51, s52
  s_lshl_b32 s51, s51, 2
  s_add_u32 s51, s51, s45
  s_lshl_b32 s51, s51, 12
  s_add_u32 s51, s51, 0x400000
  s_add_u32 s52, s51, 49152
  s_and_b32 s53, s50, 1
  s_lshl_b32 s54, s53, 16
  s_add_u32 s51, s51, s54
  v_lshlrev_b32 v2, 4, v0
  s_lshl_b32 s53, s53, 3
  v_add_u32 v3, s53, v2
  s_lshl_b32 s53, s45, 12
  v_add_u32 v232, s53, v2
  v_pk_fma_f32 v[4:5], v[116:117], v[244:245], v[4:5] op_sel:[0,0,0] op_sel_hi:[1,0,1] neg_lo:[0,1,0] neg_hi:[0,1,0]
  v_pk_fma_f32 v[6:7], v[118:119], v[244:245], v[6:7] op_sel:[0,0,0] op_sel_hi:[1,0,1] neg_lo:[0,1,0] neg_hi:[0,1,0]
  v_pk_fma_f32 v[20:21], v[120:121], v[244:245], v[20:21] op_sel:[0,0,0] op_sel_hi:[1,0,1] neg_lo:[0,1,0] neg_hi:[0,1,0]
  v_pk_fma_f32 v[22:23], v[122:123], v[244:245], v[22:23] op_sel:[0,0,0] op_sel_hi:[1,0,1] neg_lo:[0,1,0] neg_hi:[0,1,0]
  s_waitcnt lgkmcnt(0)
  v_pk_fma_f32 v[4:5], v[4:5], v[172:173], v[144:145] op_sel:[0,0,0] op_sel_hi:[1,0,1]
  v_pk_fma_f32 v[6:7], v[6:7], v[172:173], v[146:147] op_sel:[0,0,0] op_sel_hi:[1,0,1]
  v_pk_fma_f32 v[20:21], v[20:21], v[172:173], v[148:149] op_sel:[0,0,0] op_sel_hi:[1,0,1]
  v_pk_fma_f32 v[22:23], v[22:23], v[172:173], v[150:151] op_sel:[0,0,0] op_sel_hi:[1,0,1]
  v_max_f32 v4, 0, v4
  v_max_f32 v5, 0, v5
  v_max_f32 v6, 0, v6
  v_max_f32 v7, 0, v7
  v_max_f32 v20, 0, v20
  v_max_f32 v21, 0, v21
  v_max_f32 v22, 0, v22
  v_max_f32 v23, 0, v23
  v_pk_mul_f32 v[4:5], v[4:5], v[4:5]
  v_pk_mul_f32 v[6:7], v[6:7], v[6:7]
  v_pk_mul_f32 v[20:21], v[20:21], v[20:21]
  v_pk_mul_f32 v[22:23], v[22:23], v[22:23]
  v_cvt_pk_bf16_f32 v200, v4, v5
  v_cvt_pk_bf16_f32 v201, v6, v7
  v_cvt_pk_bf16_f32 v202, v20, v21
  v_cvt_pk_bf16_f32 v203, v22, v23
  buffer_store_dwordx4 v[200:203], v2, s[16:19], s51 offen offset:0 sc1
  ds_write_b128 v232, v[200:203] offset:0
  v_pk_fma_f32 v[8:9], v[116:117], v[246:247], v[8:9] op_sel:[0,0,0] op_sel_hi:[1,0,1] neg_lo:[0,1,0] neg_hi:[0,1,0]
  v_pk_fma_f32 v[10:11], v[118:119], v[246:247], v[10:11] op_sel:[0,0,0] op_sel_hi:[1,0,1] neg_lo:[0,1,0] neg_hi:[0,1,0]
  v_pk_fma_f32 v[24:25], v[120:121], v[246:247], v[24:25] op_sel:[0,0,0] op_sel_hi:[1,0,1] neg_lo:[0,1,0] neg_hi:[0,1,0]
  v_pk_fma_f32 v[26:27], v[122:123], v[246:247], v[26:27] op_sel:[0,0,0] op_sel_hi:[1,0,1] neg_lo:[0,1,0] neg_hi:[0,1,0]
  v_pk_fma_f32 v[8:9], v[8:9], v[174:175], v[144:145] op_sel:[0,0,0] op_sel_hi:[1,0,1]
  v_pk_fma_f32 v[10:11], v[10:11], v[174:175], v[146:147] op_sel:[0,0,0] op_sel_hi:[1,0,1]
  v_pk_fma_f32 v[24:25], v[24:25], v[174:175], v[148:149] op_sel:[0,0,0] op_sel_hi:[1,0,1]
  v_pk_fma_f32 v[26:27], v[26:27], v[174:175], v[150:151] op_sel:[0,0,0] op_sel_hi:[1,0,1]
  v_max_f32 v8, 0, v8
  v_max_f32 v9, 0, v9
  v_max_f32 v10, 0, v10
  v_max_f32 v11, 0, v11
  v_max_f32 v24, 0, v24
  v_max_f32 v25, 0, v25
  v_max_f32 v26, 0, v26
  v_max_f32 v27, 0, v27
  v_pk_mul_f32 v[8:9], v[8:9], v[8:9]
  v_pk_mul_f32 v[10:11], v[10:11], v[10:11]
  v_pk_mul_f32 v[24:25], v[24:25], v[24:25]
  v_pk_mul_f32 v[26:27], v[26:27], v[26:27]
  v_cvt_pk_bf16_f32 v204, v8, v9
  v_cvt_pk_bf16_f32 v205, v10, v11
  v_cvt_pk_bf16_f32 v206, v24, v25
  v_cvt_pk_bf16_f32 v207, v26, v27
  buffer_store_dwordx4 v[204:207], v2, s[16:19], s51 offen offset:1024 sc1
  ds_write_b128 v232, v[204:207] offset:1024
  v_pk_fma_f32 v[12:13], v[116:117], v[248:249], v[12:13] op_sel:[0,0,0] op_sel_hi:[1,0,1] neg_lo:[0,1,0] neg_hi:[0,1,0]
  v_pk_fma_f32 v[14:15], v[118:119], v[248:249], v[14:15] op_sel:[0,0,0] op_sel_hi:[1,0,1] neg_lo:[0,1,0] neg_hi:[0,1,0]
  v_pk_fma_f32 v[28:29], v[120:121], v[248:249], v[28:29] op_sel:[0,0,0] op_sel_hi:[1,0,1] neg_lo:[0,1,0] neg_hi:[0,1,0]
  v_pk_fma_f32 v[30:31], v[122:123], v[248:249], v[30:31] op_sel:[0,0,0] op_sel_hi:[1,0,1] neg_lo:[0,1,0] neg_hi:[0,1,0]
  v_pk_fma_f32 v[12:13], v[12:13], v[176:177], v[144:145] op_sel:[0,0,0] op_sel_hi:[1,0,1]
  v_pk_fma_f32 v[14:15], v[14:15], v[176:177], v[146:147] op_sel:[0,0,0] op_sel_hi:[1,0,1]
  v_pk_fma_f32 v[28:29], v[28:29], v[176:177], v[148:149] op_sel:[0,0,0] op_sel_hi:[1,0,1]
  v_pk_fma_f32 v[30:31], v[30:31], v[176:177], v[150:151] op_sel:[0,0,0] op_sel_hi:[1,0,1]
  v_max_f32 v12, 0, v12
  v_max_f32 v13, 0, v13
  v_max_f32 v14, 0, v14
  v_max_f32 v15, 0, v15
  v_max_f32 v28, 0, v28
  v_max_f32 v29, 0, v29
  v_max_f32 v30, 0, v30
  v_max_f32 v31, 0, v31
  v_pk_mul_f32 v[12:13], v[12:13], v[12:13]
  v_pk_mul_f32 v[14:15], v[14:15], v[14:15]
  v_pk_mul_f32 v[28:29], v[28:29], v[28:29]
  v_pk_mul_f32 v[30:31], v[30:31], v[30:31]
  v_cvt_pk_bf16_f32 v208, v12, v13
  v_cvt_pk_bf16_f32 v209, v14, v15
  v_cvt_pk_bf16_f32 v210, v28, v29
  v_cvt_pk_bf16_f32 v211, v30, v31
  buffer_store_dwordx4 v[208:211], v2, s[16:19], s51 offen offset:2048 sc1
  ds_write_b128 v232, v[208:211] offset:2048
  v_pk_fma_f32 v[16:17], v[116:117], v[250:251], v[16:17] op_sel:[0,0,0] op_sel_hi:[1,0,1] neg_lo:[0,1,0] neg_hi:[0,1,0]
  v_pk_fma_f32 v[18:19], v[118:119], v[250:251], v[18:19] op_sel:[0,0,0] op_sel_hi:[1,0,1] neg_lo:[0,1,0] neg_hi:[0,1,0]
  v_pk_fma_f32 v[32:33], v[120:121], v[250:251], v[32:33] op_sel:[0,0,0] op_sel_hi:[1,0,1] neg_lo:[0,1,0] neg_hi:[0,1,0]
  v_pk_fma_f32 v[34:35], v[122:123], v[250:251], v[34:35] op_sel:[0,0,0] op_sel_hi:[1,0,1] neg_lo:[0,1,0] neg_hi:[0,1,0]
  v_pk_fma_f32 v[16:17], v[16:17], v[178:179], v[144:145] op_sel:[0,0,0] op_sel_hi:[1,0,1]
  v_pk_fma_f32 v[18:19], v[18:19], v[178:179], v[146:147] op_sel:[0,0,0] op_sel_hi:[1,0,1]
  v_pk_fma_f32 v[32:33], v[32:33], v[178:179], v[148:149] op_sel:[0,0,0] op_sel_hi:[1,0,1]
  v_pk_fma_f32 v[34:35], v[34:35], v[178:179], v[150:151] op_sel:[0,0,0] op_sel_hi:[1,0,1]
  v_max_f32 v16, 0, v16
  v_max_f32 v17, 0, v17
  v_max_f32 v18, 0, v18
  v_max_f32 v19, 0, v19
  v_max_f32 v32, 0, v32
  v_max_f32 v33, 0, v33
  v_max_f32 v34, 0, v34
  v_max_f32 v35, 0, v35
  v_pk_mul_f32 v[16:17], v[16:17], v[16:17]
  v_pk_mul_f32 v[18:19], v[18:19], v[18:19]
  v_pk_mul_f32 v[32:33], v[32:33], v[32:33]
  v_pk_mul_f32 v[34:35], v[34:35], v[34:35]
  v_cvt_pk_bf16_f32 v212, v16, v17
  v_cvt_pk_bf16_f32 v213, v18, v19
  v_cvt_pk_bf16_f32 v214, v32, v33
  v_cvt_pk_bf16_f32 v215, v34, v35
  buffer_store_dwordx4 v[212:215], v2, s[16:19], s51 offen offset:3072 sc1
  ds_write_b128 v232, v[212:215] offset:3072
  s_add_u32 s51, s51, 16384
  v_pk_fma_f32 v[36:37], v[124:125], v[244:245], v[36:37] op_sel:[0,0,0] op_sel_hi:[1,0,1] neg_lo:[0,1,0] neg_hi:[0,1,0]
  v_pk_fma_f32 v[38:39], v[126:127], v[244:245], v[38:39] op_sel:[0,0,0] op_sel_hi:[1,0,1] neg_lo:[0,1,0] neg_hi:[0,1,0]
  v_pk_fma_f32 v[52:53], v[128:129], v[244:245], v[52:53] op_sel:[0,0,0] op_sel_hi:[1,0,1] neg_lo:[0,1,0] neg_hi:[0,1,0]
  v_pk_fma_f32 v[54:55], v[130:131], v[244:245], v[54:55] op_sel:[0,0,0] op_sel_hi:[1,0,1] neg_lo:[0,1,0] neg_hi:[0,1,0]
  v_pk_fma_f32 v[36:37], v[36:37], v[172:173], v[152:153] op_sel:[0,0,0] op_sel_hi:[1,0,1]
  v_pk_fma_f32 v[38:39], v[38:39], v[172:173], v[154:155] op_sel:[0,0,0] op_sel_hi:[1,0,1]
  v_pk_fma_f32 v[52:53], v[52:53], v[172:173], v[156:157] op_sel:[0,0,0] op_sel_hi:[1,0,1]
  v_pk_fma_f32 v[54:55], v[54:55], v[172:173], v[158:159] op_sel:[0,0,0] op_sel_hi:[1,0,1]
  v_max_f32 v36, 0, v36
  v_max_f32 v37, 0, v37
  v_max_f32 v38, 0, v38
  v_max_f32 v39, 0, v39
  v_max_f32 v52, 0, v52
  v_max_f32 v53, 0, v53
  v_max_f32 v54, 0, v54
  v_max_f32 v55, 0, v55
  v_pk_mul_f32 v[36:37], v[36:37], v[36:37]
  v_pk_mul_f32 v[38:39], v[38:39], v[38:39]
  v_pk_mul_f32 v[52:53], v[52:53], v[52:53]
  v_pk_mul_f32 v[54:55], v[54:55], v[54:55]
  v_cvt_pk_bf16_f32 v216, v36, v37
  v_cvt_pk_bf16_f32 v217, v38, v39
  v_cvt_pk_bf16_f32 v218, v52, v53
  v_cvt_pk_bf16_f32 v219, v54, v55
  buffer_store_dwordx4 v[216:219], v2, s[16:19], s51 offen offset:0 sc1
  ds_write_b128 v232, v[216:219] offset:24576
  v_pk_fma_f32 v[40:41], v[124:125], v[246:247], v[40:41] op_sel:[0,0,0] op_sel_hi:[1,0,1] neg_lo:[0,1,0] neg_hi:[0,1,0]
  v_pk_fma_f32 v[42:43], v[126:127], v[246:247], v[42:43] op_sel:[0,0,0] op_sel_hi:[1,0,1] neg_lo:[0,1,0] neg_hi:[0,1,0]
  v_pk_fma_f32 v[56:57], v[128:129], v[246:247], v[56:57] op_sel:[0,0,0] op_sel_hi:[1,0,1] neg_lo:[0,1,0] neg_hi:[0,1,0]
  v_pk_fma_f32 v[58:59], v[130:131], v[246:247], v[58:59] op_sel:[0,0,0] op_sel_hi:[1,0,1] neg_lo:[0,1,0] neg_hi:[0,1,0]
  v_pk_fma_f32 v[40:41], v[40:41], v[174:175], v[152:153] op_sel:[0,0,0] op_sel_hi:[1,0,1]
  v_pk_fma_f32 v[42:43], v[42:43], v[174:175], v[154:155] op_sel:[0,0,0] op_sel_hi:[1,0,1]
  v_pk_fma_f32 v[56:57], v[56:57], v[174:175], v[156:157] op_sel:[0,0,0] op_sel_hi:[1,0,1]
  v_pk_fma_f32 v[58:59], v[58:59], v[174:175], v[158:159] op_sel:[0,0,0] op_sel_hi:[1,0,1]
  v_max_f32 v40, 0, v40
  v_max_f32 v41, 0, v41
  v_max_f32 v42, 0, v42
  v_max_f32 v43, 0, v43
  v_max_f32 v56, 0, v56
  v_max_f32 v57, 0, v57
  v_max_f32 v58, 0, v58
  v_max_f32 v59, 0, v59
  v_pk_mul_f32 v[40:41], v[40:41], v[40:41]
  v_pk_mul_f32 v[42:43], v[42:43], v[42:43]
  v_pk_mul_f32 v[56:57], v[56:57], v[56:57]
  v_pk_mul_f32 v[58:59], v[58:59], v[58:59]
  v_cvt_pk_bf16_f32 v220, v40, v41
  v_cvt_pk_bf16_f32 v221, v42, v43
  v_cvt_pk_bf16_f32 v222, v56, v57
  v_cvt_pk_bf16_f32 v223, v58, v59
  buffer_store_dwordx4 v[220:223], v2, s[16:19], s51 offen offset:1024 sc1
  ds_write_b128 v232, v[220:223] offset:25600
  v_pk_fma_f32 v[44:45], v[124:125], v[248:249], v[44:45] op_sel:[0,0,0] op_sel_hi:[1,0,1] neg_lo:[0,1,0] neg_hi:[0,1,0]
  v_pk_fma_f32 v[46:47], v[126:127], v[248:249], v[46:47] op_sel:[0,0,0] op_sel_hi:[1,0,1] neg_lo:[0,1,0] neg_hi:[0,1,0]
  v_pk_fma_f32 v[60:61], v[128:129], v[248:249], v[60:61] op_sel:[0,0,0] op_sel_hi:[1,0,1] neg_lo:[0,1,0] neg_hi:[0,1,0]
  v_pk_fma_f32 v[62:63], v[130:131], v[248:249], v[62:63] op_sel:[0,0,0] op_sel_hi:[1,0,1] neg_lo:[0,1,0] neg_hi:[0,1,0]
  v_pk_fma_f32 v[44:45], v[44:45], v[176:177], v[152:153] op_sel:[0,0,0] op_sel_hi:[1,0,1]
  v_pk_fma_f32 v[46:47], v[46:47], v[176:177], v[154:155] op_sel:[0,0,0] op_sel_hi:[1,0,1]
  v_pk_fma_f32 v[60:61], v[60:61], v[176:177], v[156:157] op_sel:[0,0,0] op_sel_hi:[1,0,1]
  v_pk_fma_f32 v[62:63], v[62:63], v[176:177], v[158:159] op_sel:[0,0,0] op_sel_hi:[1,0,1]
  v_max_f32 v44, 0, v44
  v_max_f32 v45, 0, v45
  v_max_f32 v46, 0, v46
  v_max_f32 v47, 0, v47
  v_max_f32 v60, 0, v60
  v_max_f32 v61, 0, v61
  v_max_f32 v62, 0, v62
  v_max_f32 v63, 0, v63
  v_pk_mul_f32 v[44:45], v[44:45], v[44:45]
  v_pk_mul_f32 v[46:47], v[46:47], v[46:47]
  v_pk_mul_f32 v[60:61], v[60:61], v[60:61]
  v_pk_mul_f32 v[62:63], v[62:63], v[62:63]
  s_branch L_tover_3
L_touch_3:
  s_branch L_tret_B0
L_tover_3:
  v_cvt_pk_bf16_f32 v224, v44, v45
  v_cvt_pk_bf16_f32 v225, v46, v47
  v_cvt_pk_bf16_f32 v226, v60, v61
  v_cvt_pk_bf16_f32 v227, v62, v63
  buffer_store_dwordx4 v[224:227], v2, s[16:19], s51 offen offset:2048 sc1
  ds_write_b128 v232, v[224:227] offset:26624
  v_pk_fma_f32 v[48:49], v[124:125], v[250:251], v[48:49] op_sel:[0,0,0] op_sel_hi:[1,0,1] neg_lo:[0,1,0] neg_hi:[0,1,0]
  v_pk_fma_f32 v[50:51], v[126:127], v[250:251], v[50:51] op_sel:[0,0,0] op_sel_hi:[1,0,1] neg_lo:[0,1,0] neg_hi:[0,1,0]
  v_pk_fma_f32 v[64:65], v[128:129], v[250:251], v[64:65] op_sel:[0,0,0] op_sel_hi:[1,0,1] neg_lo:[0,1,0] neg_hi:[0,1,0]
  v_pk_fma_f32 v[66:67], v[130:131], v[250:251], v[66:67] op_sel:[0,0,0] op_sel_hi:[1,0,1] neg_lo:[0,1,0] neg_hi:[0,1,0]
  v_pk_fma_f32 v[48:49], v[48:49], v[178:179], v[152:153] op_sel:[0,0,0] op_sel_hi:[1,0,1]
  v_pk_fma_f32 v[50:51], v[50:51], v[178:179], v[154:155] op_sel:[0,0,0] op_sel_hi:[1,0,1]
  v_pk_fma_f32 v[64:65], v[64:65], v[178:179], v[156:157] op_sel:[0,0,0] op_sel_hi:[1,0,1]
  v_pk_fma_f32 v[66:67], v[66:67], v[178:179], v[158:159] op_sel:[0,0,0] op_sel_hi:[1,0,1]
  v_max_f32 v48, 0, v48
  v_max_f32 v49, 0, v49
  v_max_f32 v50, 0, v50
  v_max_f32 v51, 0, v51
  v_max_f32 v64, 0, v64
  v_max_f32 v65, 0, v65
  v_max_f32 v66, 0, v66
  v_max_f32 v67, 0, v67
  v_pk_mul_f32 v[48:49], v[48:49], v[48:49]
  v_pk_mul_f32 v[50:51], v[50:51], v[50:51]
  v_pk_mul_f32 v[64:65], v[64:65], v[64:65]
  v_pk_mul_f32 v[66:67], v[66:67], v[66:67]
  v_cvt_pk_bf16_f32 v228, v48, v49
  v_cvt_pk_bf16_f32 v229, v50, v51
  v_cvt_pk_bf16_f32 v230, v64, v65
  v_cvt_pk_bf16_f32 v231, v66, v67
  buffer_store_dwordx4 v[228:231], v2, s[16:19], s51 offen offset:3072 sc1
  ds_write_b128 v232, v[228:231] offset:27648
  s_add_u32 s51, s51, 16384
  v_pk_fma_f32 v[68:69], v[132:133], v[244:245], v[68:69] op_sel:[0,0,0] op_sel_hi:[1,0,1] neg_lo:[0,1,0] neg_hi:[0,1,0]
  v_pk_fma_f32 v[70:71], v[134:135], v[244:245], v[70:71] op_sel:[0,0,0] op_sel_hi:[1,0,1] neg_lo:[0,1,0] neg_hi:[0,1,0]
  v_pk_fma_f32 v[84:85], v[136:137], v[244:245], v[84:85] op_sel:[0,0,0] op_sel_hi:[1,0,1] neg_lo:[0,1,0] neg_hi:[0,1,0]
  v_pk_fma_f32 v[86:87], v[138:139], v[244:245], v[86:87] op_sel:[0,0,0] op_sel_hi:[1,0,1] neg_lo:[0,1,0] neg_hi:[0,1,0]
  v_pk_fma_f32 v[68:69], v[68:69], v[172:173], v[160:161] op_sel:[0,0,0] op_sel_hi:[1,0,1]
  v_pk_fma_f32 v[70:71], v[70:71], v[172:173], v[162:163] op_sel:[0,0,0] op_sel_hi:[1,0,1]
  v_pk_fma_f32 v[84:85], v[84:85], v[172:173], v[164:165] op_sel:[0,0,0] op_sel_hi:[1,0,1]
  v_pk_fma_f32 v[86:87], v[86:87], v[172:173], v[166:167] op_sel:[0,0,0] op_sel_hi:[1,0,1]
  v_max_f32 v68, 0, v68
  v_max_f32 v69, 0, v69
  v_max_f32 v70, 0, v70
  v_max_f32 v71, 0, v71
  v_max_f32 v84, 0, v84
  v_max_f32 v85, 0, v85
  v_max_f32 v86, 0, v86
  v_max_f32 v87, 0, v87
  v_pk_mul_f32 v[68:69], v[68:69], v[68:69]
  v_pk_mul_f32 v[70:71], v[70:71], v[70:71]
  v_pk_mul_f32 v[84:85], v[84:85], v[84:85]
  v_pk_mul_f32 v[86:87], v[86:87], v[86:87]
  v_cvt_pk_bf16_f32 v200, v68, v69
  v_cvt_pk_bf16_f32 v201, v70, v71
  v_cvt_pk_bf16_f32 v202, v84, v85
  v_cvt_pk_bf16_f32 v203, v86, v87
  buffer_store_dwordx4 v[200:203], v2, s[16:19], s51 offen offset:0 sc1
  ds_write_b128 v232, v[200:203] offset:49152
  v_pk_fma_f32 v[72:73], v[132:133], v[246:247], v[72:73] op_sel:[0,0,0] op_sel_hi:[1,0,1] neg_lo:[0,1,0] neg_hi:[0,1,0]
  v_pk_fma_f32 v[74:75], v[134:135], v[246:247], v[74:75] op_sel:[0,0,0] op_sel_hi:[1,0,1] neg_lo:[0,1,0] neg_hi:[0,1,0]
  v_pk_fma_f32 v[88:89], v[136:137], v[246:247], v[88:89] op_sel:[0,0,0] op_sel_hi:[1,0,1] neg_lo:[0,1,0] neg_hi:[0,1,0]
  v_pk_fma_f32 v[90:91], v[138:139], v[246:247], v[90:91] op_sel:[0,0,0] op_sel_hi:[1,0,1] neg_lo:[0,1,0] neg_hi:[0,1,0]
  v_pk_fma_f32 v[72:73], v[72:73], v[174:175], v[160:161] op_sel:[0,0,0] op_sel_hi:[1,0,1]
  v_pk_fma_f32 v[74:75], v[74:75], v[174:175], v[162:163] op_sel:[0,0,0] op_sel_hi:[1,0,1]
  v_pk_fma_f32 v[88:89], v[88:89], v[174:175], v[164:165] op_sel:[0,0,0] op_sel_hi:[1,0,1]
  v_pk_fma_f32 v[90:91], v[90:91], v[174:175], v[166:167] op_sel:[0,0,0] op_sel_hi:[1,0,1]
  v_max_f32 v72, 0, v72
  v_max_f32 v73, 0, v73
  v_max_f32 v74, 0, v74
  v_max_f32 v75, 0, v75
  v_max_f32 v88, 0, v88
  v_max_f32 v89, 0, v89
  v_max_f32 v90, 0, v90
  v_max_f32 v91, 0, v91
  v_pk_mul_f32 v[72:73], v[72:73], v[72:73]
  v_pk_mul_f32 v[74:75], v[74:75], v[74:75]
  v_pk_mul_f32 v[88:89], v[88:89], v[88:89]
  v_pk_mul_f32 v[90:91], v[90:91], v[90:91]
  v_cvt_pk_bf16_f32 v204, v72, v73
  v_cvt_pk_bf16_f32 v205, v74, v75
  v_cvt_pk_bf16_f32 v206, v88, v89
  v_cvt_pk_bf16_f32 v207, v90, v91
  buffer_store_dwordx4 v[204:207], v2, s[16:19], s51 offen offset:1024 sc1
  ds_write_b128 v232, v[204:207] offset:50176
  v_pk_fma_f32 v[76:77], v[132:133], v[248:249], v[76:77] op_sel:[0,0,0] op_sel_hi:[1,0,1] neg_lo:[0,1,0] neg_hi:[0,1,0]
  v_pk_fma_f32 v[78:79], v[134:135], v[248:249], v[78:79] op_sel:[0,0,0] op_sel_hi:[1,0,1] neg_lo:[0,1,0] neg_hi:[0,1,0]
  v_pk_fma_f32 v[92:93], v[136:137], v[248:249], v[92:93] op_sel:[0,0,0] op_sel_hi:[1,0,1] neg_lo:[0,1,0] neg_hi:[0,1,0]
  v_pk_fma_f32 v[94:95], v[138:139], v[248:249], v[94:95] op_sel:[0,0,0] op_sel_hi:[1,0,1] neg_lo:[0,1,0] neg_hi:[0,1,0]
  v_pk_fma_f32 v[76:77], v[76:77], v[176:177], v[160:161] op_sel:[0,0,0] op_sel_hi:[1,0,1]
  v_pk_fma_f32 v[78:79], v[78:79], v[176:177], v[162:163] op_sel:[0,0,0] op_sel_hi:[1,0,1]
  v_pk_fma_f32 v[92:93], v[92:93], v[176:177], v[164:165] op_sel:[0,0,0] op_sel_hi:[1,0,1]
  v_pk_fma_f32 v[94:95], v[94:95], v[176:177], v[166:167] op_sel:[0,0,0] op_sel_hi:[1,0,1]
  v_max_f32 v76, 0, v76
  v_max_f32 v77, 0, v77
  v_max_f32 v78, 0, v78
  v_max_f32 v79, 0, v79
  v_max_f32 v92, 0, v92
  v_max_f32 v93, 0, v93
  v_max_f32 v94, 0, v94
  v_max_f32 v95, 0, v95
  v_pk_mul_f32 v[76:77], v[76:77], v[76:77]
  v_pk_mul_f32 v[78:79], v[78:79], v[78:79]
  v_pk_mul_f32 v[92:93], v[92:93], v[92:93]
  v_pk_mul_f32 v[94:95], v[94:95], v[94:95]
  v_cvt_pk_bf16_f32 v208, v76, v77
  v_cvt_pk_bf16_f32 v209, v78, v79
  v_cvt_pk_bf16_f32 v210, v92, v93
  v_cvt_pk_bf16_f32 v211, v94, v95
  buffer_store_dwordx4 v[208:211], v2, s[16:19], s51 offen offset:2048 sc1
  ds_write_b128 v232, v[208:211] offset:51200
  v_pk_fma_f32 v[80:81], v[132:133], v[250:251], v[80:81] op_sel:[0,0,0] op_sel_hi:[1,0,1] neg_lo:[0,1,0] neg_hi:[0,1,0]
  v_pk_fma_f32 v[82:83], v[134:135], v[250:251], v[82:83] op_sel:[0,0,0] op_sel_hi:[1,0,1] neg_lo:[0,1,0] neg_hi:[0,1,0]
  v_pk_fma_f32 v[96:97], v[136:137], v[250:251], v[96:97] op_sel:[0,0,0] op_sel_hi:[1,0,1] neg_lo:[0,1,0] neg_hi:[0,1,0]
  v_pk_fma_f32 v[98:99], v[138:139], v[250:251], v[98:99] op_sel:[0,0,0] op_sel_hi:[1,0,1] neg_lo:[0,1,0] neg_hi:[0,1,0]
  v_pk_fma_f32 v[80:81], v[80:81], v[178:179], v[160:161] op_sel:[0,0,0] op_sel_hi:[1,0,1]
  v_pk_fma_f32 v[82:83], v[82:83], v[178:179], v[162:163] op_sel:[0,0,0] op_sel_hi:[1,0,1]
  v_pk_fma_f32 v[96:97], v[96:97], v[178:179], v[164:165] op_sel:[0,0,0] op_sel_hi:[1,0,1]
  v_pk_fma_f32 v[98:99], v[98:99], v[178:179], v[166:167] op_sel:[0,0,0] op_sel_hi:[1,0,1]
  v_max_f32 v80, 0, v80
  v_max_f32 v81, 0, v81
  v_max_f32 v82, 0, v82
  v_max_f32 v83, 0, v83
  v_max_f32 v96, 0, v96
  v_max_f32 v97, 0, v97
  v_max_f32 v98, 0, v98
  v_max_f32 v99, 0, v99
  v_pk_mul_f32 v[80:81], v[80:81], v[80:81]
  v_pk_mul_f32 v[82:83], v[82:83], v[82:83]
  v_pk_mul_f32 v[96:97], v[96:97], v[96:97]
  v_pk_mul_f32 v[98:99], v[98:99], v[98:99]
  v_cvt_pk_bf16_f32 v212, v80, v81
  v_cvt_pk_bf16_f32 v213, v82, v83
  v_cvt_pk_bf16_f32 v214, v96, v97
  v_cvt_pk_bf16_f32 v215, v98, v99
  buffer_store_dwordx4 v[212:215], v2, s[16:19], s51 offen offset:3072 sc1
  ds_write_b128 v232, v[212:215] offset:52224
  v_and_b32 v3, 31, v0
  v_lshlrev_b32 v3, 4, v3
  v_lshrrev_b32 v1, 5, v0
  v_lshl_add_u32 v3, v1, 10, v3
  s_and_b32 s53, s50, 1
  s_lshl_b32 s53, s53, 9
  v_add_u32 v3, s53, v3
  v_pk_fma_f32 v[100:101], v[140:141], v[244:245], v[100:101] op_sel:[0,0,0] op_sel_hi:[1,0,1] neg_lo:[0,1,0] neg_hi:[0,1,0]
  v_pk_fma_f32 v[102:103], v[142:143], v[244:245], v[102:103] op_sel:[0,0,0] op_sel_hi:[1,0,1] neg_lo:[0,1,0] neg_hi:[0,1,0]
  v_pk_fma_f32 v[100:101], v[100:101], v[172:173], v[168:169] op_sel:[0,0,0] op_sel_hi:[1,0,1]
  v_pk_fma_f32 v[102:103], v[102:103], v[172:173], v[170:171] op_sel:[0,0,0] op_sel_hi:[1,0,1]
  v_max_f32 v100, 0, v100
  v_max_f32 v101, 0, v101
  v_max_f32 v102, 0, v102
  v_max_f32 v103, 0, v103
  v_pk_mul_f32 v[100:101], v[100:101], v[100:101]
  v_pk_mul_f32 v[102:103], v[102:103], v[102:103]
  v_cvt_pk_bf16_f32 v216, v100, v101
  v_cvt_pk_bf16_f32 v217, v102, v103
  v_pk_fma_f32 v[104:105], v[140:141], v[246:247], v[104:105] op_sel:[0,0,0] op_sel_hi:[1,0,1] neg_lo:[0,1,0] neg_hi:[0,1,0]
  v_pk_fma_f32 v[106:107], v[142:143], v[246:247], v[106:107] op_sel:[0,0,0] op_sel_hi:[1,0,1] neg_lo:[0,1,0] neg_hi:[0,1,0]
  v_pk_fma_f32 v[104:105], v[104:105], v[174:175], v[168:169] op_sel:[0,0,0] op_sel_hi:[1,0,1]
  v_pk_fma_f32 v[106:107], v[106:107], v[174:175], v[170:171] op_sel:[0,0,0] op_sel_hi:[1,0,1]
  v_max_f32 v104, 0, v104
  v_max_f32 v105, 0, v105
  v_max_f32 v106, 0, v106
  v_max_f32 v107, 0, v107
  v_pk_mul_f32 v[104:105], v[104:105], v[104:105]
  v_pk_mul_f32 v[106:107], v[106:107], v[106:107]
  v_cvt_pk_bf16_f32 v218, v104, v105
  v_cvt_pk_bf16_f32 v219, v106, v107
  s_nop 0
  v_permlane32_swap_b32 v216, v218
  v_permlane32_swap_b32 v217, v219
  buffer_store_dwordx4 v[216:219], v3, s[16:19], s52 offen offset:0 sc1
  v_pk_fma_f32 v[108:109], v[140:141], v[248:249], v[108:109] op_sel:[0,0,0] op_sel_hi:[1,0,1] neg_lo:[0,1,0] neg_hi:[0,1,0]
  v_pk_fma_f32 v[110:111], v[142:143], v[248:249], v[110:111] op_sel:[0,0,0] op_sel_hi:[1,0,1] neg_lo:[0,1,0] neg_hi:[0,1,0]
  v_pk_fma_f32 v[108:109], v[108:109], v[176:177], v[168:169] op_sel:[0,0,0] op_sel_hi:[1,0,1]
  v_pk_fma_f32 v[110:111], v[110:111], v[176:177], v[170:171] op_sel:[0,0,0] op_sel_hi:[1,0,1]
  v_max_f32 v108, 0, v108
  v_max_f32 v109, 0, v109
  v_max_f32 v110, 0, v110
  v_max_f32 v111, 0, v111
  v_pk_mul_f32 v[108:109], v[108:109], v[108:109]
  v_pk_mul_f32 v[110:111], v[110:111], v[110:111]
  v_cvt_pk_bf16_f32 v220, v108, v109
  v_cvt_pk_bf16_f32 v221, v110, v111
  v_pk_fma_f32 v[112:113], v[140:141], v[250:251], v[112:113] op_sel:[0,0,0] op_sel_hi:[1,0,1] neg_lo:[0,1,0] neg_hi:[0,1,0]
  v_pk_fma_f32 v[114:115], v[142:143], v[250:251], v[114:115] op_sel:[0,0,0] op_sel_hi:[1,0,1] neg_lo:[0,1,0] neg_hi:[0,1,0]
  v_pk_fma_f32 v[112:113], v[112:113], v[178:179], v[168:169] op_sel:[0,0,0] op_sel_hi:[1,0,1]
  v_pk_fma_f32 v[114:115], v[114:115], v[178:179], v[170:171] op_sel:[0,0,0] op_sel_hi:[1,0,1]
  v_max_f32 v112, 0, v112
  v_max_f32 v113, 0, v113
  v_max_f32 v114, 0, v114
  v_max_f32 v115, 0, v115
  v_pk_mul_f32 v[112:113], v[112:113], v[112:113]
  v_pk_mul_f32 v[114:115], v[114:115], v[114:115]
  v_cvt_pk_bf16_f32 v222, v112, v113
  v_cvt_pk_bf16_f32 v223, v114, v115
  s_nop 0
  v_permlane32_swap_b32 v220, v222
  v_permlane32_swap_b32 v221, v223
  buffer_store_dwordx4 v[220:223], v3, s[16:19], s52 offen offset:2048 sc1
  v_lshlrev_b32 v144, 4, v0
  v_lshrrev_b32 v1, 4, v0
  v_and_b32 v2, 15, v0
  s_lshl_b32 s53, s48, 8
  s_and_b32 s51, s44, 1
  s_lshl_b32 s51, s51, 2
  v_add_u32 v3, s51, v1
  v_lshlrev_b32 v3, 1, v3
  v_xor_b32 v3, v3, v2
  s_lshl_b32 s52, s44, 2
  v_add_u32 v4, s52, v1
  v_lshlrev_b32 v4, 11, v4
  v_lshl_add_u32 v4, v3, 4, v4
  v_add_u32 v147, s53, v4
  s_lshl_b32 s52, s44, 3
  v_add_u32 v4, s52, v1
  v_lshlrev_b32 v4, 11, v4
  v_add_u32 v4, s53, v4
  v_lshlrev_b32 v3, 1, v1
  v_xor_b32 v3, v3, v2
  v_lshl_add_u32 v148, v3, 4, v4
  v_xor_b32 v149, 0x80, v148
  v_add_u32 v149, 7168, v149
  s_lshl_b32 s51, s45, 12
  v_add_u32 v150, s51, v144
  s_and_b32 s51, s44, 1
  s_lshl_b32 s51, s51, 11
  s_add_u32 s51, s51, 73728
  v_add_u32 v155, s51, v144
  v_lshrrev_b32 v3, 2, v2
  v_lshl_add_u32 v3, v1, 2, v3
  v_and_b32 v4, 7, v3
  v_lshlrev_b32 v3, 8, v3
  v_and_b32 v5, 3, v2
  v_lshl_add_u32 v3, v5, 3, v3
  s_lshr_b32 s51, s44, 2
  s_lshl_b32 s51, s51, 2
  v_xor_b32 v5, s51, v4
  v_lshl_add_u32 v5, v5, 5, v3
  v_add_u32 v151, 16384, v5
  v_xor_b32 v152, 32, v151
  v_xor_b32 v153, 64, v151
  v_xor_b32 v154, 96, v151
  v_add_u32 v161, 73728, v150
  v_add_u32 v162, 73728, v151
  v_add_u32 v163, 73728, v152
  v_add_u32 v164, 73728, v153
  v_add_u32 v165, 73728, v154
  s_lshr_b32 s51, s44, 1
  s_lshl_b32 s51, s51, 1
  v_xor_b32 v5, s51, v4
  v_lshl_add_u32 v5, v5, 5, v3
  v_add_u32 v156, 81920, v5
  v_xor_b32 v157, 32, v156
  s_mul_i32 s51, s46, 112
  s_mul_i32 s52, s49, 28
  s_add_u32 s51, s51, s52
  s_lshl_b32 s51, s51, 14
  s_lshl_b32 s61, s44, 11
  s_add_u32 s51, s51, s61
  s_add_u32 s59, s51, 0x400000
  s_mul_i32 s60, s49, 1835008
  s_lshr_b32 s51, s48, 1
  s_mul_i32 s51, s51, 7
  s_and_b32 s52, s48, 1
  s_lshl_b32 s52, s52, 2
  s_add_u32 s51, s51, s52
  s_lshl_b32 s52, s51, 14
  s_add_u32 s63, s59, s52
  s_add_u32 s58, s63, 49152
  s_lshl_b32 s52, s51, 16
  s_add_u32 s98, s60, s52
  s_add_u32 s96, s98, 196608
  s_cmp_eq_u32 s51, 0
  s_cselect_b32 s59, s58, s59
  s_cselect_b32 s60, s96, s60
  s_bfm_b32 s52, s51, 0
  s_and_b32 s53, s52, 0x1020408
  s_lshl_b32 s53, s53, 3
  s_andn2_b32 s97, 0x1020408, s52
  s_or_b32 s97, s97, s53
  s_lshr_b32 s52, s44, 1
  s_mov_b32 s47, 0
  s_cmp_eq_u32 s52, 1
  s_cselect_b32 s47, 16384, s47
  s_cmp_eq_u32 s52, 2
  s_cselect_b32 s47, 0xffffc000, s47
  s_lshl_b32 s62, s44, 10
  s_add_u32 s62, s62, 16384
  s_lshl_b32 s3, s46, 3
  s_add_u32 s3, s3, s48
  s_mov_b32 s12, s16
  s_mov_b32 s13, s17
  s_mov_b32 s14, 0
  s_mov_b32 s15, 0x20000
  s_waitcnt vmcnt(0)
  v_mov_b32 v1, 161792
  v_mov_b32 v2, 1
  s_mov_b64 exec, 1
  ds_add_rtn_u32 v3, v1, v2
  s_mov_b64 exec, -1
  s_waitcnt lgkmcnt(0)
  v_readfirstlane_b32 s51, v3
  s_cmp_lg_u32 s51, 3
  s_cbranch_scc1 L_la_4_done
  s_lshl_b32 s51, s46, 2
  s_add_u32 s51, s51, s49
  s_lshl_b32 s51, s51, 8
  s_add_u32 s51, s51, 0x80000
  s_lshl_b32 s56, s48, 2
  s_add_u32 s51, s51, s56
  v_mov_b32 v1, 1
  v_mov_b32 v2, 0
  s_mov_b64 exec, 1
  buffer_store_dword v1, v2, s[16:19], s51 offen sc1
  s_mov_b64 exec, -1
L_la_4_done:
  s_setprio 0
  v_mul_f32 v220, 0x3fb8aa3b, v245
  v_mul_f32 v236, 0x3fb8aa3b, v247
  v_mul_f32 v222, 0x3fb8aa3b, v249
  v_mul_f32 v238, 0x3fb8aa3b, v251
  s_lshl_b32 s51, s45, 13
  v_add_u32 v3, s51, v144
  v_add_u32 v3, 122880, v3
  v_mov_b32 v1, 161984
  s_mov_b32 s7, 0x100000
L_lw_5:
  ds_read_b32 v2, v1
  s_waitcnt lgkmcnt(0)
  v_readfirstlane_b32 s56, v2
  s_cmp_ge_u32 s56, 4
  s_cbranch_scc1 L_lw_5_done
  s_sub_u32 s7, s7, 1
  s_cmp_eq_u32 s7, 0
  s_cbranch_scc1 L_lw_5_done
  s_sleep 1
  s_branch L_lw_5
L_lw_5_done:
  ds_read_b128 v[80:83], v3 offset:0
  ds_read_b128 v[96:99], v3 offset:4096
  ds_read_b128 v[84:87], v3 offset:1024
  ds_read_b128 v[100:103], v3 offset:5120
  ds_read_b128 v[88:91], v3 offset:2048
  ds_read_b128 v[104:107], v3 offset:6144
  ds_read_b128 v[92:95], v3 offset:3072
  ds_read_b128 v[108:111], v3 offset:7168
  s_waitcnt lgkmcnt(0)
  v_max3_f32 v212, v80, v81, v82
  v_min3_f32 v216, v80, v81, v82
  v_max3_f32 v213, v84, v85, v86
  v_min3_f32 v217, v84, v85, v86
  v_max3_f32 v214, v88, v89, v90
  v_min3_f32 v218, v88, v89, v90
  v_max3_f32 v215, v92, v93, v94
  v_min3_f32 v219, v92, v93, v94
  v_max3_f32 v212, v212, v83, v96
  v_min3_f32 v216, v216, v83, v96
  v_max3_f32 v213, v213, v87, v100
  v_min3_f32 v217, v217, v87, v100
  v_max3_f32 v214, v214, v91, v104
  v_min3_f32 v218, v218, v91, v104
  v_max3_f32 v215, v215, v95, v108
  v_min3_f32 v219, v219, v95, v108
  v_max3_f32 v212, v212, v97, v98
  v_min3_f32 v216, v216, v97, v98
  v_max3_f32 v213, v213, v101, v102
  v_min3_f32 v217, v217, v101, v102
  v_max3_f32 v214, v214, v105, v106
  v_min3_f32 v218, v218, v105, v106
  v_max3_f32 v215, v215, v109, v110
  v_min3_f32 v219, v219, v109, v110
  v_max_f32 v212, v212, v99
  v_min_f32 v216, v216, v99
  v_max_f32 v213, v213, v103
  v_min_f32 v217, v217, v103
  v_max_f32 v214, v214, v107
  v_min_f32 v218, v218, v107
  v_max_f32 v215, v215, v111
  v_min_f32 v219, v219, v111
  v_permlane32_swap_b32 v212, v213
  v_permlane32_swap_b32 v214, v215
  v_permlane32_swap_b32 v216, v217
  v_permlane32_swap_b32 v218, v219
  v_max_f32 v212, v212, v213
  v_max_f32 v214, v214, v215
  v_min_f32 v216, v216, v217
  v_min_f32 v218, v218, v219
  v_permlane16_swap_b32 v212, v214
  s_nop 0
  v_permlane16_swap_b32 v216, v218
  v_max_f32 v212, v212, v214
  v_min_f32 v216, v216, v218
  v_mov_b32 v214, v212
  v_mov_b32 v218, v216
  s_nop 0
  v_permlane16_swap_b32 v212, v214
  v_permlane16_swap_b32 v216, v218
  v_mov_b32 v213, v212
  v_mov_b32 v215, v214
  v_mov_b32 v217, v216
  v_mov_b32 v219, v218
  v_permlane32_swap_b32 v212, v213
  v_permlane32_swap_b32 v214, v215
  v_permlane32_swap_b32 v216, v217
  v_permlane32_swap_b32 v218, v219
  v_mul_f32 v212, v212, v220
  v_mul_f32 v240, v213, v236
  v_mul_f32 v214, v214, v222
  v_mul_f32 v242, v215, v238
  v_mul_f32 v216, v216, v220
  v_mul_f32 v176, v217, v236
  v_mul_f32 v218, v218, v222
  v_mul_f32 v178, v219, v238
  v_pk_fma_f32 v[112:113], v[80:81], v[220:221], v[212:213] op_sel:[0,0,0] op_sel_hi:[1,0,0] neg_lo:[0,0,1] neg_hi:[0,0,1]
  v_pk_fma_f32 v[80:81], v[80:81], v[220:221], v[216:217] op_sel:[0,0,0] op_sel_hi:[1,0,0] neg_lo:[0,1,0] neg_hi:[0,1,0]
  v_pk_fma_f32 v[114:115], v[82:83], v[220:221], v[212:213] op_sel:[0,0,0] op_sel_hi:[1,0,0] neg_lo:[0,0,1] neg_hi:[0,0,1]
  v_pk_fma_f32 v[82:83], v[82:83], v[220:221], v[216:217] op_sel:[0,0,0] op_sel_hi:[1,0,0] neg_lo:[0,1,0] neg_hi:[0,1,0]
  v_pk_fma_f32 v[128:129], v[96:97], v[220:221], v[212:213] op_sel:[0,0,0] op_sel_hi:[1,0,0] neg_lo:[0,0,1] neg_hi:[0,0,1]
  v_pk_fma_f32 v[96:97], v[96:97], v[220:221], v[216:217] op_sel:[0,0,0] op_sel_hi:[1,0,0] neg_lo:[0,1,0] neg_hi:[0,1,0]
  v_pk_fma_f32 v[130:131], v[98:99], v[220:221], v[212:213] op_sel:[0,0,0] op_sel_hi:[1,0,0] neg_lo:[0,0,1] neg_hi:[0,0,1]
  v_pk_fma_f32 v[98:99], v[98:99], v[220:221], v[216:217] op_sel:[0,0,0] op_sel_hi:[1,0,0] neg_lo:[0,1,0] neg_hi:[0,1,0]
  v_exp_f32 v112, v112
  v_exp_f32 v80, v80
  v_exp_f32 v113, v113
  v_exp_f32 v81, v81
  v_exp_f32 v114, v114
  v_exp_f32 v82, v82
  v_exp_f32 v115, v115
  v_exp_f32 v83, v83
  v_exp_f32 v128, v128
  v_exp_f32 v96, v96
  v_exp_f32 v129, v129
  v_exp_f32 v97, v97
  v_exp_f32 v130, v130
  v_exp_f32 v98, v98
  v_exp_f32 v131, v131
  v_exp_f32 v99, v99
  v_pk_fma_f32 v[116:117], v[84:85], v[236:237], v[240:241] op_sel:[0,0,0] op_sel_hi:[1,0,0] neg_lo:[0,0,1] neg_hi:[0,0,1]
  v_pk_fma_f32 v[84:85], v[84:85], v[236:237], v[176:177] op_sel:[0,0,0] op_sel_hi:[1,0,0] neg_lo:[0,1,0] neg_hi:[0,1,0]
  v_pk_fma_f32 v[118:119], v[86:87], v[236:237], v[240:241] op_sel:[0,0,0] op_sel_hi:[1,0,0] neg_lo:[0,0,1] neg_hi:[0,0,1]
  v_pk_fma_f32 v[86:87], v[86:87], v[236:237], v[176:177] op_sel:[0,0,0] op_sel_hi:[1,0,0] neg_lo:[0,1,0] neg_hi:[0,1,0]
  v_pk_fma_f32 v[132:133], v[100:101], v[236:237], v[240:241] op_sel:[0,0,0] op_sel_hi:[1,0,0] neg_lo:[0,0,1] neg_hi:[0,0,1]
  v_pk_fma_f32 v[100:101], v[100:101], v[236:237], v[176:177] op_sel:[0,0,0] op_sel_hi:[1,0,0] neg_lo:[0,1,0] neg_hi:[0,1,0]
  v_pk_fma_f32 v[134:135], v[102:103], v[236:237], v[240:241] op_sel:[0,0,0] op_sel_hi:[1,0,0] neg_lo:[0,0,1] neg_hi:[0,0,1]
  v_pk_fma_f32 v[102:103], v[102:103], v[236:237], v[176:177] op_sel:[0,0,0] op_sel_hi:[1,0,0] neg_lo:[0,1,0] neg_hi:[0,1,0]
  v_exp_f32 v116, v116
  v_exp_f32 v84, v84
  v_exp_f32 v117, v117
  v_exp_f32 v85, v85
  v_exp_f32 v118, v118
  v_exp_f32 v86, v86
  v_exp_f32 v119, v119
  v_exp_f32 v87, v87
  v_exp_f32 v132, v132
  v_exp_f32 v100, v100
  v_exp_f32 v133, v133
  v_exp_f32 v101, v101
  v_exp_f32 v134, v134
  v_exp_f32 v102, v102
  v_exp_f32 v135, v135
  v_exp_f32 v103, v103
  v_pk_fma_f32 v[120:121], v[88:89], v[222:223], v[214:215] op_sel:[0,0,0] op_sel_hi:[1,0,0] neg_lo:[0,0,1] neg_hi:[0,0,1]
  v_pk_fma_f32 v[88:89], v[88:89], v[222:223], v[218:219] op_sel:[0,0,0] op_sel_hi:[1,0,0] neg_lo:[0,1,0] neg_hi:[0,1,0]
  v_pk_fma_f32 v[122:123], v[90:91], v[222:223], v[214:215] op_sel:[0,0,0] op_sel_hi:[1,0,0] neg_lo:[0,0,1] neg_hi:[0,0,1]
  v_pk_fma_f32 v[90:91], v[90:91], v[222:223], v[218:219] op_sel:[0,0,0] op_sel_hi:[1,0,0] neg_lo:[0,1,0] neg_hi:[0,1,0]
  v_pk_fma_f32 v[136:137], v[104:105], v[222:223], v[214:215] op_sel:[0,0,0] op_sel_hi:[1,0,0] neg_lo:[0,0,1] neg_hi:[0,0,1]
  v_pk_fma_f32 v[104:105], v[104:105], v[222:223], v[218:219] op_sel:[0,0,0] op_sel_hi:[1,0,0] neg_lo:[0,1,0] neg_hi:[0,1,0]
  v_pk_fma_f32 v[138:139], v[106:107], v[222:223], v[214:215] op_sel:[0,0,0] op_sel_hi:[1,0,0] neg_lo:[0,0,1] neg_hi:[0,0,1]
  v_pk_fma_f32 v[106:107], v[106:107], v[222:223], v[218:219] op_sel:[0,0,0] op_sel_hi:[1,0,0] neg_lo:[0,1,0] neg_hi:[0,1,0]
  v_exp_f32 v120, v120
  v_exp_f32 v88, v88
  v_exp_f32 v121, v121
  v_exp_f32 v89, v89
  v_exp_f32 v122, v122
  v_exp_f32 v90, v90
  v_exp_f32 v123, v123
  v_exp_f32 v91, v91
  v_exp_f32 v136, v136
  v_exp_f32 v104, v104
  v_exp_f32 v137, v137
  v_exp_f32 v105, v105
  v_exp_f32 v138, v138
  v_exp_f32 v106, v106
  v_exp_f32 v139, v139
  v_exp_f32 v107, v107
  v_pk_fma_f32 v[124:125], v[92:93], v[238:239], v[242:243] op_sel:[0,0,0] op_sel_hi:[1,0,0] neg_lo:[0,0,1] neg_hi:[0,0,1]
  v_pk_fma_f32 v[92:93], v[92:93], v[238:239], v[178:179] op_sel:[0,0,0] op_sel_hi:[1,0,0] neg_lo:[0,1,0] neg_hi:[0,1,0]
  v_pk_fma_f32 v[126:127], v[94:95], v[238:239], v[242:243] op_sel:[0,0,0] op_sel_hi:[1,0,0] neg_lo:[0,0,1] neg_hi:[0,0,1]
  v_pk_fma_f32 v[94:95], v[94:95], v[238:239], v[178:179] op_sel:[0,0,0] op_sel_hi:[1,0,0] neg_lo:[0,1,0] neg_hi:[0,1,0]
  v_pk_fma_f32 v[140:141], v[108:109], v[238:239], v[242:243] op_sel:[0,0,0] op_sel_hi:[1,0,0] neg_lo:[0,0,1] neg_hi:[0,0,1]
  v_pk_fma_f32 v[108:109], v[108:109], v[238:239], v[178:179] op_sel:[0,0,0] op_sel_hi:[1,0,0] neg_lo:[0,1,0] neg_hi:[0,1,0]
  v_pk_fma_f32 v[142:143], v[110:111], v[238:239], v[242:243] op_sel:[0,0,0] op_sel_hi:[1,0,0] neg_lo:[0,0,1] neg_hi:[0,0,1]
  v_pk_fma_f32 v[110:111], v[110:111], v[238:239], v[178:179] op_sel:[0,0,0] op_sel_hi:[1,0,0] neg_lo:[0,1,0] neg_hi:[0,1,0]
  v_exp_f32 v124, v124
  v_exp_f32 v92, v92
  v_exp_f32 v125, v125
  v_exp_f32 v93, v93
  v_exp_f32 v126, v126
  v_exp_f32 v94, v94
  v_exp_f32 v127, v127
  v_exp_f32 v95, v95
  v_exp_f32 v140, v140
  v_exp_f32 v108, v108
  v_exp_f32 v141, v141
  v_exp_f32 v109, v109
  v_exp_f32 v142, v142
  v_exp_f32 v110, v110
  v_exp_f32 v143, v143
  v_exp_f32 v111, v111
  v_cvt_pk_bf16_f32 v168, v112, v113
  v_cvt_pk_bf16_f32 v169, v114, v115
  v_cvt_pk_bf16_f32 v170, v128, v129
  v_cvt_pk_bf16_f32 v171, v130, v131
  ds_write_b128 v3, v[168:171] offset:0
  v_cvt_pk_bf16_f32 v172, v80, v81
  v_cvt_pk_bf16_f32 v173, v82, v83
  v_cvt_pk_bf16_f32 v174, v96, v97
  v_cvt_pk_bf16_f32 v175, v98, v99
  ds_write_b128 v3, v[172:175] offset:1024
  v_cvt_pk_bf16_f32 v176, v116, v117
  v_cvt_pk_bf16_f32 v177, v118, v119
  v_cvt_pk_bf16_f32 v178, v132, v133
  v_cvt_pk_bf16_f32 v179, v134, v135
  ds_write_b128 v3, v[176:179] offset:2048
  v_cvt_pk_bf16_f32 v180, v84, v85
  v_cvt_pk_bf16_f32 v181, v86, v87
  v_cvt_pk_bf16_f32 v182, v100, v101
  v_cvt_pk_bf16_f32 v183, v102, v103
  ds_write_b128 v3, v[180:183] offset:3072
  v_cvt_pk_bf16_f32 v184, v120, v121
  v_cvt_pk_bf16_f32 v185, v122, v123
  v_cvt_pk_bf16_f32 v186, v136, v137
  v_cvt_pk_bf16_f32 v187, v138, v139
  ds_write_b128 v3, v[184:187] offset:4096
  v_cvt_pk_bf16_f32 v188, v88, v89
  v_cvt_pk_bf16_f32 v189, v90, v91
  v_cvt_pk_bf16_f32 v190, v104, v105
  v_cvt_pk_bf16_f32 v191, v106, v107
  ds_write_b128 v3, v[188:191] offset:5120
  v_cvt_pk_bf16_f32 v192, v124, v125
  v_cvt_pk_bf16_f32 v193, v126, v127
  v_cvt_pk_bf16_f32 v194, v140, v141
  v_cvt_pk_bf16_f32 v195, v142, v143
  ds_write_b128 v3, v[192:195] offset:6144
  v_cvt_pk_bf16_f32 v196, v92, v93
  v_cvt_pk_bf16_f32 v197, v94, v95
  v_cvt_pk_bf16_f32 v198, v108, v109
  v_cvt_pk_bf16_f32 v199, v110, v111
  ds_write_b128 v3, v[196:199] offset:7168
  s_waitcnt lgkmcnt(0)
  s_setprio 0
  s_branch L_p2_join
L_p2_join:
  s_barrier
  s_lshl_b32 s51, s46, 2
  s_add_u32 s51, s51, s49
  s_lshl_b32 s51, s51, 8
  s_add_u32 s51, s51, 0x80000
  v_and_b32 v1, 7, v0
  v_lshlrev_b32 v1, 2, v1
  buffer_load_dword v158, v1, s[16:19], s51 offen sc1
  s_add_u32 m0, s62, 73728
  s_bitcmp1_b32 s97, 3
  s_cselect_b32 s55, s47, 0
  s_add_u32 s55, s55, s60
  buffer_load_dwordx4 v147, s[28:31], s55 offen lds
  s_add_u32 s60, s60, 65536
  s_cmp_eq_u32 s60, s98
  s_cselect_b32 s60, s96, s60
  s_add_u32 m0, s62, 98304
  s_bitcmp1_b32 s97, 4
  s_cselect_b32 s55, s47, 0
  s_add_u32 s55, s55, s60
  buffer_load_dwordx4 v147, s[28:31], s55 offen lds
  s_add_u32 s60, s60, 65536
  s_cmp_eq_u32 s60, s98
  s_cselect_b32 s60, s96, s60
  ds_read_b64_tr_b16 v[96:97], v151 offset:0
  ds_read_b64_tr_b16 v[98:99], v151 offset:4096
  ds_read_b128 v[80:83], v150 offset:0
  ds_read_b128 v[84:87], v150 offset:1024
  ds_read_b128 v[88:91], v150 offset:2048
  ds_read_b128 v[92:95], v150 offset:3072
  ds_read_b64_tr_b16 v[100:101], v152 offset:0
  ds_read_b64_tr_b16 v[102:103], v152 offset:4096
  ds_read_b64_tr_b16 v[104:105], v153 offset:0
  ds_read_b64_tr_b16 v[106:107], v153 offset:4096
  ds_read_b64_tr_b16 v[108:109], v154 offset:0
  ds_read_b64_tr_b16 v[110:111], v154 offset:4096
  s_waitcnt vmcnt(7) lgkmcnt(0)
  s_barrier
  v_mfma_f32_16x16x32_bf16 v[16:19], v[96:99], v[80:83], 0
  ds_read_b64_tr_b16 v[128:129], v151 offset:24576
  v_mfma_f32_16x16x32_bf16 v[32:35], v[96:99], v[84:87], 0
  ds_read_b64_tr_b16 v[130:131], v151 offset:28672
  s_add_u32 m0, s62, 0
  s_bitcmp1_b32 s97, 5
  s_cselect_b32 s55, s47, 0
  s_add_u32 s55, s55, s60
  buffer_load_dwordx4 v147, s[28:31], s55 offen lds
  s_add_u32 s60, s60, 65536
  s_cmp_eq_u32 s60, s98
  s_cselect_b32 s60, s96, s60
  v_mfma_f32_16x16x32_bf16 v[48:51], v[96:99], v[88:91], 0
  ds_read_b128 v[112:115], v150 offset:24576
  v_mfma_f32_16x16x32_bf16 v[64:67], v[96:99], v[92:95], 0
  ds_read_b128 v[116:119], v150 offset:25600
  v_mfma_f32_16x16x32_bf16 v[20:23], v[100:103], v[80:83], 0
  ds_read_b128 v[120:123], v150 offset:26624
  v_mfma_f32_16x16x32_bf16 v[36:39], v[100:103], v[84:87], 0
  ds_read_b128 v[124:127], v150 offset:27648
  v_mfma_f32_16x16x32_bf16 v[52:55], v[100:103], v[88:91], 0
  ds_read_b64_tr_b16 v[132:133], v152 offset:24576
  v_mfma_f32_16x16x32_bf16 v[68:71], v[100:103], v[92:95], 0
  ds_read_b64_tr_b16 v[134:135], v152 offset:28672
  v_mfma_f32_16x16x32_bf16 v[24:27], v[104:107], v[80:83], 0
  ds_read_b64_tr_b16 v[136:137], v153 offset:24576
  s_lshl_b32 s51, s46, 2
  s_add_u32 s51, s51, s49
  s_lshl_b32 s51, s51, 8
  s_add_u32 s51, s51, 0x80000
  v_and_b32 v1, 7, v0
  v_lshlrev_b32 v1, 2, v1
  buffer_load_dword v159, v1, s[16:19], s51 offen sc1
  v_mfma_f32_16x16x32_bf16 v[40:43], v[104:107], v[84:87], 0
  ds_read_b64_tr_b16 v[138:139], v153 offset:28672
  v_mfma_f32_16x16x32_bf16 v[56:59], v[104:107], v[88:91], 0
  ds_read_b64_tr_b16 v[140:141], v154 offset:24576
  v_mfma_f32_16x16x32_bf16 v[72:75], v[104:107], v[92:95], 0
  ds_read_b64_tr_b16 v[142:143], v154 offset:28672
  v_mfma_f32_16x16x32_bf16 v[28:31], v[108:111], v[80:83], 0
  v_mfma_f32_16x16x32_bf16 v[44:47], v[108:111], v[84:87], 0
  v_mfma_f32_16x16x32_bf16 v[60:63], v[108:111], v[88:91], 0
  v_mfma_f32_16x16x32_bf16 v[76:79], v[108:111], v[92:95], 0
  s_waitcnt vmcnt(4) lgkmcnt(0)
  s_barrier
  v_mfma_f32_16x16x32_bf16 v[16:19], v[128:131], v[112:115], v[16:19]
  ds_read_b64_tr_b16 v[96:97], v151 offset:49152
  v_cmp_gt_u32 vcc, 1, v158
  s_nop 0
  s_cmp_eq_u64 vcc, 0
  s_cbranch_scc0 L_spin_f3
L_spinr_f3:
  s_add_u32 m0, s61, 73728
  s_nop 0
  buffer_load_dwordx4 v144, s[16:19], s59 offen sc1 lds
  buffer_load_dwordx4 v144, s[16:19], s59 offen offset:1024 sc1 lds
  s_add_u32 s59, s59, 16384
  s_cmp_eq_u32 s59, s63
  s_cselect_b32 s59, s58, s59
  v_mfma_f32_16x16x32_bf16 v[32:35], v[128:131], v[116:119], v[32:35]
  ds_read_b64_tr_b16 v[98:99], v151 offset:53248
  s_add_u32 m0, s61, 98304
  s_nop 0
  buffer_load_dwordx4 v144, s[16:19], s59 offen sc1 lds
  buffer_load_dwordx4 v144, s[16:19], s59 offen offset:1024 sc1 lds
  s_add_u32 s59, s59, 16384
  s_cmp_eq_u32 s59, s63
  s_cselect_b32 s59, s58, s59
  s_cmp_eq_u32 s44, 0
  s_cbranch_scc1 L_w0_f2
L_w0r_f2:
  v_mfma_f32_16x16x32_bf16 v[48:51], v[128:131], v[120:123], v[48:51]
  ds_read_b128 v[80:83], v150 offset:49152
  s_add_u32 m0, s61, 0
  s_nop 0
  buffer_load_dwordx4 v144, s[16:19], s59 offen sc1 lds
  buffer_load_dwordx4 v144, s[16:19], s59 offen offset:1024 sc1 lds
  s_add_u32 s59, s59, 16384
  s_cmp_eq_u32 s59, s63
  s_cselect_b32 s59, s58, s59
  v_mfma_f32_16x16x32_bf16 v[64:67], v[128:131], v[124:127], v[64:67]
  ds_read_b128 v[84:87], v150 offset:50176
  v_mfma_f32_16x16x32_bf16 v[20:23], v[132:135], v[112:115], v[20:23]
  ds_read_b128 v[88:91], v150 offset:51200
  v_mfma_f32_16x16x32_bf16 v[36:39], v[132:135], v[116:119], v[36:39]
  s_branch L_tover_4
L_touch_4:
  s_branch L_tret_A0
L_tover_4:
  ds_read_b128 v[92:95], v150 offset:52224
  s_add_u32 m0, s61, 24576
  s_nop 0
  buffer_load_dwordx4 v144, s[16:19], s59 offen sc1 lds
  buffer_load_dwordx4 v144, s[16:19], s59 offen offset:1024 sc1 lds
  s_add_u32 s59, s59, 16384
  s_cmp_eq_u32 s59, s63
  s_cselect_b32 s59, s58, s59
  v_mfma_f32_16x16x32_bf16 v[52:55], v[132:135], v[120:123], v[52:55]
  ds_read_b64_tr_b16 v[100:101], v152 offset:49152
  v_mfma_f32_16x16x32_bf16 v[68:71], v[132:135], v[124:127], v[68:71]
  ds_read_b64_tr_b16 v[102:103], v152 offset:53248
  v_mfma_f32_16x16x32_bf16 v[24:27], v[136:139], v[112:115], v[24:27]
  ds_read_b64_tr_b16 v[104:105], v153 offset:49152
  v_mfma_f32_16x16x32_bf16 v[40:43], v[136:139], v[116:119], v[40:43]
  ds_read_b64_tr_b16 v[106:107], v153 offset:53248
  s_add_u32 m0, s62, 24576
  s_bitcmp1_b32 s97, 6
  s_cselect_b32 s55, s47, 0
  s_add_u32 s55, s55, s60
  buffer_load_dwordx4 v147, s[28:31], s55 offen lds
  s_add_u32 s60, s60, 65536
  s_cmp_eq_u32 s60, s98
  s_cselect_b32 s60, s96, s60
  v_mfma_f32_16x16x32_bf16 v[56:59], v[136:139], v[120:123], v[56:59]
  ds_read_b64_tr_b16 v[108:109], v154 offset:49152
  v_mfma_f32_16x16x32_bf16 v[72:75], v[136:139], v[124:127], v[72:75]
  ds_read_b64_tr_b16 v[110:111], v154 offset:53248
  v_mfma_f32_16x16x32_bf16 v[28:31], v[140:143], v[112:115], v[28:31]
  v_mfma_f32_16x16x32_bf16 v[44:47], v[140:143], v[116:119], v[44:47]
  v_mfma_f32_16x16x32_bf16 v[60:63], v[140:143], v[120:123], v[60:63]
  v_mfma_f32_16x16x32_bf16 v[76:79], v[140:143], v[124:127], v[76:79]
  s_waitcnt vmcnt(7) lgkmcnt(0)
  s_barrier
  v_mfma_f32_16x16x32_bf16 v[16:19], v[96:99], v[80:83], v[16:19]
  ds_read_b64_tr_b16 v[128:129], v162 offset:0
  v_mfma_f32_16x16x32_bf16 v[32:35], v[96:99], v[84:87], v[32:35]
  ds_read_b64_tr_b16 v[130:131], v162 offset:4096
  s_add_u32 m0, s61, 49152
  s_nop 0
  buffer_load_dwordx4 v144, s[16:19], s59 offen sc1 lds
  v_mfma_f32_16x16x32_bf16 v[48:51], v[96:99], v[88:91], v[48:51]
  ds_read_b128 v[112:115], v161 offset:0
  v_mfma_f32_16x16x32_bf16 v[64:67], v[96:99], v[92:95], v[64:67]
  ds_read_b128 v[116:119], v161 offset:1024
  v_mfma_f32_16x16x32_bf16 v[20:23], v[100:103], v[80:83], v[20:23]
  ds_read_b128 v[120:123], v161 offset:2048
  v_mfma_f32_16x16x32_bf16 v[36:39], v[100:103], v[84:87], v[36:39]
  ds_read_b128 v[124:127], v161 offset:3072
  buffer_load_dwordx4 v144, s[16:19], s59 offen offset:1024 sc1 lds
  s_add_u32 s59, s59, 16384
  s_cmp_eq_u32 s59, s63
  s_cselect_b32 s59, s58, s59
  v_mfma_f32_16x16x32_bf16 v[52:55], v[100:103], v[88:91], v[52:55]
  ds_read_b64_tr_b16 v[132:133], v163 offset:0
  v_mfma_f32_16x16x32_bf16 v[68:71], v[100:103], v[92:95], v[68:71]
  ds_read_b64_tr_b16 v[134:135], v163 offset:4096
  v_mfma_f32_16x16x32_bf16 v[24:27], v[104:107], v[80:83], v[24:27]
  ds_read_b64_tr_b16 v[136:137], v164 offset:0
  v_mfma_f32_16x16x32_bf16 v[40:43], v[104:107], v[84:87], v[40:43]
  ds_read_b64_tr_b16 v[138:139], v164 offset:4096
  s_add_u32 m0, s62, 49152
  s_bitcmp1_b32 s97, 7
  s_cselect_b32 s55, s47, 0
  s_add_u32 s55, s55, s60
  buffer_load_dwordx4 v147, s[28:31], s55 offen lds
  s_add_u32 s60, s60, 65536
  s_cmp_eq_u32 s60, s98
  s_cselect_b32 s60, s96, s60
  v_mfma_f32_16x16x32_bf16 v[56:59], v[104:107], v[88:91], v[56:59]
  ds_read_b64_tr_b16 v[140:141], v165 offset:0
  v_mfma_f32_16x16x32_bf16 v[72:75], v[104:107], v[92:95], v[72:75]
  ds_read_b64_tr_b16 v[142:143], v165 offset:4096
  v_mfma_f32_16x16x32_bf16 v[28:31], v[108:111], v[80:83], v[28:31]
  v_mfma_f32_16x16x32_bf16 v[44:47], v[108:111], v[84:87], v[44:47]
  v_mfma_f32_16x16x32_bf16 v[60:63], v[108:111], v[88:91], v[60:63]
  v_mfma_f32_16x16x32_bf16 v[76:79], v[108:111], v[92:95], v[76:79]
  s_waitcnt vmcnt(8) lgkmcnt(0)
  s_barrier
  v_mfma_f32_16x16x32_bf16 v[16:19], v[128:131], v[112:115], v[16:19]
  ds_read_b64_tr_b16 v[96:97], v162 offset:24576
  v_mfma_f32_16x16x32_bf16 v[32:35], v[128:131], v[116:119], v[32:35]
  ds_read_b64_tr_b16 v[98:99], v162 offset:28672
  s_add_u32 m0, s61, 73728
  s_nop 0
  buffer_load_dwordx4 v144, s[16:19], s59 offen sc1 lds
  v_mfma_f32_16x16x32_bf16 v[48:51], v[128:131], v[120:123], v[48:51]
  ds_read_b128 v[80:83], v161 offset:24576
  v_mfma_f32_16x16x32_bf16 v[64:67], v[128:131], v[124:127], v[64:67]
  ds_read_b128 v[84:87], v161 offset:25600
  v_mfma_f32_16x16x32_bf16 v[20:23], v[132:135], v[112:115], v[20:23]
  ds_read_b128 v[88:91], v161 offset:26624
  v_mfma_f32_16x16x32_bf16 v[36:39], v[132:135], v[116:119], v[36:39]
  ds_read_b128 v[92:95], v161 offset:27648
  buffer_load_dwordx4 v144, s[16:19], s59 offen offset:1024 sc1 lds
  s_add_u32 s59, s59, 16384
  s_cmp_eq_u32 s59, s63
  s_cselect_b32 s59, s58, s59
  v_mfma_f32_16x16x32_bf16 v[52:55], v[132:135], v[120:123], v[52:55]
  ds_read_b64_tr_b16 v[100:101], v163 offset:24576
  v_mfma_f32_16x16x32_bf16 v[68:71], v[132:135], v[124:127], v[68:71]
  ds_read_b64_tr_b16 v[102:103], v163 offset:28672
  v_mfma_f32_16x16x32_bf16 v[24:27], v[136:139], v[112:115], v[24:27]
  ds_read_b64_tr_b16 v[104:105], v164 offset:24576
  v_mfma_f32_16x16x32_bf16 v[40:43], v[136:139], v[116:119], v[40:43]
  ds_read_b64_tr_b16 v[106:107], v164 offset:28672
  s_add_u32 m0, s62, 73728
  s_bitcmp1_b32 s97, 8
  s_cselect_b32 s55, s47, 0
  s_add_u32 s55, s55, s60
  buffer_load_dwordx4 v147, s[28:31], s55 offen lds
  s_add_u32 s60, s60, 65536
  s_cmp_eq_u32 s60, s98
  s_cselect_b32 s60, s96, s60
  v_mfma_f32_16x16x32_bf16 v[56:59], v[136:139], v[120:123], v[56:59]
  ds_read_b64_tr_b16 v[108:109], v165 offset:24576
  s_lshl_b32 s51, s50, 8
  s_add_u32 s51, s51, 0x84000
  v_mfma_f32_16x16x32_bf16 v[72:75], v[136:139], v[124:127], v[72:75]
  ds_read_b64_tr_b16 v[110:111], v165 offset:28672
  v_and_b32 v1, 7, v0
  v_mfma_f32_16x16x32_bf16 v[28:31], v[140:143], v[112:115], v[28:31]
  v_lshlrev_b32 v1, 2, v1
  v_mfma_f32_16x16x32_bf16 v[44:47], v[140:143], v[116:119], v[44:47]
  buffer_load_dword v158, v1, s[16:19], s51 offen sc1
  v_mfma_f32_16x16x32_bf16 v[60:63], v[140:143], v[120:123], v[60:63]
  v_mfma_f32_16x16x32_bf16 v[76:79], v[140:143], v[124:127], v[76:79]
  s_waitcnt vmcnt(10) lgkmcnt(0)
  s_barrier
  v_mfma_f32_16x16x32_bf16 v[16:19], v[96:99], v[80:83], v[16:19]
  ds_read_b64_tr_b16 v[128:129], v151 offset:0
  v_mfma_f32_16x16x32_bf16 v[32:35], v[96:99], v[84:87], v[32:35]
  ds_read_b64_tr_b16 v[130:131], v151 offset:4096
  s_add_u32 m0, s61, 98304
  s_nop 0
  buffer_load_dwordx4 v144, s[16:19], s59 offen sc1 lds
  v_mfma_f32_16x16x32_bf16 v[48:51], v[96:99], v[88:91], v[48:51]
  ds_read_b128 v[112:115], v150 offset:0
  v_mfma_f32_16x16x32_bf16 v[64:67], v[96:99], v[92:95], v[64:67]
  ds_read_b128 v[116:119], v150 offset:1024
  v_mfma_f32_16x16x32_bf16 v[20:23], v[100:103], v[80:83], v[20:23]
  ds_read_b128 v[120:123], v150 offset:2048
  v_mfma_f32_16x16x32_bf16 v[36:39], v[100:103], v[84:87], v[36:39]
  ds_read_b128 v[124:127], v150 offset:3072
  buffer_load_dwordx4 v144, s[16:19], s59 offen offset:1024 sc1 lds
  s_add_u32 s59, s59, 16384
  s_cmp_eq_u32 s59, s63
  s_cselect_b32 s59, s58, s59
  v_mfma_f32_16x16x32_bf16 v[52:55], v[100:103], v[88:91], v[52:55]
  ds_read_b64_tr_b16 v[132:133], v152 offset:0
  v_mfma_f32_16x16x32_bf16 v[68:71], v[100:103], v[92:95], v[68:71]
  ds_read_b64_tr_b16 v[134:135], v152 offset:4096
  v_mfma_f32_16x16x32_bf16 v[24:27], v[104:107], v[80:83], v[24:27]
  ds_read_b64_tr_b16 v[136:137], v153 offset:0
  v_mfma_f32_16x16x32_bf16 v[40:43], v[104:107], v[84:87], v[40:43]
  ds_read_b64_tr_b16 v[138:139], v153 offset:4096
  s_add_u32 m0, s62, 98304
  s_bitcmp1_b32 s97, 9
  s_cselect_b32 s55, s47, 0
  s_add_u32 s55, s55, s60
  buffer_load_dwordx4 v147, s[28:31], s55 offen lds
  s_add_u32 s60, s60, 65536
  s_cmp_eq_u32 s60, s98
  s_cselect_b32 s60, s96, s60
  v_mfma_f32_16x16x32_bf16 v[56:59], v[104:107], v[88:91], v[56:59]
  ds_read_b64_tr_b16 v[140:141], v154 offset:0
  v_mfma_f32_16x16x32_bf16 v[72:75], v[104:107], v[92:95], v[72:75]
  ds_read_b64_tr_b16 v[142:143], v154 offset:4096
  v_mfma_f32_16x16x32_bf16 v[28:31], v[108:111], v[80:83], v[28:31]
  v_mfma_f32_16x16x32_bf16 v[44:47], v[108:111], v[84:87], v[44:47]
  v_mfma_f32_16x16x32_bf16 v[60:63], v[108:111], v[88:91], v[60:63]
  v_mfma_f32_16x16x32_bf16 v[76:79], v[108:111], v[92:95], v[76:79]
  s_waitcnt vmcnt(10) lgkmcnt(0)
  s_barrier
  v_mfma_f32_16x16x32_bf16 v[16:19], v[128:131], v[112:115], v[16:19]
  ds_read_b64_tr_b16 v[96:97], v151 offset:24576
  v_mfma_f32_16x16x32_bf16 v[32:35], v[128:131], v[116:119], v[32:35]
  ds_read_b64_tr_b16 v[98:99], v151 offset:28672
  s_add_u32 m0, s61, 0
  s_nop 0
  buffer_load_dwordx4 v144, s[16:19], s59 offen sc1 lds
  s_waitcnt vmcnt(4)
  v_cmp_gt_u32 vcc, 1, v158
  v_mfma_f32_16x16x32_bf16 v[48:51], v[128:131], v[120:123], v[48:51]
  ds_read_b128 v[80:83], v150 offset:24576
  s_nop 0
  s_cmp_eq_u64 vcc, 0
  s_cbranch_scc0 L_spin_f2
L_spinr_f2:
  v_mfma_f32_16x16x32_bf16 v[64:67], v[128:131], v[124:127], v[64:67]
  ds_read_b128 v[84:87], v150 offset:25600
  s_lshl_b32 s51, s50, 5
  s_add_u32 s51, s51, s45
  s_lshl_b32 s51, s51, 1
  s_lshr_b32 s52, s44, 2
  s_add_u32 s51, s51, s52
  s_lshl_b32 s51, s51, 9
  s_add_u32 s51, s51, 0x100000
  v_mfma_f32_16x16x32_bf16 v[20:23], v[132:135], v[112:115], v[20:23]
  ds_read_b128 v[88:91], v150 offset:26624
  v_lshrrev_b32 v2, 5, v0
  v_mfma_f32_16x16x32_bf16 v[36:39], v[132:135], v[116:119], v[36:39]
  ds_read_b128 v[92:95], v150 offset:27648
  buffer_load_dwordx4 v144, s[16:19], s59 offen offset:1024 sc1 lds
  s_add_u32 s59, s59, 16384
  s_cmp_eq_u32 s59, s63
  s_cselect_b32 s59, s58, s59
  v_and_b32 v1, 31, v0
  v_mfma_f32_16x16x32_bf16 v[52:55], v[132:135], v[120:123], v[52:55]
  ds_read_b64_tr_b16 v[100:101], v152 offset:24576
  v_lshlrev_b32 v1, 4, v1
  v_lshl_add_u32 v1, v2, 12, v1
  v_mfma_f32_16x16x32_bf16 v[68:71], v[132:135], v[124:127], v[68:71]
  ds_read_b64_tr_b16 v[102:103], v152 offset:28672
  buffer_load_dwordx4 v[168:171], v1, s[16:19], s51 offen sc1
  s_add_u32 s51, s51, 8192
  v_mfma_f32_16x16x32_bf16 v[24:27], v[136:139], v[112:115], v[24:27]
  ds_read_b64_tr_b16 v[104:105], v153 offset:24576
  buffer_load_dwordx4 v[172:175], v1, s[16:19], s51 offen sc1
  s_add_u32 s51, s51, 8192
  v_mfma_f32_16x16x32_bf16 v[40:43], v[136:139], v[116:119], v[40:43]
  ds_read_b64_tr_b16 v[106:107], v153 offset:28672
  s_add_u32 m0, s62, 0
  s_bitcmp1_b32 s97, 10
  s_cselect_b32 s55, s47, 0
  s_add_u32 s55, s55, s60
  buffer_load_dwordx4 v147, s[28:31], s55 offen lds
  s_add_u32 s60, s60, 65536
  s_cmp_eq_u32 s60, s98
  s_cselect_b32 s60, s96, s60
  buffer_load_dwordx4 v[176:179], v1, s[16:19], s51 offen sc1
  s_add_u32 s51, s51, 8192
  v_mfma_f32_16x16x32_bf16 v[56:59], v[136:139], v[120:123], v[56:59]
  ds_read_b64_tr_b16 v[108:109], v154 offset:24576
  buffer_load_dwordx4 v[180:183], v1, s[16:19], s51 offen sc1
  v_mfma_f32_16x16x32_bf16 v[72:75], v[136:139], v[124:127], v[72:75]
  ds_read_b64_tr_b16 v[110:111], v154 offset:28672
  s_lshl_b32 s51, s50, 2
  s_add_u32 s51, s51, s45
  s_lshl_b32 s51, s51, 9
  s_add_u32 s51, s51, 0x300000
  v_and_b32 v1, 7, v0
  v_mfma_f32_16x16x32_bf16 v[28:31], v[140:143], v[112:115], v[28:31]
  v_lshlrev_b32 v1, 6, v1
  v_mfma_f32_16x16x32_bf16 v[44:47], v[140:143], v[116:119], v[44:47]
  v_lshrrev_b32 v2, 4, v0
  v_mfma_f32_16x16x32_bf16 v[60:63], v[140:143], v[120:123], v[60:63]
  v_lshl_add_u32 v1, v2, 4, v1
  v_mfma_f32_16x16x32_bf16 v[76:79], v[140:143], v[124:127], v[76:79]
  buffer_load_dwordx4 v[200:203], v1, s[16:19], s51 offen sc1
  s_waitcnt vmcnt(15) lgkmcnt(0)
  s_barrier
  v_mfma_f32_16x16x32_bf16 v[16:19], v[96:99], v[80:83], v[16:19]
  ds_read_b64_tr_b16 v[128:129], v151 offset:49152
  v_mfma_f32_16x16x32_bf16 v[32:35], v[96:99], v[84:87], v[32:35]
  ds_read_b64_tr_b16 v[130:131], v151 offset:53248
  s_add_u32 m0, s61, 24576
  s_nop 0
  buffer_load_dwordx4 v144, s[16:19], s59 offen sc1 lds
  v_mfma_f32_16x16x32_bf16 v[48:51], v[96:99], v[88:91], v[48:51]
  ds_read_b128 v[112:115], v150 offset:49152
  v_mfma_f32_16x16x32_bf16 v[64:67], v[96:99], v[92:95], v[64:67]
  ds_read_b128 v[116:119], v150 offset:50176
  v_mfma_f32_16x16x32_bf16 v[20:23], v[100:103], v[80:83], v[20:23]
  ds_read_b128 v[120:123], v150 offset:51200
  v_mfma_f32_16x16x32_bf16 v[36:39], v[100:103], v[84:87], v[36:39]
  ds_read_b128 v[124:127], v150 offset:52224
  buffer_load_dwordx4 v144, s[16:19], s59 offen offset:1024 sc1 lds
  s_add_u32 s59, s59, 16384
  s_cmp_eq_u32 s59, s63
  s_cselect_b32 s59, s58, s59
  v_mfma_f32_16x16x32_bf16 v[52:55], v[100:103], v[88:91], v[52:55]
  ds_read_b64_tr_b16 v[132:133], v152 offset:49152
  v_mfma_f32_16x16x32_bf16 v[68:71], v[100:103], v[92:95], v[68:71]
  ds_read_b64_tr_b16 v[134:135], v152 offset:53248
  v_mfma_f32_16x16x32_bf16 v[24:27], v[104:107], v[80:83], v[24:27]
  ds_read_b64_tr_b16 v[136:137], v153 offset:49152
  v_mfma_f32_16x16x32_bf16 v[40:43], v[104:107], v[84:87], v[40:43]
  ds_read_b64_tr_b16 v[138:139], v153 offset:53248
  s_add_u32 m0, s62, 24576
  s_bitcmp1_b32 s97, 11
  s_cselect_b32 s55, s47, 0
  s_add_u32 s55, s55, s60
  buffer_load_dwordx4 v147, s[28:31], s55 offen lds
  s_add_u32 s60, s60, 65536
  s_cmp_eq_u32 s60, s98
  s_cselect_b32 s60, s96, s60
  v_mfma_f32_16x16x32_bf16 v[56:59], v[104:107], v[88:91], v[56:59]
  ds_read_b64_tr_b16 v[140:141], v154 offset:49152
  v_mfma_f32_16x16x32_bf16 v[72:75], v[104:107], v[92:95], v[72:75]
  ds_read_b64_tr_b16 v[142:143], v154 offset:53248
  v_mfma_f32_16x16x32_bf16 v[28:31], v[108:111], v[80:83], v[28:31]
  v_mfma_f32_16x16x32_bf16 v[44:47], v[108:111], v[84:87], v[44:47]
  v_mfma_f32_16x16x32_bf16 v[60:63], v[108:111], v[88:91], v[60:63]
  v_mfma_f32_16x16x32_bf16 v[76:79], v[108:111], v[92:95], v[76:79]
  s_waitcnt vmcnt(15) lgkmcnt(0)
  s_barrier
  v_mfma_f32_16x16x32_bf16 v[16:19], v[128:131], v[112:115], v[16:19]
  ds_read_b64_tr_b16 v[96:97], v162 offset:0
  v_mfma_f32_16x16x32_bf16 v[32:35], v[128:131], v[116:119], v[32:35]
  ds_read_b64_tr_b16 v[98:99], v162 offset:4096
  s_add_u32 m0, s61, 49152
  s_nop 0
  buffer_load_dwordx4 v144, s[16:19], s59 offen sc1 lds
  v_mfma_f32_16x16x32_bf16 v[48:51], v[128:131], v[120:123], v[48:51]
  ds_read_b128 v[80:83], v161 offset:0
  v_mfma_f32_16x16x32_bf16 v[64:67], v[128:131], v[124:127], v[64:67]
  ds_read_b128 v[84:87], v161 offset:1024
  v_mfma_f32_16x16x32_bf16 v[20:23], v[132:135], v[112:115], v[20:23]
  ds_read_b128 v[88:91], v161 offset:2048
  v_mfma_f32_16x16x32_bf16 v[36:39], v[132:135], v[116:119], v[36:39]
  ds_read_b128 v[92:95], v161 offset:3072
  buffer_load_dwordx4 v144, s[16:19], s59 offen offset:1024 sc1 lds
  s_add_u32 s59, s59, 16384
  s_cmp_eq_u32 s59, s63
  s_cselect_b32 s59, s58, s59
  v_mfma_f32_16x16x32_bf16 v[52:55], v[132:135], v[120:123], v[52:55]
  ds_read_b64_tr_b16 v[100:101], v163 offset:0
  v_mfma_f32_16x16x32_bf16 v[68:71], v[132:135], v[124:127], v[68:71]
  ds_read_b64_tr_b16 v[102:103], v163 offset:4096
  v_mfma_f32_16x16x32_bf16 v[24:27], v[136:139], v[112:115], v[24:27]
  ds_read_b64_tr_b16 v[104:105], v164 offset:0
  v_mfma_f32_16x16x32_bf16 v[40:43], v[136:139], v[116:119], v[40:43]
  ds_read_b64_tr_b16 v[106:107], v164 offset:4096
  s_add_u32 m0, s62, 49152
  s_bitcmp1_b32 s97, 12
  s_cselect_b32 s55, s47, 0
  s_add_u32 s55, s55, s60
  buffer_load_dwordx4 v147, s[28:31], s55 offen lds
  s_add_u32 s60, s60, 65536
  s_cmp_eq_u32 s60, s98
  s_cselect_b32 s60, s96, s60
  v_mfma_f32_16x16x32_bf16 v[56:59], v[136:139], v[120:123], v[56:59]
  ds_read_b64_tr_b16 v[108:109], v165 offset:0
  v_mfma_f32_16x16x32_bf16 v[72:75], v[136:139], v[124:127], v[72:75]
  ds_read_b64_tr_b16 v[110:111], v165 offset:4096
  v_mfma_f32_16x16x32_bf16 v[28:31], v[140:143], v[112:115], v[28:31]
  v_mfma_f32_16x16x32_bf16 v[44:47], v[140:143], v[116:119], v[44:47]
  v_mfma_f32_16x16x32_bf16 v[60:63], v[140:143], v[120:123], v[60:63]
  v_mfma_f32_16x16x32_bf16 v[76:79], v[140:143], v[124:127], v[76:79]
  s_waitcnt vmcnt(14) lgkmcnt(0)
  s_barrier
  v_mfma_f32_16x16x32_bf16 v[16:19], v[96:99], v[80:83], v[16:19]
  ds_read_b64_tr_b16 v[128:129], v162 offset:24576
  v_mfma_f32_16x16x32_bf16 v[32:35], v[96:99], v[84:87], v[32:35]
  ds_read_b64_tr_b16 v[130:131], v162 offset:28672
  s_add_u32 m0, s61, 73728
  s_nop 0
  buffer_load_dwordx4 v144, s[16:19], s59 offen sc1 lds
  s_waitcnt vmcnt(7)
  v_lshlrev_b32 v184, 16, v168
  v_mfma_f32_16x16x32_bf16 v[48:51], v[96:99], v[88:91], v[48:51]
  ds_read_b128 v[112:115], v161 offset:24576
  v_and_b32 v185, 0xffff0000, v168
  v_lshlrev_b32 v186, 16, v169
  v_mfma_f32_16x16x32_bf16 v[64:67], v[96:99], v[92:95], v[64:67]
  ds_read_b128 v[116:119], v161 offset:25600
  v_and_b32 v187, 0xffff0000, v169
  v_lshlrev_b32 v188, 16, v170
  v_mfma_f32_16x16x32_bf16 v[20:23], v[100:103], v[80:83], v[20:23]
  ds_read_b128 v[120:123], v161 offset:26624
  v_and_b32 v189, 0xffff0000, v170
  v_lshlrev_b32 v190, 16, v171
  v_mfma_f32_16x16x32_bf16 v[36:39], v[100:103], v[84:87], v[36:39]
  ds_read_b128 v[124:127], v161 offset:27648
  buffer_load_dwordx4 v144, s[16:19], s59 offen offset:1024 sc1 lds
  s_add_u32 s59, s59, 16384
  s_cmp_eq_u32 s59, s63
  s_cselect_b32 s59, s58, s59
  v_and_b32 v191, 0xffff0000, v171
  v_lshlrev_b32 v192, 16, v172
  v_mfma_f32_16x16x32_bf16 v[52:55], v[100:103], v[88:91], v[52:55]
  ds_read_b64_tr_b16 v[132:133], v163 offset:24576
  v_and_b32 v193, 0xffff0000, v172
  v_add_f32 v184, v184, v192
  v_mfma_f32_16x16x32_bf16 v[68:71], v[100:103], v[92:95], v[68:71]
  ds_read_b64_tr_b16 v[134:135], v163 offset:28672
  v_add_f32 v185, v185, v193
  v_lshlrev_b32 v194, 16, v173
  v_mfma_f32_16x16x32_bf16 v[24:27], v[104:107], v[80:83], v[24:27]
  ds_read_b64_tr_b16 v[136:137], v164 offset:24576
  v_and_b32 v195, 0xffff0000, v173
  v_add_f32 v186, v186, v194
  v_mfma_f32_16x16x32_bf16 v[40:43], v[104:107], v[84:87], v[40:43]
  ds_read_b64_tr_b16 v[138:139], v164 offset:28672
  s_add_u32 m0, s62, 73728
  s_bitcmp1_b32 s97, 13
  s_cselect_b32 s55, s47, 0
  s_add_u32 s55, s55, s60
  buffer_load_dwordx4 v147, s[28:31], s55 offen lds
  s_add_u32 s60, s60, 65536
  s_cmp_eq_u32 s60, s98
  s_cselect_b32 s60, s96, s60
  v_add_f32 v187, v187, v195
  v_lshlrev_b32 v192, 16, v174
  v_mfma_f32_16x16x32_bf16 v[56:59], v[104:107], v[88:91], v[56:59]
  ds_read_b64_tr_b16 v[140:141], v165 offset:24576
  v_and_b32 v193, 0xffff0000, v174
  v_add_f32 v188, v188, v192
  v_mfma_f32_16x16x32_bf16 v[72:75], v[104:107], v[92:95], v[72:75]
  ds_read_b64_tr_b16 v[142:143], v165 offset:28672
  v_add_f32 v189, v189, v193
  v_lshlrev_b32 v194, 16, v175
  v_mfma_f32_16x16x32_bf16 v[28:31], v[108:111], v[80:83], v[28:31]
  v_and_b32 v195, 0xffff0000, v175
  v_add_f32 v190, v190, v194
  v_mfma_f32_16x16x32_bf16 v[44:47], v[108:111], v[84:87], v[44:47]
  v_add_f32 v191, v191, v195
  v_add_f32_dpp v200, v200, v200 row_ror:4 row_mask:0xf bank_mask:0xf
  v_mfma_f32_16x16x32_bf16 v[60:63], v[108:111], v[88:91], v[60:63]
  v_add_f32_dpp v201, v201, v201 row_ror:4 row_mask:0xf bank_mask:0xf
  v_add_f32_dpp v202, v202, v202 row_ror:4 row_mask:0xf bank_mask:0xf
  v_mfma_f32_16x16x32_bf16 v[76:79], v[108:111], v[92:95], v[76:79]
  v_add_f32_dpp v203, v203, v203 row_ror:4 row_mask:0xf bank_mask:0xf
  s_waitcnt vmcnt(12) lgkmcnt(0)
  s_barrier
  v_mfma_f32_16x16x32_bf16 v[16:19], v[128:131], v[112:115], v[16:19]
  ds_read_b64_tr_b16 v[96:97], v151 offset:0
  v_lshlrev_b32 v192, 16, v176
  v_and_b32 v193, 0xffff0000, v176
  v_mfma_f32_16x16x32_bf16 v[32:35], v[128:131], v[116:119], v[32:35]
  ds_read_b64_tr_b16 v[98:99], v151 offset:4096
  s_add_u32 m0, s61, 98304
  s_nop 0
  buffer_load_dwordx4 v144, s[16:19], s59 offen sc1 lds
  v_add_f32 v184, v184, v192
  v_add_f32 v185, v185, v193
  v_mfma_f32_16x16x32_bf16 v[48:51], v[128:131], v[120:123], v[48:51]
  ds_read_b128 v[80:83], v150 offset:0
  v_lshlrev_b32 v194, 16, v177
  v_and_b32 v195, 0xffff0000, v177
  v_mfma_f32_16x16x32_bf16 v[64:67], v[128:131], v[124:127], v[64:67]
  ds_read_b128 v[84:87], v150 offset:1024
  v_add_f32 v186, v186, v194
  v_add_f32 v187, v187, v195
  v_mfma_f32_16x16x32_bf16 v[20:23], v[132:135], v[112:115], v[20:23]
  ds_read_b128 v[88:91], v150 offset:2048
  v_lshlrev_b32 v192, 16, v178
  v_and_b32 v193, 0xffff0000, v178
  v_mfma_f32_16x16x32_bf16 v[36:39], v[132:135], v[116:119], v[36:39]
  ds_read_b128 v[92:95], v150 offset:3072
  buffer_load_dwordx4 v144, s[16:19], s59 offen offset:1024 sc1 lds
  s_add_u32 s59, s59, 16384
  s_cmp_eq_u32 s59, s63
  s_cselect_b32 s59, s58, s59
  v_add_f32 v188, v188, v192
  v_add_f32 v189, v189, v193
  v_mfma_f32_16x16x32_bf16 v[52:55], v[132:135], v[120:123], v[52:55]
  ds_read_b64_tr_b16 v[100:101], v152 offset:0
  v_lshlrev_b32 v194, 16, v179
  v_and_b32 v195, 0xffff0000, v179
  v_mfma_f32_16x16x32_bf16 v[68:71], v[132:135], v[124:127], v[68:71]
  ds_read_b64_tr_b16 v[102:103], v152 offset:4096
  v_add_f32 v190, v190, v194
  v_add_f32 v191, v191, v195
  v_mfma_f32_16x16x32_bf16 v[24:27], v[136:139], v[112:115], v[24:27]
  ds_read_b64_tr_b16 v[104:105], v153 offset:0
  v_add_f32_dpp v200, v200, v200 row_ror:2 row_mask:0xf bank_mask:0xf
  v_add_f32_dpp v201, v201, v201 row_ror:2 row_mask:0xf bank_mask:0xf
  v_mfma_f32_16x16x32_bf16 v[40:43], v[136:139], v[116:119], v[40:43]
  ds_read_b64_tr_b16 v[106:107], v153 offset:4096
  s_add_u32 m0, s62, 98304
  s_bitcmp1_b32 s97, 14
  s_cselect_b32 s55, s47, 0
  s_add_u32 s55, s55, s60
  buffer_load_dwordx4 v147, s[28:31], s55 offen lds
  s_add_u32 s60, s60, 65536
  s_cmp_eq_u32 s60, s98
  s_cselect_b32 s60, s96, s60
  v_add_f32_dpp v202, v202, v202 row_ror:2 row_mask:0xf bank_mask:0xf
  v_add_f32_dpp v203, v203, v203 row_ror:2 row_mask:0xf bank_mask:0xf
  v_mfma_f32_16x16x32_bf16 v[56:59], v[136:139], v[120:123], v[56:59]
  ds_read_b64_tr_b16 v[108:109], v154 offset:0
  v_add_f32_dpp v200, v200, v200 row_ror:1 row_mask:0xf bank_mask:0xf
  v_add_f32_dpp v201, v201, v201 row_ror:1 row_mask:0xf bank_mask:0xf
  v_mfma_f32_16x16x32_bf16 v[72:75], v[136:139], v[124:127], v[72:75]
  ds_read_b64_tr_b16 v[110:111], v154 offset:4096
  v_add_f32_dpp v202, v202, v202 row_ror:1 row_mask:0xf bank_mask:0xf
  v_add_f32_dpp v203, v203, v203 row_ror:1 row_mask:0xf bank_mask:0xf
  v_mfma_f32_16x16x32_bf16 v[28:31], v[140:143], v[112:115], v[28:31]
  v_cvt_pk_bf16_f32 v204, v200, v201
  v_cvt_pk_bf16_f32 v205, v202, v203
  v_mfma_f32_16x16x32_bf16 v[44:47], v[140:143], v[116:119], v[44:47]
  v_and_b32 v1, 3, v0
  v_cmp_eq_u32 vcc, 1, v1
  v_mfma_f32_16x16x32_bf16 v[60:63], v[140:143], v[120:123], v[60:63]
  v_mov_b32 v2, 0x3f803f80
  v_cndmask_b32 v204, v204, v2, vcc
  v_mfma_f32_16x16x32_bf16 v[76:79], v[140:143], v[124:127], v[76:79]
  v_cndmask_b32 v205, v205, v2, vcc
  s_waitcnt vmcnt(9) lgkmcnt(0)
  s_barrier
  v_mfma_f32_16x16x32_bf16 v[16:19], v[96:99], v[80:83], v[16:19]
  ds_read_b64_tr_b16 v[128:129], v151 offset:24576
  v_lshlrev_b32 v192, 16, v180
  v_and_b32 v193, 0xffff0000, v180
  v_add_f32 v184, v184, v192
  v_mfma_f32_16x16x32_bf16 v[32:35], v[96:99], v[84:87], v[32:35]
  ds_read_b64_tr_b16 v[130:131], v151 offset:28672
  s_add_u32 m0, s61, 0
  s_nop 0
  buffer_load_dwordx4 v144, s[16:19], s59 offen sc1 lds
  v_add_f32 v185, v185, v193
  v_lshlrev_b32 v194, 16, v181
  v_mfma_f32_16x16x32_bf16 v[48:51], v[96:99], v[88:91], v[48:51]
  ds_read_b128 v[112:115], v150 offset:24576
  v_and_b32 v195, 0xffff0000, v181
  v_add_f32 v186, v186, v194
  v_add_f32 v187, v187, v195
  v_mfma_f32_16x16x32_bf16 v[64:67], v[96:99], v[92:95], v[64:67]
  ds_read_b128 v[116:119], v150 offset:25600
  v_lshlrev_b32 v192, 16, v182
  v_and_b32 v193, 0xffff0000, v182
  v_mfma_f32_16x16x32_bf16 v[20:23], v[100:103], v[80:83], v[20:23]
  ds_read_b128 v[120:123], v150 offset:26624
  v_add_f32 v188, v188, v192
  v_add_f32 v189, v189, v193
  v_mfma_f32_16x16x32_bf16 v[36:39], v[100:103], v[84:87], v[36:39]
  ds_read_b128 v[124:127], v150 offset:27648
  buffer_load_dwordx4 v144, s[16:19], s59 offen offset:1024 sc1 lds
  s_add_u32 s59, s59, 16384
  s_cmp_eq_u32 s59, s63
  s_cselect_b32 s59, s58, s59
  v_lshlrev_b32 v194, 16, v183
  v_and_b32 v195, 0xffff0000, v183
  v_add_f32 v190, v190, v194
  v_mfma_f32_16x16x32_bf16 v[52:55], v[100:103], v[88:91], v[52:55]
  ds_read_b64_tr_b16 v[132:133], v152 offset:24576
  v_add_f32 v191, v191, v195
  v_permlane32_swap_b32 v184, v188
  v_mfma_f32_16x16x32_bf16 v[68:71], v[100:103], v[92:95], v[68:71]
  ds_read_b64_tr_b16 v[134:135], v152 offset:28672
  v_permlane32_swap_b32 v185, v189
  v_permlane32_swap_b32 v186, v190
  v_permlane32_swap_b32 v187, v191
  v_mfma_f32_16x16x32_bf16 v[24:27], v[104:107], v[80:83], v[24:27]
  ds_read_b64_tr_b16 v[136:137], v153 offset:24576
  s_lshr_b32 s51, s45, 1
  s_lshl_b32 s51, s51, 10
  s_and_b32 s52, s45, 1
  s_lshl_b32 s52, s52, 3
  s_add_u32 s51, s51, s52
  s_add_u32 s51, s51, 155648
  v_add_u32 v1, s51, v144
  v_mfma_f32_16x16x32_bf16 v[40:43], v[104:107], v[84:87], v[40:43]
  ds_read_b64_tr_b16 v[138:139], v153 offset:28672
  s_add_u32 m0, s62, 0
  s_bitcmp1_b32 s97, 15
  s_cselect_b32 s55, s47, 0
  s_add_u32 s55, s55, s60
  buffer_load_dwordx4 v147, s[28:31], s55 offen lds
  s_add_u32 s60, s60, 65536
  s_cmp_eq_u32 s60, s98
  s_cselect_b32 s60, s96, s60
  ds_write_b64 v1, v[204:205] offset:4096
  s_lshr_b32 s52, s44, 2
  s_lshl_b32 s52, s52, 9
  s_add_u32 s51, s51, s52
  v_mfma_f32_16x16x32_bf16 v[56:59], v[104:107], v[88:91], v[56:59]
  ds_read_b64_tr_b16 v[140:141], v154 offset:24576
  v_add_f32 v184, v184, v188
  v_add_f32 v185, v185, v189
  v_add_f32 v186, v186, v190
  v_mfma_f32_16x16x32_bf16 v[72:75], v[104:107], v[92:95], v[72:75]
  ds_read_b64_tr_b16 v[142:143], v154 offset:28672
  v_add_f32 v187, v187, v191
  v_lshrrev_b32 v2, 5, v0
  v_mfma_f32_16x16x32_bf16 v[28:31], v[108:111], v[80:83], v[28:31]
  v_and_b32 v1, 31, v0
  v_lshlrev_b32 v1, 4, v1
  v_lshl_add_u32 v1, v2, 11, v1
  v_mfma_f32_16x16x32_bf16 v[44:47], v[108:111], v[84:87], v[44:47]
  v_add_u32 v1, s51, v1
  v_cvt_pk_bf16_f32 v192, v184, v185
  v_mfma_f32_16x16x32_bf16 v[60:63], v[108:111], v[88:91], v[60:63]
  v_cvt_pk_bf16_f32 v193, v186, v187
  ds_write_b64 v1, v[192:193]
  v_mfma_f32_16x16x32_bf16 v[76:79], v[108:111], v[92:95], v[76:79]
  s_waitcnt vmcnt(9) lgkmcnt(0)
  s_barrier
  v_mfma_f32_16x16x32_bf16 v[16:19], v[128:131], v[112:115], v[16:19]
  ds_read_b64_tr_b16 v[96:97], v151 offset:49152
  v_mfma_f32_16x16x32_bf16 v[32:35], v[128:131], v[116:119], v[32:35]
  ds_read_b64_tr_b16 v[98:99], v151 offset:53248
  s_add_u32 m0, s61, 24576
  s_nop 0
  buffer_load_dwordx4 v144, s[16:19], s59 offen sc1 lds
  v_mfma_f32_16x16x32_bf16 v[48:51], v[128:131], v[120:123], v[48:51]
  ds_read_b128 v[80:83], v150 offset:49152
  v_add_u32 v1, 155648, v144
  v_mfma_f32_16x16x32_bf16 v[64:67], v[128:131], v[124:127], v[64:67]
  ds_read_b128 v[84:87], v150 offset:50176
  s_lshl_b32 s51, s44, 12
  s_add_u32 s51, s51, 122880
  v_mfma_f32_16x16x32_bf16 v[20:23], v[132:135], v[112:115], v[20:23]
  ds_read_b128 v[88:91], v150 offset:51200
  v_add_u32 v2, s51, v144
  v_mfma_f32_16x16x32_bf16 v[36:39], v[132:135], v[116:119], v[36:39]
  ds_read_b128 v[92:95], v150 offset:52224
  buffer_load_dwordx4 v144, s[16:19], s59 offen offset:1024 sc1 lds
  s_add_u32 s59, s59, 16384
  s_cmp_eq_u32 s59, s63
  s_cselect_b32 s59, s58, s59
  ds_read_b128 v[168:171], v1 offset:0
  v_mfma_f32_16x16x32_bf16 v[52:55], v[132:135], v[120:123], v[52:55]
  ds_read_b64_tr_b16 v[100:101], v152 offset:49152
  ds_read_b128 v[172:175], v1 offset:1024
  v_mfma_f32_16x16x32_bf16 v[68:71], v[132:135], v[124:127], v[68:71]
  ds_read_b64_tr_b16 v[102:103], v152 offset:53248
  ds_read_b128 v[176:179], v1 offset:2048
  v_mfma_f32_16x16x32_bf16 v[24:27], v[136:139], v[112:115], v[24:27]
  s_branch L_tover_5
L_touch_5:
  s_branch L_tret_A0
L_tover_5:
  ds_read_b64_tr_b16 v[104:105], v153 offset:49152
  ds_read_b128 v[180:183], v1 offset:3072
  v_mfma_f32_16x16x32_bf16 v[40:43], v[136:139], v[116:119], v[40:43]
  ds_read_b64_tr_b16 v[106:107], v153 offset:53248
  s_add_u32 m0, s62, 24576
  s_bitcmp1_b32 s97, 16
  s_cselect_b32 s55, s47, 0
  s_add_u32 s55, s55, s60
  buffer_load_dwordx4 v147, s[28:31], s55 offen lds
  s_add_u32 s60, s60, 65536
  s_cmp_eq_u32 s60, s98
  s_cselect_b32 s60, s96, s60
  ds_read_b128 v[184:187], v1 offset:4096
  v_mfma_f32_16x16x32_bf16 v[56:59], v[136:139], v[120:123], v[56:59]
  ds_read_b64_tr_b16 v[108:109], v154 offset:49152
  ds_read_b128 v[188:191], v1 offset:5120
  v_mfma_f32_16x16x32_bf16 v[72:75], v[136:139], v[124:127], v[72:75]
  ds_read_b64_tr_b16 v[110:111], v154 offset:53248
  ds_read_b128 v[192:195], v2 offset:0
  v_mfma_f32_16x16x32_bf16 v[28:31], v[140:143], v[112:115], v[28:31]
  ds_read_b128 v[196:199], v2 offset:1024
  v_mfma_f32_16x16x32_bf16 v[44:47], v[140:143], v[116:119], v[44:47]
  ds_read_b128 v[200:203], v2 offset:2048
  v_mfma_f32_16x16x32_bf16 v[60:63], v[140:143], v[120:123], v[60:63]
  ds_read_b128 v[204:207], v2 offset:3072
  v_mfma_f32_16x16x32_bf16 v[76:79], v[140:143], v[124:127], v[76:79]
  s_waitcnt vmcnt(9) lgkmcnt(0)
  s_barrier
  v_mfma_f32_16x16x32_bf16 v[16:19], v[96:99], v[80:83], v[16:19]
  ds_read_b64_tr_b16 v[128:129], v162 offset:0
  v_mfma_f32_16x16x32_bf16 v[216:219], v[184:187], v[192:195], 0
  v_mfma_f32_16x16x32_bf16 v[228:231], v[188:191], v[196:199], 0
  v_mfma_f32_16x16x32_bf16 v[32:35], v[96:99], v[84:87], v[32:35]
  ds_read_b64_tr_b16 v[130:131], v162 offset:4096
  s_add_u32 m0, s61, 49152
  s_nop 0
  buffer_load_dwordx4 v144, s[16:19], s59 offen sc1 lds
  v_mfma_f32_16x16x32_bf16 v[240:243], v[184:187], v[200:203], 0
  v_mfma_f32_16x16x32_bf16 v[252:255], v[188:191], v[204:207], 0
  v_mfma_f32_16x16x32_bf16 v[48:51], v[96:99], v[88:91], v[48:51]
  ds_read_b128 v[112:115], v161 offset:0
  v_mfma_f32_16x16x32_bf16 v[208:211], v[168:171], v[192:195], 0
  v_mfma_f32_16x16x32_bf16 v[64:67], v[96:99], v[92:95], v[64:67]
  ds_read_b128 v[116:119], v161 offset:1024
  v_mfma_f32_16x16x32_bf16 v[220:223], v[172:175], v[196:199], 0
  v_mfma_f32_16x16x32_bf16 v[20:23], v[100:103], v[80:83], v[20:23]
  ds_read_b128 v[120:123], v161 offset:2048
  v_mfma_f32_16x16x32_bf16 v[212:215], v[176:179], v[192:195], 0
  v_mfma_f32_16x16x32_bf16 v[36:39], v[100:103], v[84:87], v[36:39]
  ds_read_b128 v[124:127], v161 offset:3072
  buffer_load_dwordx4 v144, s[16:19], s59 offen offset:1024 sc1 lds
  s_add_u32 s59, s59, 16384
  s_cmp_eq_u32 s59, s63
  s_cselect_b32 s59, s58, s59
  v_mfma_f32_16x16x32_bf16 v[224:227], v[180:183], v[196:199], 0
  v_mfma_f32_16x16x32_bf16 v[52:55], v[100:103], v[88:91], v[52:55]
  ds_read_b64_tr_b16 v[132:133], v163 offset:0
  v_mfma_f32_16x16x32_bf16 v[232:235], v[168:171], v[200:203], 0
  v_mfma_f32_16x16x32_bf16 v[68:71], v[100:103], v[92:95], v[68:71]
  ds_read_b64_tr_b16 v[134:135], v163 offset:4096
  v_mfma_f32_16x16x32_bf16 v[244:247], v[172:175], v[204:207], 0
  v_rcp_f32 v2, v217
  v_rcp_f32 v6, v229
  v_mfma_f32_16x16x32_bf16 v[24:27], v[104:107], v[80:83], v[24:27]
  ds_read_b64_tr_b16 v[136:137], v164 offset:0
  v_mfma_f32_16x16x32_bf16 v[236:239], v[176:179], v[200:203], 0
  v_rcp_f32 v4, v241
  v_rcp_f32 v8, v253
  v_mfma_f32_16x16x32_bf16 v[40:43], v[104:107], v[84:87], v[40:43]
  ds_read_b64_tr_b16 v[138:139], v164 offset:4096
  s_add_u32 m0, s62, 49152
  s_bitcmp1_b32 s97, 17
  s_cselect_b32 s55, s47, 0
  s_add_u32 s55, s55, s60
  buffer_load_dwordx4 v147, s[28:31], s55 offen lds
  s_add_u32 s60, s60, 65536
  s_cmp_eq_u32 s60, s98
  s_cselect_b32 s60, s96, s60
  v_mfma_f32_16x16x32_bf16 v[248:251], v[180:183], v[204:207], 0
  v_mul_f32 v3, v216, v2
  v_mul_f32 v5, v240, v4
  v_mfma_f32_16x16x32_bf16 v[56:59], v[104:107], v[88:91], v[56:59]
  ds_read_b64_tr_b16 v[140:141], v165 offset:0
  v_fma_f32 v3, v228, v6, v3
  v_fma_f32 v5, v252, v8, v5
  v_mfma_f32_16x16x32_bf16 v[72:75], v[104:107], v[92:95], v[72:75]
  ds_read_b64_tr_b16 v[142:143], v165 offset:4096
  v_add_f32 v3, 0x358637bd, v3
  v_mfma_f32_16x16x32_bf16 v[28:31], v[108:111], v[80:83], v[28:31]
  v_add_f32 v5, 0x358637bd, v5
  v_rcp_f32 v3, v3
  v_mfma_f32_16x16x32_bf16 v[44:47], v[108:111], v[84:87], v[44:47]
  v_rcp_f32 v5, v5
  v_mul_f32 v2, v2, v3
  v_mfma_f32_16x16x32_bf16 v[60:63], v[108:111], v[88:91], v[60:63]
  v_mul_f32 v6, v6, v3
  v_mul_f32 v4, v4, v5
  v_mfma_f32_16x16x32_bf16 v[76:79], v[108:111], v[92:95], v[76:79]
  v_mul_f32 v8, v8, v5
  s_waitcnt vmcnt(9) lgkmcnt(0)
  s_barrier
  v_mfma_f32_16x16x32_bf16 v[16:19], v[128:131], v[112:115], v[16:19]
  ds_read_b64_tr_b16 v[96:97], v162 offset:24576
  s_lshl_b32 s51, s46, 5
  s_add_u32 s51, s51, s50
  s_lshl_b32 s51, s51, 3
  s_add_u32 s51, s51, s44
  s_lshl_b32 s51, s51, 11
  s_add_u32 s54, s51, 0x1400000
  v_mul_f32 v208, v208, v2
  v_mfma_f32_16x16x32_bf16 v[32:35], v[128:131], v[116:119], v[32:35]
  ds_read_b64_tr_b16 v[98:99], v162 offset:28672
  s_add_u32 m0, s61, 73728
  s_nop 0
  buffer_load_dwordx4 v144, s[16:19], s59 offen sc1 lds
  v_mul_f32 v209, v209, v2
  v_mfma_f32_16x16x32_bf16 v[48:51], v[128:131], v[120:123], v[48:51]
  ds_read_b128 v[80:83], v161 offset:24576
  v_mul_f32 v210, v210, v2
  v_mul_f32 v211, v211, v2
  v_mfma_f32_16x16x32_bf16 v[64:67], v[128:131], v[124:127], v[64:67]
  ds_read_b128 v[84:87], v161 offset:25600
  v_mul_f32 v212, v212, v2
  v_mfma_f32_16x16x32_bf16 v[20:23], v[132:135], v[112:115], v[20:23]
  ds_read_b128 v[88:91], v161 offset:26624
  v_mul_f32 v213, v213, v2
  v_mfma_f32_16x16x32_bf16 v[36:39], v[132:135], v[116:119], v[36:39]
  ds_read_b128 v[92:95], v161 offset:27648
  buffer_load_dwordx4 v144, s[16:19], s59 offen offset:1024 sc1 lds
  s_add_u32 s59, s59, 16384
  s_cmp_eq_u32 s59, s63
  s_cselect_b32 s59, s58, s59
  v_mul_f32 v214, v214, v2
  v_mul_f32 v215, v215, v2
  v_mfma_f32_16x16x32_bf16 v[52:55], v[132:135], v[120:123], v[52:55]
  ds_read_b64_tr_b16 v[100:101], v163 offset:24576
  v_fmac_f32 v208, v220, v6
  v_mfma_f32_16x16x32_bf16 v[68:71], v[132:135], v[124:127], v[68:71]
  ds_read_b64_tr_b16 v[102:103], v163 offset:28672
  v_fmac_f32 v209, v221, v6
  v_mfma_f32_16x16x32_bf16 v[24:27], v[136:139], v[112:115], v[24:27]
  ds_read_b64_tr_b16 v[104:105], v164 offset:24576
  v_fmac_f32 v210, v222, v6
  v_fmac_f32 v211, v223, v6
  v_mfma_f32_16x16x32_bf16 v[40:43], v[136:139], v[116:119], v[40:43]
  ds_read_b64_tr_b16 v[106:107], v164 offset:28672
  s_add_u32 m0, s62, 73728
  s_bitcmp1_b32 s97, 18
  s_cselect_b32 s55, s47, 0
  s_add_u32 s55, s55, s60
  buffer_load_dwordx4 v147, s[28:31], s55 offen lds
  s_add_u32 s60, s60, 65536
  s_cmp_eq_u32 s60, s98
  s_cselect_b32 s60, s96, s60
  v_fmac_f32 v212, v224, v6
  v_mfma_f32_16x16x32_bf16 v[56:59], v[136:139], v[120:123], v[56:59]
  ds_read_b64_tr_b16 v[108:109], v165 offset:24576
  v_fmac_f32 v213, v225, v6
  v_fmac_f32 v214, v226, v6
  v_mfma_f32_16x16x32_bf16 v[72:75], v[136:139], v[124:127], v[72:75]
  ds_read_b64_tr_b16 v[110:111], v165 offset:28672
  v_fmac_f32 v215, v227, v6
  v_mfma_f32_16x16x32_bf16 v[28:31], v[140:143], v[112:115], v[28:31]
  v_cvt_pk_bf16_f32 v12, v208, v209
  v_mfma_f32_16x16x32_bf16 v[44:47], v[140:143], v[116:119], v[44:47]
  v_cvt_pk_bf16_f32 v13, v210, v211
  v_cvt_pk_bf16_f32 v14, v212, v213
  v_mfma_f32_16x16x32_bf16 v[60:63], v[140:143], v[120:123], v[60:63]
  v_cvt_pk_bf16_f32 v15, v214, v215
  v_mfma_f32_16x16x32_bf16 v[76:79], v[140:143], v[124:127], v[76:79]
  buffer_store_dwordx4 v[12:15], v144, s[16:19], s54 offen offset:0 sc1
  s_waitcnt vmcnt(10) lgkmcnt(0)
  s_barrier
  v_mfma_f32_16x16x32_bf16 v[16:19], v[96:99], v[80:83], v[16:19]
  ds_read_b64_tr_b16 v[128:129], v151 offset:0
  v_mul_f32 v232, v232, v4
  v_mul_f32 v233, v233, v4
  v_mfma_f32_16x16x32_bf16 v[32:35], v[96:99], v[84:87], v[32:35]
  ds_read_b64_tr_b16 v[130:131], v151 offset:4096
  s_add_u32 m0, s61, 98304
  s_nop 0
  buffer_load_dwordx4 v144, s[16:19], s59 offen sc1 lds
  v_mul_f32 v234, v234, v4
  v_mfma_f32_16x16x32_bf16 v[48:51], v[96:99], v[88:91], v[48:51]
  ds_read_b128 v[112:115], v150 offset:0
  v_mul_f32 v235, v235, v4
  v_mfma_f32_16x16x32_bf16 v[64:67], v[96:99], v[92:95], v[64:67]
  ds_read_b128 v[116:119], v150 offset:1024
  v_mul_f32 v236, v236, v4
  v_mul_f32 v237, v237, v4
  v_mfma_f32_16x16x32_bf16 v[20:23], v[100:103], v[80:83], v[20:23]
  ds_read_b128 v[120:123], v150 offset:2048
  v_mul_f32 v238, v238, v4
  v_mfma_f32_16x16x32_bf16 v[36:39], v[100:103], v[84:87], v[36:39]
  ds_read_b128 v[124:127], v150 offset:3072
  buffer_load_dwordx4 v144, s[16:19], s59 offen offset:1024 sc1 lds
  s_add_u32 s59, s59, 16384
  s_cmp_eq_u32 s59, s63
  s_cselect_b32 s59, s58, s59
  v_mul_f32 v239, v239, v4
  v_mfma_f32_16x16x32_bf16 v[52:55], v[100:103], v[88:91], v[52:55]
  ds_read_b64_tr_b16 v[132:133], v152 offset:0
  v_fmac_f32 v232, v244, v8
  v_fmac_f32 v233, v245, v8
  v_mfma_f32_16x16x32_bf16 v[68:71], v[100:103], v[92:95], v[68:71]
  ds_read_b64_tr_b16 v[134:135], v152 offset:4096
  v_fmac_f32 v234, v246, v8
  v_mfma_f32_16x16x32_bf16 v[24:27], v[104:107], v[80:83], v[24:27]
  ds_read_b64_tr_b16 v[136:137], v153 offset:0
  v_fmac_f32 v235, v247, v8
  v_mfma_f32_16x16x32_bf16 v[40:43], v[104:107], v[84:87], v[40:43]
  ds_read_b64_tr_b16 v[138:139], v153 offset:4096
  s_add_u32 m0, s62, 98304
  s_bitcmp1_b32 s97, 19
  s_cselect_b32 s55, s47, 0
  s_add_u32 s55, s55, s60
  buffer_load_dwordx4 v147, s[28:31], s55 offen lds
  s_add_u32 s60, s60, 65536
  s_cmp_eq_u32 s60, s98
  s_cselect_b32 s60, s96, s60
  v_fmac_f32 v236, v248, v8
  v_fmac_f32 v237, v249, v8
  v_mfma_f32_16x16x32_bf16 v[56:59], v[104:107], v[88:91], v[56:59]
  ds_read_b64_tr_b16 v[140:141], v154 offset:0
  v_fmac_f32 v238, v250, v8
  v_mfma_f32_16x16x32_bf16 v[72:75], v[104:107], v[92:95], v[72:75]
  ds_read_b64_tr_b16 v[142:143], v154 offset:4096
  v_fmac_f32 v239, v251, v8
  v_mfma_f32_16x16x32_bf16 v[28:31], v[108:111], v[80:83], v[28:31]
  v_cvt_pk_bf16_f32 v220, v232, v233
  v_cvt_pk_bf16_f32 v221, v234, v235
  v_mfma_f32_16x16x32_bf16 v[44:47], v[108:111], v[84:87], v[44:47]
  v_cvt_pk_bf16_f32 v222, v236, v237
  v_mfma_f32_16x16x32_bf16 v[60:63], v[108:111], v[88:91], v[60:63]
  v_cvt_pk_bf16_f32 v223, v238, v239
  v_mfma_f32_16x16x32_bf16 v[76:79], v[108:111], v[92:95], v[76:79]
  buffer_store_dwordx4 v[220:223], v144, s[16:19], s54 offen offset:1024 sc1
  s_waitcnt vmcnt(11) lgkmcnt(0)
  s_barrier
  v_mfma_f32_16x16x32_bf16 v[16:19], v[128:131], v[112:115], v[16:19]
  ds_read_b64_tr_b16 v[96:97], v151 offset:24576
  v_mfma_f32_16x16x32_bf16 v[32:35], v[128:131], v[116:119], v[32:35]
  ds_read_b64_tr_b16 v[98:99], v151 offset:28672
  s_add_u32 m0, s61, 0
  s_nop 0
  buffer_load_dwordx4 v144, s[16:19], s59 offen sc1 lds
  v_mfma_f32_16x16x32_bf16 v[48:51], v[128:131], v[120:123], v[48:51]
  ds_read_b128 v[80:83], v150 offset:24576
  v_mfma_f32_16x16x32_bf16 v[64:67], v[128:131], v[124:127], v[64:67]
  ds_read_b128 v[84:87], v150 offset:25600
  v_mfma_f32_16x16x32_bf16 v[20:23], v[132:135], v[112:115], v[20:23]
  ds_read_b128 v[88:91], v150 offset:26624
  v_mfma_f32_16x16x32_bf16 v[36:39], v[132:135], v[116:119], v[36:39]
  ds_read_b128 v[92:95], v150 offset:27648
  buffer_load_dwordx4 v144, s[16:19], s59 offen offset:1024 sc1 lds
  s_add_u32 s59, s59, 16384
  s_cmp_eq_u32 s59, s63
  s_cselect_b32 s59, s58, s59
  v_mfma_f32_16x16x32_bf16 v[52:55], v[132:135], v[120:123], v[52:55]
  ds_read_b64_tr_b16 v[100:101], v152 offset:24576
  v_mfma_f32_16x16x32_bf16 v[68:71], v[132:135], v[124:127], v[68:71]
  ds_read_b64_tr_b16 v[102:103], v152 offset:28672
  v_mfma_f32_16x16x32_bf16 v[24:27], v[136:139], v[112:115], v[24:27]
  ds_read_b64_tr_b16 v[104:105], v153 offset:24576
  v_mfma_f32_16x16x32_bf16 v[40:43], v[136:139], v[116:119], v[40:43]
  ds_read_b64_tr_b16 v[106:107], v153 offset:28672
  s_add_u32 m0, s62, 0
  s_bitcmp1_b32 s97, 20
  s_cselect_b32 s55, s47, 0
  s_add_u32 s55, s55, s60
  buffer_load_dwordx4 v147, s[28:31], s55 offen lds
  s_add_u32 s60, s60, 65536
  s_cmp_eq_u32 s60, s98
  s_cselect_b32 s60, s96, s60
  v_mfma_f32_16x16x32_bf16 v[56:59], v[136:139], v[120:123], v[56:59]
  ds_read_b64_tr_b16 v[108:109], v154 offset:24576
  v_mfma_f32_16x16x32_bf16 v[72:75], v[136:139], v[124:127], v[72:75]
  ds_read_b64_tr_b16 v[110:111], v154 offset:28672
  v_mfma_f32_16x16x32_bf16 v[28:31], v[140:143], v[112:115], v[28:31]
  v_mfma_f32_16x16x32_bf16 v[44:47], v[140:143], v[116:119], v[44:47]
  v_mfma_f32_16x16x32_bf16 v[60:63], v[140:143], v[120:123], v[60:63]
  v_mfma_f32_16x16x32_bf16 v[76:79], v[140:143], v[124:127], v[76:79]
  s_waitcnt vmcnt(11) lgkmcnt(0)
  s_barrier
  v_mfma_f32_16x16x32_bf16 v[16:19], v[96:99], v[80:83], v[16:19]
  ds_read_b64_tr_b16 v[128:129], v151 offset:49152
  v_mfma_f32_16x16x32_bf16 v[32:35], v[96:99], v[84:87], v[32:35]
  ds_read_b64_tr_b16 v[130:131], v151 offset:53248
  s_add_u32 m0, s61, 24576
  s_nop 0
  buffer_load_dwordx4 v144, s[16:19], s59 offen sc1 lds
  v_mfma_f32_16x16x32_bf16 v[48:51], v[96:99], v[88:91], v[48:51]
  ds_read_b128 v[112:115], v150 offset:49152
  v_mfma_f32_16x16x32_bf16 v[64:67], v[96:99], v[92:95], v[64:67]
  ds_read_b128 v[116:119], v150 offset:50176
  v_mfma_f32_16x16x32_bf16 v[20:23], v[100:103], v[80:83], v[20:23]
  ds_read_b128 v[120:123], v150 offset:51200
  v_mfma_f32_16x16x32_bf16 v[36:39], v[100:103], v[84:87], v[36:39]
  ds_read_b128 v[124:127], v150 offset:52224
  buffer_load_dwordx4 v144, s[16:19], s59 offen offset:1024 sc1 lds
  s_add_u32 s59, s59, 16384
  s_cmp_eq_u32 s59, s63
  s_cselect_b32 s59, s58, s59
  v_mfma_f32_16x16x32_bf16 v[52:55], v[100:103], v[88:91], v[52:55]
  ds_read_b64_tr_b16 v[132:133], v152 offset:49152
  v_mfma_f32_16x16x32_bf16 v[68:71], v[100:103], v[92:95], v[68:71]
  ds_read_b64_tr_b16 v[134:135], v152 offset:53248
  v_mfma_f32_16x16x32_bf16 v[24:27], v[104:107], v[80:83], v[24:27]
  ds_read_b64_tr_b16 v[136:137], v153 offset:49152
  v_mfma_f32_16x16x32_bf16 v[40:43], v[104:107], v[84:87], v[40:43]
  ds_read_b64_tr_b16 v[138:139], v153 offset:53248
  s_add_u32 m0, s62, 24576
  s_bitcmp1_b32 s97, 21
  s_cselect_b32 s55, s47, 0
  s_add_u32 s55, s55, s60
  buffer_load_dwordx4 v147, s[28:31], s55 offen lds
  s_add_u32 s60, s60, 65536
  s_cmp_eq_u32 s60, s98
  s_cselect_b32 s60, s96, s60
  v_mfma_f32_16x16x32_bf16 v[56:59], v[104:107], v[88:91], v[56:59]
  ds_read_b64_tr_b16 v[140:141], v154 offset:49152
  v_mfma_f32_16x16x32_bf16 v[72:75], v[104:107], v[92:95], v[72:75]
  ds_read_b64_tr_b16 v[142:143], v154 offset:53248
  v_mfma_f32_16x16x32_bf16 v[28:31], v[108:111], v[80:83], v[28:31]
  v_mfma_f32_16x16x32_bf16 v[44:47], v[108:111], v[84:87], v[44:47]
  v_mfma_f32_16x16x32_bf16 v[60:63], v[108:111], v[88:91], v[60:63]
  v_mfma_f32_16x16x32_bf16 v[76:79], v[108:111], v[92:95], v[76:79]
  s_waitcnt vmcnt(6) lgkmcnt(0)
  s_barrier
  v_mfma_f32_16x16x32_bf16 v[16:19], v[128:131], v[112:115], v[16:19]
  ds_read_b64_tr_b16 v[96:97], v162 offset:0
  v_mfma_f32_16x16x32_bf16 v[32:35], v[128:131], v[116:119], v[32:35]
  ds_read_b64_tr_b16 v[98:99], v162 offset:4096
  s_add_u32 m0, s61, 49152
  s_nop 0
  buffer_load_dwordx4 v144, s[16:19], s59 offen sc1 lds
  v_mfma_f32_16x16x32_bf16 v[48:51], v[128:131], v[120:123], v[48:51]
  ds_read_b128 v[80:83], v161 offset:0
  s_cmp_eq_u32 s44, 0
  s_cbranch_scc1 L_w0_f4
L_w0r_f4:
  v_mfma_f32_16x16x32_bf16 v[64:67], v[128:131], v[124:127], v[64:67]
  ds_read_b128 v[84:87], v161 offset:1024
  v_mfma_f32_16x16x32_bf16 v[20:23], v[132:135], v[112:115], v[20:23]
  ds_read_b128 v[88:91], v161 offset:2048
  v_mfma_f32_16x16x32_bf16 v[36:39], v[132:135], v[116:119], v[36:39]
  ds_read_b128 v[92:95], v161 offset:3072
  buffer_load_dwordx4 v144, s[16:19], s59 offen offset:1024 sc1 lds
  s_add_u32 s59, s59, 16384
  s_cmp_eq_u32 s59, s63
  s_cselect_b32 s59, s58, s59
  v_mfma_f32_16x16x32_bf16 v[52:55], v[132:135], v[120:123], v[52:55]
  ds_read_b64_tr_b16 v[100:101], v163 offset:0
  v_mfma_f32_16x16x32_bf16 v[68:71], v[132:135], v[124:127], v[68:71]
  ds_read_b64_tr_b16 v[102:103], v163 offset:4096
  v_mfma_f32_16x16x32_bf16 v[24:27], v[136:139], v[112:115], v[24:27]
  ds_read_b64_tr_b16 v[104:105], v164 offset:0
  v_mfma_f32_16x16x32_bf16 v[40:43], v[136:139], v[116:119], v[40:43]
  ds_read_b64_tr_b16 v[106:107], v164 offset:4096
  s_add_u32 m0, s62, 49152
  s_bitcmp1_b32 s97, 22
  s_cselect_b32 s55, s47, 0
  s_add_u32 s55, s55, s60
  buffer_load_dwordx4 v147, s[28:31], s55 offen lds
  s_add_u32 s60, s60, 65536
  s_cmp_eq_u32 s60, s98
  s_cselect_b32 s60, s96, s60
  v_mfma_f32_16x16x32_bf16 v[56:59], v[136:139], v[120:123], v[56:59]
  ds_read_b64_tr_b16 v[108:109], v165 offset:0
  v_mfma_f32_16x16x32_bf16 v[72:75], v[136:139], v[124:127], v[72:75]
  ds_read_b64_tr_b16 v[110:111], v165 offset:4096
  v_mfma_f32_16x16x32_bf16 v[28:31], v[140:143], v[112:115], v[28:31]
  v_mfma_f32_16x16x32_bf16 v[44:47], v[140:143], v[116:119], v[44:47]
  v_mfma_f32_16x16x32_bf16 v[60:63], v[140:143], v[120:123], v[60:63]
  v_mfma_f32_16x16x32_bf16 v[76:79], v[140:143], v[124:127], v[76:79]
  s_waitcnt vmcnt(10) lgkmcnt(0)
  s_barrier
  v_mfma_f32_16x16x32_bf16 v[16:19], v[96:99], v[80:83], v[16:19]
  ds_read_b64_tr_b16 v[128:129], v162 offset:24576
  v_mfma_f32_16x16x32_bf16 v[32:35], v[96:99], v[84:87], v[32:35]
  ds_read_b64_tr_b16 v[130:131], v162 offset:28672
  s_add_u32 m0, s61, 73728
  s_nop 0
  buffer_load_dwordx4 v144, s[16:19], s59 offen sc1 lds
  v_mfma_f32_16x16x32_bf16 v[48:51], v[96:99], v[88:91], v[48:51]
  ds_read_b128 v[112:115], v161 offset:24576
  v_mfma_f32_16x16x32_bf16 v[64:67], v[96:99], v[92:95], v[64:67]
  ds_read_b128 v[116:119], v161 offset:25600
  v_mfma_f32_16x16x32_bf16 v[20:23], v[100:103], v[80:83], v[20:23]
  ds_read_b128 v[120:123], v161 offset:26624
  v_mfma_f32_16x16x32_bf16 v[36:39], v[100:103], v[84:87], v[36:39]
  ds_read_b128 v[124:127], v161 offset:27648
  buffer_load_dwordx4 v144, s[16:19], s59 offen offset:1024 sc1 lds
  s_add_u32 s59, s59, 16384
  s_cmp_eq_u32 s59, s63
  s_cselect_b32 s59, s58, s59
  v_mfma_f32_16x16x32_bf16 v[52:55], v[100:103], v[88:91], v[52:55]
  ds_read_b64_tr_b16 v[132:133], v163 offset:24576
  v_mfma_f32_16x16x32_bf16 v[68:71], v[100:103], v[92:95], v[68:71]
  ds_read_b64_tr_b16 v[134:135], v163 offset:28672
  v_mfma_f32_16x16x32_bf16 v[24:27], v[104:107], v[80:83], v[24:27]
  ds_read_b64_tr_b16 v[136:137], v164 offset:24576
  v_mfma_f32_16x16x32_bf16 v[40:43], v[104:107], v[84:87], v[40:43]
  ds_read_b64_tr_b16 v[138:139], v164 offset:28672
  s_add_u32 m0, s62, 73728
  s_bitcmp1_b32 s97, 23
  s_cselect_b32 s55, s47, 0
  s_add_u32 s55, s55, s60
  buffer_load_dwordx4 v147, s[28:31], s55 offen lds
  s_add_u32 s60, s60, 65536
  s_cmp_eq_u32 s60, s98
  s_cselect_b32 s60, s96, s60
  v_mfma_f32_16x16x32_bf16 v[56:59], v[104:107], v[88:91], v[56:59]
  ds_read_b64_tr_b16 v[140:141], v165 offset:24576
  v_mfma_f32_16x16x32_bf16 v[72:75], v[104:107], v[92:95], v[72:75]
  ds_read_b64_tr_b16 v[142:143], v165 offset:28672
  v_mfma_f32_16x16x32_bf16 v[28:31], v[108:111], v[80:83], v[28:31]
  v_mfma_f32_16x16x32_bf16 v[44:47], v[108:111], v[84:87], v[44:47]
  v_mfma_f32_16x16x32_bf16 v[60:63], v[108:111], v[88:91], v[60:63]
  v_mfma_f32_16x16x32_bf16 v[76:79], v[108:111], v[92:95], v[76:79]
  s_waitcnt vmcnt(9) lgkmcnt(0)
  s_barrier
  v_mfma_f32_16x16x32_bf16 v[16:19], v[128:131], v[112:115], v[16:19]
  ds_read_b64_tr_b16 v[96:97], v151 offset:0
  v_mfma_f32_16x16x32_bf16 v[32:35], v[128:131], v[116:119], v[32:35]
  ds_read_b64_tr_b16 v[98:99], v151 offset:4096
  s_add_u32 m0, s61, 98304
  s_nop 0
  buffer_load_dwordx4 v144, s[16:19], s59 offen sc1 lds
  v_mfma_f32_16x16x32_bf16 v[48:51], v[128:131], v[120:123], v[48:51]
  ds_read_b128 v[80:83], v150 offset:0
  v_mfma_f32_16x16x32_bf16 v[64:67], v[128:131], v[124:127], v[64:67]
  ds_read_b128 v[84:87], v150 offset:1024
  v_mfma_f32_16x16x32_bf16 v[20:23], v[132:135], v[112:115], v[20:23]
  ds_read_b128 v[88:91], v150 offset:2048
  v_mfma_f32_16x16x32_bf16 v[36:39], v[132:135], v[116:119], v[36:39]
  ds_read_b128 v[92:95], v150 offset:3072
  buffer_load_dwordx4 v144, s[16:19], s59 offen offset:1024 sc1 lds
  s_add_u32 s59, s59, 16384
  s_cmp_eq_u32 s59, s63
  s_cselect_b32 s59, s58, s59
  v_mfma_f32_16x16x32_bf16 v[52:55], v[132:135], v[120:123], v[52:55]
  ds_read_b64_tr_b16 v[100:101], v152 offset:0
  v_mfma_f32_16x16x32_bf16 v[68:71], v[132:135], v[124:127], v[68:71]
  ds_read_b64_tr_b16 v[102:103], v152 offset:4096
  v_mfma_f32_16x16x32_bf16 v[24:27], v[136:139], v[112:115], v[24:27]
  ds_read_b64_tr_b16 v[104:105], v153 offset:0
  v_mfma_f32_16x16x32_bf16 v[40:43], v[136:139], v[116:119], v[40:43]
  ds_read_b64_tr_b16 v[106:107], v153 offset:4096
  s_add_u32 m0, s62, 98304
  s_bitcmp1_b32 s97, 24
  s_cselect_b32 s55, s47, 0
  s_add_u32 s55, s55, s60
  buffer_load_dwordx4 v147, s[28:31], s55 offen lds
  s_add_u32 s60, s60, 65536
  s_cmp_eq_u32 s60, s98
  s_cselect_b32 s60, s96, s60
  v_mfma_f32_16x16x32_bf16 v[56:59], v[136:139], v[120:123], v[56:59]
  ds_read_b64_tr_b16 v[108:109], v154 offset:0
  v_mfma_f32_16x16x32_bf16 v[72:75], v[136:139], v[124:127], v[72:75]
  ds_read_b64_tr_b16 v[110:111], v154 offset:4096
  v_mfma_f32_16x16x32_bf16 v[28:31], v[140:143], v[112:115], v[28:31]
  v_mfma_f32_16x16x32_bf16 v[44:47], v[140:143], v[116:119], v[44:47]
  v_mfma_f32_16x16x32_bf16 v[60:63], v[140:143], v[120:123], v[60:63]
  v_mfma_f32_16x16x32_bf16 v[76:79], v[140:143], v[124:127], v[76:79]
  s_waitcnt vmcnt(9) lgkmcnt(0)
  s_barrier
  v_mfma_f32_16x16x32_bf16 v[16:19], v[96:99], v[80:83], v[16:19]
  ds_read_b64_tr_b16 v[128:129], v151 offset:24576
  v_mfma_f32_16x16x32_bf16 v[32:35], v[96:99], v[84:87], v[32:35]
  ds_read_b64_tr_b16 v[130:131], v151 offset:28672
  s_add_u32 m0, s61, 0
  s_nop 0
  buffer_load_dwordx4 v144, s[16:19], s59 offen sc1 lds
  v_mfma_f32_16x16x32_bf16 v[48:51], v[96:99], v[88:91], v[48:51]
  ds_read_b128 v[112:115], v150 offset:24576
  v_mfma_f32_16x16x32_bf16 v[64:67], v[96:99], v[92:95], v[64:67]
  ds_read_b128 v[116:119], v150 offset:25600
  v_mfma_f32_16x16x32_bf16 v[20:23], v[100:103], v[80:83], v[20:23]
  ds_read_b128 v[120:123], v150 offset:26624
  v_mfma_f32_16x16x32_bf16 v[36:39], v[100:103], v[84:87], v[36:39]
  ds_read_b128 v[124:127], v150 offset:27648
  buffer_load_dwordx4 v144, s[16:19], s59 offen offset:1024 sc1 lds
  s_add_u32 s59, s59, 16384
  s_cmp_eq_u32 s59, s63
  s_cselect_b32 s59, s58, s59
  v_mfma_f32_16x16x32_bf16 v[52:55], v[100:103], v[88:91], v[52:55]
  ds_read_b64_tr_b16 v[132:133], v152 offset:24576
  v_mfma_f32_16x16x32_bf16 v[68:71], v[100:103], v[92:95], v[68:71]
  ds_read_b64_tr_b16 v[134:135], v152 offset:28672
  v_mfma_f32_16x16x32_bf16 v[24:27], v[104:107], v[80:83], v[24:27]
  ds_read_b64_tr_b16 v[136:137], v153 offset:24576
  v_mfma_f32_16x16x32_bf16 v[40:43], v[104:107], v[84:87], v[40:43]
  ds_read_b64_tr_b16 v[138:139], v153 offset:28672
  s_add_u32 m0, s62, 0
  s_bitcmp1_b32 s97, 25
  s_cselect_b32 s55, s47, 0
  s_add_u32 s55, s55, s60
  buffer_load_dwordx4 v147, s[28:31], s55 offen lds
  s_add_u32 s60, s60, 65536
  s_cmp_eq_u32 s60, s98
  s_cselect_b32 s60, s96, s60
  v_mfma_f32_16x16x32_bf16 v[56:59], v[104:107], v[88:91], v[56:59]
  ds_read_b64_tr_b16 v[140:141], v154 offset:24576
  v_mfma_f32_16x16x32_bf16 v[72:75], v[104:107], v[92:95], v[72:75]
  ds_read_b64_tr_b16 v[142:143], v154 offset:28672
  v_mfma_f32_16x16x32_bf16 v[28:31], v[108:111], v[80:83], v[28:31]
  v_mfma_f32_16x16x32_bf16 v[44:47], v[108:111], v[84:87], v[44:47]
  v_mfma_f32_16x16x32_bf16 v[60:63], v[108:111], v[88:91], v[60:63]
  v_mfma_f32_16x16x32_bf16 v[76:79], v[108:111], v[92:95], v[76:79]
  s_waitcnt vmcnt(9) lgkmcnt(0)
  s_barrier
  v_mfma_f32_16x16x32_bf16 v[16:19], v[128:131], v[112:115], v[16:19]
  ds_read_b64_tr_b16 v[96:97], v151 offset:49152
  v_mfma_f32_16x16x32_bf16 v[32:35], v[128:131], v[116:119], v[32:35]
  ds_read_b64_tr_b16 v[98:99], v151 offset:53248
  s_add_u32 m0, s61, 24576
  s_nop 0
  buffer_load_dwordx4 v144, s[16:19], s59 offen sc1 lds
  v_mfma_f32_16x16x32_bf16 v[48:51], v[128:131], v[120:123], v[48:51]
  ds_read_b128 v[80:83], v150 offset:49152
  v_mfma_f32_16x16x32_bf16 v[64:67], v[128:131], v[124:127], v[64:67]
  ds_read_b128 v[84:87], v150 offset:50176
  v_mfma_f32_16x16x32_bf16 v[20:23], v[132:135], v[112:115], v[20:23]
  ds_read_b128 v[88:91], v150 offset:51200
  v_mfma_f32_16x16x32_bf16 v[36:39], v[132:135], v[116:119], v[36:39]
  ds_read_b128 v[92:95], v150 offset:52224
  buffer_load_dwordx4 v144, s[16:19], s59 offen offset:1024 sc1 lds
  s_add_u32 s59, s59, 16384
  s_cmp_eq_u32 s59, s63
  s_cselect_b32 s59, s58, s59
  v_mfma_f32_16x16x32_bf16 v[52:55], v[132:135], v[120:123], v[52:55]
  ds_read_b64_tr_b16 v[100:101], v152 offset:49152
  v_mfma_f32_16x16x32_bf16 v[68:71], v[132:135], v[124:127], v[68:71]
  ds_read_b64_tr_b16 v[102:103], v152 offset:53248
  v_mfma_f32_16x16x32_bf16 v[24:27], v[136:139], v[112:115], v[24:27]
  ds_read_b64_tr_b16 v[104:105], v153 offset:49152
  v_mfma_f32_16x16x32_bf16 v[40:43], v[136:139], v[116:119], v[40:43]
  ds_read_b64_tr_b16 v[106:107], v153 offset:53248
  s_add_u32 m0, s62, 24576
  s_bitcmp1_b32 s97, 26
  s_cselect_b32 s55, s47, 0
  s_add_u32 s55, s55, s60
  buffer_load_dwordx4 v147, s[28:31], s55 offen lds
  s_add_u32 s60, s60, 65536
  s_cmp_eq_u32 s60, s98
  s_cselect_b32 s60, s96, s60
  v_mfma_f32_16x16x32_bf16 v[56:59], v[136:139], v[120:123], v[56:59]
  ds_read_b64_tr_b16 v[108:109], v154 offset:49152
  v_mfma_f32_16x16x32_bf16 v[72:75], v[136:139], v[124:127], v[72:75]
  ds_read_b64_tr_b16 v[110:111], v154 offset:53248
  v_mfma_f32_16x16x32_bf16 v[28:31], v[140:143], v[112:115], v[28:31]
  v_mfma_f32_16x16x32_bf16 v[44:47], v[140:143], v[116:119], v[44:47]
  v_mfma_f32_16x16x32_bf16 v[60:63], v[140:143], v[120:123], v[60:63]
  v_mfma_f32_16x16x32_bf16 v[76:79], v[140:143], v[124:127], v[76:79]
  s_waitcnt vmcnt(9) lgkmcnt(0)
  s_barrier
  v_mfma_f32_16x16x32_bf16 v[16:19], v[96:99], v[80:83], v[16:19]
  ds_read_b64_tr_b16 v[128:129], v162 offset:0
  v_mfma_f32_16x16x32_bf16 v[32:35], v[96:99], v[84:87], v[32:35]
  ds_read_b64_tr_b16 v[130:131], v162 offset:4096
  s_add_u32 m0, s61, 49152
  s_nop 0
  buffer_load_dwordx4 v144, s[16:19], s59 offen sc1 lds
  v_mfma_f32_16x16x32_bf16 v[48:51], v[96:99], v[88:91], v[48:51]
  ds_read_b128 v[112:115], v161 offset:0
  v_mfma_f32_16x16x32_bf16 v[64:67], v[96:99], v[92:95], v[64:67]
  ds_read_b128 v[116:119], v161 offset:1024
  v_mfma_f32_16x16x32_bf16 v[20:23], v[100:103], v[80:83], v[20:23]
  ds_read_b128 v[120:123], v161 offset:2048
  v_mfma_f32_16x16x32_bf16 v[36:39], v[100:103], v[84:87], v[36:39]
  ds_read_b128 v[124:127], v161 offset:3072
  buffer_load_dwordx4 v144, s[16:19], s59 offen offset:1024 sc1 lds
  s_add_u32 s59, s59, 16384
  s_cmp_eq_u32 s59, s63
  s_cselect_b32 s59, s58, s59
  v_mfma_f32_16x16x32_bf16 v[52:55], v[100:103], v[88:91], v[52:55]
  ds_read_b64_tr_b16 v[132:133], v163 offset:0
  v_mfma_f32_16x16x32_bf16 v[68:71], v[100:103], v[92:95], v[68:71]
  ds_read_b64_tr_b16 v[134:135], v163 offset:4096
  v_mfma_f32_16x16x32_bf16 v[24:27], v[104:107], v[80:83], v[24:27]
  ds_read_b64_tr_b16 v[136:137], v164 offset:0
  v_mfma_f32_16x16x32_bf16 v[40:43], v[104:107], v[84:87], v[40:43]
  ds_read_b64_tr_b16 v[138:139], v164 offset:4096
  s_add_u32 m0, s62, 49152
  s_bitcmp1_b32 s97, 27
  s_cselect_b32 s55, s47, 0
  s_add_u32 s55, s55, s60
  buffer_load_dwordx4 v147, s[28:31], s55 offen lds
  s_add_u32 s60, s60, 65536
  s_cmp_eq_u32 s60, s98
  s_cselect_b32 s60, s96, s60
  v_mfma_f32_16x16x32_bf16 v[56:59], v[104:107], v[88:91], v[56:59]
  ds_read_b64_tr_b16 v[140:141], v165 offset:0
  v_mfma_f32_16x16x32_bf16 v[72:75], v[104:107], v[92:95], v[72:75]
  ds_read_b64_tr_b16 v[142:143], v165 offset:4096
  s_mov_b32 s53, 0
  s_lshl_b32 s59, s53, 17
  s_branch L_tover_6
L_touch_6:
  s_branch L_tret_B0
L_tover_6:
  s_lshl_b32 s61, s44, 11
  s_add_u32 s61, s61, 8192
  s_lshl_b32 s62, s44, 10
  v_mfma_f32_16x16x32_bf16 v[28:31], v[108:111], v[80:83], v[28:31]
  s_lshl_b32 s51, s46, 5
  s_lshr_b32 s52, s44, 2
  s_add_u32 s51, s51, s52
  s_lshl_b32 s51, s51, 2
  s_add_u32 s51, s51, s49
  v_mfma_f32_16x16x32_bf16 v[44:47], v[108:111], v[84:87], v[44:47]
  s_lshl_b32 s51, s51, 2
  s_add_u32 s51, s51, s45
  s_lshl_b32 s51, s51, 10
  s_add_u32 s96, s51, 0x1400000
  s_add_u32 s98, s96, 524288
  s_lshl_b32 s53, s53, 15
  s_add_u32 s60, s96, s53
  v_mfma_f32_16x16x32_bf16 v[60:63], v[108:111], v[88:91], v[60:63]
  v_mfma_f32_16x16x32_bf16 v[76:79], v[108:111], v[92:95], v[76:79]
  s_waitcnt vmcnt(9) lgkmcnt(0)
  s_barrier
  v_mfma_f32_16x16x32_bf16 v[16:19], v[128:131], v[112:115], v[16:19]
  ds_read_b64_tr_b16 v[96:97], v162 offset:24576
  v_mfma_f32_16x16x32_bf16 v[32:35], v[128:131], v[116:119], v[32:35]
  ds_read_b64_tr_b16 v[98:99], v162 offset:28672
  s_add_u32 m0, s61, 73728
  s_nop 0
  buffer_load_dwordx4 v148, s[32:35], s59 offen lds
  v_mfma_f32_16x16x32_bf16 v[48:51], v[128:131], v[120:123], v[48:51]
  ds_read_b128 v[80:83], v161 offset:24576
  v_mfma_f32_16x16x32_bf16 v[64:67], v[128:131], v[124:127], v[64:67]
  ds_read_b128 v[84:87], v161 offset:25600
  v_mfma_f32_16x16x32_bf16 v[20:23], v[132:135], v[112:115], v[20:23]
  ds_read_b128 v[88:91], v161 offset:26624
  v_mfma_f32_16x16x32_bf16 v[36:39], v[132:135], v[116:119], v[36:39]
  ds_read_b128 v[92:95], v161 offset:27648
  buffer_load_dwordx4 v149, s[32:35], s59 offen offset:1024 lds
  s_add_u32 s59, s59, 131072
  s_and_b32 s59, s59, 0x1fffff
  v_mfma_f32_16x16x32_bf16 v[52:55], v[132:135], v[120:123], v[52:55]
  ds_read_b64_tr_b16 v[100:101], v163 offset:24576
  v_mfma_f32_16x16x32_bf16 v[68:71], v[132:135], v[124:127], v[68:71]
  ds_read_b64_tr_b16 v[102:103], v163 offset:28672
  v_mfma_f32_16x16x32_bf16 v[24:27], v[136:139], v[112:115], v[24:27]
  ds_read_b64_tr_b16 v[104:105], v164 offset:24576
  v_mfma_f32_16x16x32_bf16 v[40:43], v[136:139], v[116:119], v[40:43]
  ds_read_b64_tr_b16 v[106:107], v164 offset:28672
  v_mfma_f32_16x16x32_bf16 v[56:59], v[136:139], v[120:123], v[56:59]
  ds_read_b64_tr_b16 v[108:109], v165 offset:24576
  s_lshl_b32 s51, s46, 8
  s_add_u32 s51, s51, 0x88000
  v_mfma_f32_16x16x32_bf16 v[72:75], v[136:139], v[124:127], v[72:75]
  ds_read_b64_tr_b16 v[110:111], v165 offset:28672
  v_and_b32 v1, 31, v0
  v_mfma_f32_16x16x32_bf16 v[28:31], v[140:143], v[112:115], v[28:31]
  v_lshlrev_b32 v1, 2, v1
  v_mfma_f32_16x16x32_bf16 v[44:47], v[140:143], v[116:119], v[44:47]
  buffer_load_dword v158, v1, s[16:19], s51 offen sc1
  v_mfma_f32_16x16x32_bf16 v[60:63], v[140:143], v[120:123], v[60:63]
  v_mfma_f32_16x16x32_bf16 v[76:79], v[140:143], v[124:127], v[76:79]
  s_waitcnt vmcnt(9) lgkmcnt(0)
  s_barrier
  v_mfma_f32_16x16x32_bf16 v[16:19], v[96:99], v[80:83], v[16:19]
  ds_read_b64_tr_b16 v[128:129], v151 offset:0
  v_mfma_f32_16x16x32_bf16 v[32:35], v[96:99], v[84:87], v[32:35]
  ds_read_b64_tr_b16 v[130:131], v151 offset:4096
  s_add_u32 m0, s61, 98304
  s_nop 0
  buffer_load_dwordx4 v148, s[32:35], s59 offen lds
  v_mfma_f32_16x16x32_bf16 v[48:51], v[96:99], v[88:91], v[48:51]
  ds_read_b128 v[112:115], v150 offset:0
  v_mfma_f32_16x16x32_bf16 v[64:67], v[96:99], v[92:95], v[64:67]
  ds_read_b128 v[116:119], v150 offset:1024
  v_mfma_f32_16x16x32_bf16 v[20:23], v[100:103], v[80:83], v[20:23]
  ds_read_b128 v[120:123], v150 offset:2048
  v_mfma_f32_16x16x32_bf16 v[36:39], v[100:103], v[84:87], v[36:39]
  ds_read_b128 v[124:127], v150 offset:3072
  buffer_load_dwordx4 v149, s[32:35], s59 offen offset:1024 lds
  s_add_u32 s59, s59, 131072
  s_and_b32 s59, s59, 0x1fffff
  v_mfma_f32_16x16x32_bf16 v[52:55], v[100:103], v[88:91], v[52:55]
  ds_read_b64_tr_b16 v[132:133], v152 offset:0
  v_mfma_f32_16x16x32_bf16 v[68:71], v[100:103], v[92:95], v[68:71]
  ds_read_b64_tr_b16 v[134:135], v152 offset:4096
  v_mfma_f32_16x16x32_bf16 v[24:27], v[104:107], v[80:83], v[24:27]
  ds_read_b64_tr_b16 v[136:137], v153 offset:0
  v_mfma_f32_16x16x32_bf16 v[40:43], v[104:107], v[84:87], v[40:43]
  ds_read_b64_tr_b16 v[138:139], v153 offset:4096
  v_mfma_f32_16x16x32_bf16 v[56:59], v[104:107], v[88:91], v[56:59]
  ds_read_b64_tr_b16 v[140:141], v154 offset:0
  v_mfma_f32_16x16x32_bf16 v[72:75], v[104:107], v[92:95], v[72:75]
  ds_read_b64_tr_b16 v[142:143], v154 offset:4096
  v_mfma_f32_16x16x32_bf16 v[28:31], v[108:111], v[80:83], v[28:31]
  v_mfma_f32_16x16x32_bf16 v[44:47], v[108:111], v[84:87], v[44:47]
  v_mfma_f32_16x16x32_bf16 v[60:63], v[108:111], v[88:91], v[60:63]
  v_mfma_f32_16x16x32_bf16 v[76:79], v[108:111], v[92:95], v[76:79]
  s_waitcnt vmcnt(8) lgkmcnt(0)
  s_barrier
  v_mfma_f32_16x16x32_bf16 v[16:19], v[128:131], v[112:115], v[16:19]
  ds_read_b64_tr_b16 v[96:97], v151 offset:24576
  s_waitcnt vmcnt(2)
  v_cmp_gt_u32 vcc, 1, v158
  s_nop 0
  s_cmp_eq_u64 vcc, 0
  s_cbranch_scc0 L_spin_f4
L_spinr_f4:
  s_add_u32 m0, s62, 73728
  s_nop 0
  buffer_load_dwordx4 v144, s[16:19], s60 offen sc1 lds
  s_add_u32 s60, s60, 32768
  s_cmp_eq_u32 s60, s98
  s_cselect_b32 s60, s96, s60
  s_add_u32 m0, s62, 98304
  s_nop 0
  buffer_load_dwordx4 v144, s[16:19], s60 offen sc1 lds
  s_add_u32 s60, s60, 32768
  s_cmp_eq_u32 s60, s98
  s_cselect_b32 s60, s96, s60
  v_mfma_f32_16x16x32_bf16 v[32:35], v[128:131], v[116:119], v[32:35]
  ds_read_b64_tr_b16 v[98:99], v151 offset:28672
  s_add_u32 m0, s61, 0
  s_nop 0
  buffer_load_dwordx4 v148, s[32:35], s59 offen lds
  v_mfma_f32_16x16x32_bf16 v[48:51], v[128:131], v[120:123], v[48:51]
  ds_read_b128 v[80:83], v150 offset:24576
  v_mfma_f32_16x16x32_bf16 v[64:67], v[128:131], v[124:127], v[64:67]
  ds_read_b128 v[84:87], v150 offset:25600
  v_mfma_f32_16x16x32_bf16 v[20:23], v[132:135], v[112:115], v[20:23]
  ds_read_b128 v[88:91], v150 offset:26624
  v_mfma_f32_16x16x32_bf16 v[36:39], v[132:135], v[116:119], v[36:39]
  ds_read_b128 v[92:95], v150 offset:27648
  buffer_load_dwordx4 v149, s[32:35], s59 offen offset:1024 lds
  s_add_u32 s59, s59, 131072
  s_and_b32 s59, s59, 0x1fffff
  v_mfma_f32_16x16x32_bf16 v[52:55], v[132:135], v[120:123], v[52:55]
  ds_read_b64_tr_b16 v[100:101], v152 offset:24576
  v_mfma_f32_16x16x32_bf16 v[68:71], v[132:135], v[124:127], v[68:71]
  ds_read_b64_tr_b16 v[102:103], v152 offset:28672
  v_mfma_f32_16x16x32_bf16 v[24:27], v[136:139], v[112:115], v[24:27]
  ds_read_b64_tr_b16 v[104:105], v153 offset:24576
  v_mfma_f32_16x16x32_bf16 v[40:43], v[136:139], v[116:119], v[40:43]
  ds_read_b64_tr_b16 v[106:107], v153 offset:28672
  s_add_u32 m0, s62, 0
  s_nop 0
  buffer_load_dwordx4 v144, s[16:19], s60 offen sc1 lds
  s_add_u32 s60, s60, 32768
  s_cmp_eq_u32 s60, s98
  s_cselect_b32 s60, s96, s60
  v_mfma_f32_16x16x32_bf16 v[56:59], v[136:139], v[120:123], v[56:59]
  ds_read_b64_tr_b16 v[108:109], v154 offset:24576
  v_mfma_f32_16x16x32_bf16 v[72:75], v[136:139], v[124:127], v[72:75]
  ds_read_b64_tr_b16 v[110:111], v154 offset:28672
  v_mfma_f32_16x16x32_bf16 v[28:31], v[140:143], v[112:115], v[28:31]
  v_mfma_f32_16x16x32_bf16 v[44:47], v[140:143], v[116:119], v[44:47]
  v_mfma_f32_16x16x32_bf16 v[60:63], v[140:143], v[120:123], v[60:63]
  v_mfma_f32_16x16x32_bf16 v[76:79], v[140:143], v[124:127], v[76:79]
  s_waitcnt vmcnt(10) lgkmcnt(0)
  s_barrier
  v_mfma_f32_16x16x32_bf16 v[16:19], v[96:99], v[80:83], v[16:19]
  ds_read_b64_tr_b16 v[128:129], v151 offset:49152
  v_mfma_f32_16x16x32_bf16 v[32:35], v[96:99], v[84:87], v[32:35]
  ds_read_b64_tr_b16 v[130:131], v151 offset:53248
  s_add_u32 m0, s61, 24576
  s_nop 0
  buffer_load_dwordx4 v148, s[32:35], s59 offen lds
  v_mfma_f32_16x16x32_bf16 v[48:51], v[96:99], v[88:91], v[48:51]
  ds_read_b128 v[112:115], v150 offset:49152
  v_mfma_f32_16x16x32_bf16 v[64:67], v[96:99], v[92:95], v[64:67]
  ds_read_b128 v[116:119], v150 offset:50176
  v_mfma_f32_16x16x32_bf16 v[20:23], v[100:103], v[80:83], v[20:23]
  ds_read_b128 v[120:123], v150 offset:51200
  v_mfma_f32_16x16x32_bf16 v[36:39], v[100:103], v[84:87], v[36:39]
  ds_read_b128 v[124:127], v150 offset:52224
  buffer_load_dwordx4 v149, s[32:35], s59 offen offset:1024 lds
  s_add_u32 s59, s59, 131072
  s_and_b32 s59, s59, 0x1fffff
  v_mfma_f32_16x16x32_bf16 v[52:55], v[100:103], v[88:91], v[52:55]
  ds_read_b64_tr_b16 v[132:133], v152 offset:49152
  v_mfma_f32_16x16x32_bf16 v[68:71], v[100:103], v[92:95], v[68:71]
  ds_read_b64_tr_b16 v[134:135], v152 offset:53248
  v_mfma_f32_16x16x32_bf16 v[24:27], v[104:107], v[80:83], v[24:27]
  ds_read_b64_tr_b16 v[136:137], v153 offset:49152
  v_mfma_f32_16x16x32_bf16 v[40:43], v[104:107], v[84:87], v[40:43]
  ds_read_b64_tr_b16 v[138:139], v153 offset:53248
  s_add_u32 m0, s62, 24576
  s_nop 0
  buffer_load_dwordx4 v144, s[16:19], s60 offen sc1 lds
  s_add_u32 s60, s60, 32768
  s_cmp_eq_u32 s60, s98
  s_cselect_b32 s60, s96, s60
  v_mfma_f32_16x16x32_bf16 v[56:59], v[104:107], v[88:91], v[56:59]
  ds_read_b64_tr_b16 v[140:141], v154 offset:49152
  v_mfma_f32_16x16x32_bf16 v[72:75], v[104:107], v[92:95], v[72:75]
  ds_read_b64_tr_b16 v[142:143], v154 offset:53248
  v_mfma_f32_16x16x32_bf16 v[28:31], v[108:111], v[80:83], v[28:31]
  v_mfma_f32_16x16x32_bf16 v[44:47], v[108:111], v[84:87], v[44:47]
  v_mfma_f32_16x16x32_bf16 v[60:63], v[108:111], v[88:91], v[60:63]
  v_mfma_f32_16x16x32_bf16 v[76:79], v[108:111], v[92:95], v[76:79]
  s_waitcnt vmcnt(7) lgkmcnt(0)
  s_barrier
  v_mfma_f32_16x16x32_bf16 v[16:19], v[128:131], v[112:115], v[16:19]
  ds_read_b128 v[80:83], v155 offset:0
  v_mfma_f32_16x16x32_bf16 v[32:35], v[128:131], v[116:119], v[32:35]
  ds_read_b128 v[84:87], v155 offset:1024
  s_add_u32 m0, s61, 49152
  s_nop 0
  buffer_load_dwordx4 v148, s[32:35], s59 offen lds
  v_mfma_f32_16x16x32_bf16 v[48:51], v[128:131], v[120:123], v[48:51]
  ds_read_b64_tr_b16 v[96:97], v156 offset:0
  v_mfma_f32_16x16x32_bf16 v[64:67], v[128:131], v[124:127], v[64:67]
  ds_read_b64_tr_b16 v[98:99], v156 offset:4096
  v_mfma_f32_16x16x32_bf16 v[20:23], v[132:135], v[112:115], v[20:23]
  ds_read_b64_tr_b16 v[100:101], v157 offset:0
  v_mfma_f32_16x16x32_bf16 v[36:39], v[132:135], v[116:119], v[36:39]
  ds_read_b64_tr_b16 v[102:103], v157 offset:4096
  buffer_load_dwordx4 v149, s[32:35], s59 offen offset:1024 lds
  s_add_u32 s59, s59, 131072
  s_and_b32 s59, s59, 0x1fffff
  v_mfma_f32_16x16x32_bf16 v[52:55], v[132:135], v[120:123], v[52:55]
  ds_read_b128 v[88:91], v155 offset:4096
  v_mfma_f32_16x16x32_bf16 v[68:71], v[132:135], v[124:127], v[68:71]
  ds_read_b128 v[92:95], v155 offset:5120
  v_mfma_f32_16x16x32_bf16 v[24:27], v[136:139], v[112:115], v[24:27]
  ds_read_b64_tr_b16 v[104:105], v156 offset:8192
  v_mfma_f32_16x16x32_bf16 v[40:43], v[136:139], v[116:119], v[40:43]
  ds_read_b64_tr_b16 v[106:107], v156 offset:12288
  s_add_u32 m0, s62, 49152
  s_nop 0
  buffer_load_dwordx4 v144, s[16:19], s60 offen sc1 lds
  s_add_u32 s60, s60, 32768
  s_cmp_eq_u32 s60, s98
  s_cselect_b32 s60, s96, s60
  v_mfma_f32_16x16x32_bf16 v[56:59], v[136:139], v[120:123], v[56:59]
  ds_read_b64_tr_b16 v[108:109], v157 offset:8192
  v_mfma_f32_16x16x32_bf16 v[72:75], v[136:139], v[124:127], v[72:75]
  ds_read_b64_tr_b16 v[110:111], v157 offset:12288
  v_mfma_f32_16x16x32_bf16 v[28:31], v[140:143], v[112:115], v[28:31]
  v_add_u32 v150, 0xfffee000, v155
  v_mfma_f32_16x16x32_bf16 v[44:47], v[140:143], v[116:119], v[44:47]
  v_add_u32 v151, 0xfffee000, v156
  v_mfma_f32_16x16x32_bf16 v[60:63], v[140:143], v[120:123], v[60:63]
  v_add_u32 v152, 0xfffee000, v157
  v_mfma_f32_16x16x32_bf16 v[76:79], v[140:143], v[124:127], v[76:79]
  s_waitcnt vmcnt(9) lgkmcnt(0)
  s_barrier
  v_mfma_f32_16x16x32_bf16 v[200:203], v[96:99], v[80:83], 0
  ds_read_b128 v[112:115], v155 offset:24576
  ds_read_b128 v[116:119], v155 offset:25600
  s_lshr_b32 s52, s44, 2
  s_lshl_b32 s52, s52, 11
  s_lshl_b32 s51, s3, 2
  s_add_u32 s51, s51, s45
  s_lshl_b32 s51, s51, 2
  s_add_u32 s51, s51, s49
  s_lshl_b32 s51, s51, 14
  s_add_u32 s51, s51, s52
  s_add_u32 s57, s51, 0x1800000
  s_add_u32 s52, s52, 122880
  v_mfma_f32_16x16x32_bf16 v[204:207], v[100:103], v[80:83], 0
  ds_read_b64_tr_b16 v[128:129], v156 offset:24576
  ds_read_b64_tr_b16 v[130:131], v156 offset:28672
  s_add_u32 m0, s61, 73728
  s_nop 0
  buffer_load_dwordx4 v148, s[32:35], s59 offen lds
  v_add_u32 v159, s52, v144
  v_mfma_f32_16x16x32_bf16 v[208:211], v[96:99], v[84:87], 0
  ds_read_b64_tr_b16 v[132:133], v157 offset:24576
  ds_read_b64_tr_b16 v[134:135], v157 offset:28672
  s_cmp_eq_u32 s45, s49
  s_cselect_b32 s14, 0, 0x10000000
  s_cselect_b64 s[4:5], -1, 0
  v_mfma_f32_16x16x32_bf16 v[212:215], v[100:103], v[84:87], 0
  ds_read_b128 v[120:123], v155 offset:28672
  buffer_load_dwordx4 v149, s[32:35], s59 offen offset:1024 lds
  s_add_u32 s59, s59, 131072
  s_and_b32 s59, s59, 0x1fffff
  v_cvt_pk_bf16_f32 v168, v16, v17
  v_mfma_f32_16x16x32_bf16 v[200:203], v[104:107], v[88:91], v[200:203]
  ds_read_b128 v[124:127], v155 offset:29696
  ds_read_b64_tr_b16 v[136:137], v156 offset:32768
  v_cvt_pk_bf16_f32 v169, v18, v19
  v_cvt_pk_bf16_f32 v170, v20, v21
  v_mfma_f32_16x16x32_bf16 v[204:207], v[108:111], v[88:91], v[204:207]
  ds_read_b64_tr_b16 v[138:139], v156 offset:36864
  ds_read_b64_tr_b16 v[140:141], v157 offset:32768
  s_add_u32 m0, s62, 73728
  s_nop 0
  buffer_load_dwordx4 v144, s[16:19], s60 offen sc1 lds
  s_add_u32 s60, s60, 32768
  s_cmp_eq_u32 s60, s98
  s_cselect_b32 s60, s96, s60
  v_cvt_pk_bf16_f32 v171, v22, v23
  v_mfma_f32_16x16x32_bf16 v[208:211], v[104:107], v[92:95], v[208:211]
  ds_read_b64_tr_b16 v[142:143], v157 offset:36864
  buffer_store_dwordx4 v[168:171], v144, s[12:15], s57 offen offset:0 sc1
  v_mfma_f32_16x16x32_bf16 v[212:215], v[108:111], v[92:95], v[212:215]
  s_mov_b64 exec, s[4:5]
  ds_write_b128 v159, v[168:171] offset:0
  s_mov_b64 exec, -1
  s_waitcnt vmcnt(10) lgkmcnt(0)
  s_barrier
  v_mfma_f32_16x16x32_bf16 v[200:203], v[128:131], v[112:115], v[200:203]
  ds_read_b128 v[80:83], v150 offset:0
  ds_read_b128 v[84:87], v150 offset:1024
  v_cvt_pk_bf16_f32 v172, v24, v25
  v_mfma_f32_16x16x32_bf16 v[204:207], v[132:135], v[112:115], v[204:207]
  ds_read_b64_tr_b16 v[96:97], v151 offset:0
  ds_read_b64_tr_b16 v[98:99], v151 offset:4096
  s_add_u32 m0, s61, 98304
  s_nop 0
  buffer_load_dwordx4 v148, s[32:35], s59 offen lds
  v_cvt_pk_bf16_f32 v173, v26, v27
  v_mfma_f32_16x16x32_bf16 v[208:211], v[128:131], v[116:119], v[208:211]
  ds_read_b64_tr_b16 v[100:101], v152 offset:0
  ds_read_b64_tr_b16 v[102:103], v152 offset:4096
  v_cvt_pk_bf16_f32 v174, v28, v29
  v_mfma_f32_16x16x32_bf16 v[212:215], v[132:135], v[116:119], v[212:215]
  ds_read_b128 v[88:91], v150 offset:4096
  buffer_load_dwordx4 v149, s[32:35], s59 offen offset:1024 lds
  s_add_u32 s59, s59, 131072
  s_and_b32 s59, s59, 0x1fffff
  v_mfma_f32_16x16x32_bf16 v[200:203], v[136:139], v[120:123], v[200:203]
  ds_read_b128 v[92:95], v150 offset:5120
  ds_read_b64_tr_b16 v[104:105], v151 offset:8192
  v_cvt_pk_bf16_f32 v175, v30, v31
  v_mfma_f32_16x16x32_bf16 v[204:207], v[140:143], v[120:123], v[204:207]
  ds_read_b64_tr_b16 v[106:107], v151 offset:12288
  ds_read_b64_tr_b16 v[108:109], v152 offset:8192
  s_add_u32 m0, s62, 98304
  s_nop 0
  buffer_load_dwordx4 v144, s[16:19], s60 offen sc1 lds
  s_add_u32 s60, s60, 32768
  s_cmp_eq_u32 s60, s98
  s_cselect_b32 s60, s96, s60
  buffer_store_dwordx4 v[172:175], v144, s[12:15], s57 offen offset:1024 sc1
  s_add_u32 s57, s57, 4096
  v_mfma_f32_16x16x32_bf16 v[208:211], v[136:139], v[124:127], v[208:211]
  ds_read_b64_tr_b16 v[110:111], v152 offset:12288
  s_mov_b64 exec, s[4:5]
  ds_write_b128 v159, v[172:175] offset:1024
  s_mov_b64 exec, -1
  v_mfma_f32_16x16x32_bf16 v[212:215], v[140:143], v[124:127], v[212:215]
  s_waitcnt vmcnt(11) lgkmcnt(0)
  s_barrier
  v_mfma_f32_16x16x32_bf16 v[200:203], v[96:99], v[80:83], v[200:203]
  ds_read_b128 v[112:115], v150 offset:24576
  ds_read_b128 v[116:119], v150 offset:25600
  v_cvt_pk_bf16_f32 v176, v32, v33
  v_mfma_f32_16x16x32_bf16 v[204:207], v[100:103], v[80:83], v[204:207]
  ds_read_b64_tr_b16 v[128:129], v151 offset:24576
  ds_read_b64_tr_b16 v[130:131], v151 offset:28672
  s_add_u32 m0, s61, 0
  s_nop 0
  buffer_load_dwordx4 v148, s[32:35], s59 offen lds
  v_cvt_pk_bf16_f32 v177, v34, v35
  v_mfma_f32_16x16x32_bf16 v[208:211], v[96:99], v[84:87], v[208:211]
  ds_read_b64_tr_b16 v[132:133], v152 offset:24576
  ds_read_b64_tr_b16 v[134:135], v152 offset:28672
  v_cvt_pk_bf16_f32 v178, v36, v37
  v_mfma_f32_16x16x32_bf16 v[212:215], v[100:103], v[84:87], v[212:215]
  ds_read_b128 v[120:123], v150 offset:28672
  buffer_load_dwordx4 v149, s[32:35], s59 offen offset:1024 lds
  s_add_u32 s59, s59, 131072
  s_and_b32 s59, s59, 0x1fffff
  v_mfma_f32_16x16x32_bf16 v[200:203], v[104:107], v[88:91], v[200:203]
  ds_read_b128 v[124:127], v150 offset:29696
  ds_read_b64_tr_b16 v[136:137], v151 offset:32768
  v_cvt_pk_bf16_f32 v179, v38, v39
  v_mfma_f32_16x16x32_bf16 v[204:207], v[108:111], v[88:91], v[204:207]
  ds_read_b64_tr_b16 v[138:139], v151 offset:36864
  ds_read_b64_tr_b16 v[140:141], v152 offset:32768
  s_add_u32 m0, s62, 0
  s_nop 0
  buffer_load_dwordx4 v144, s[16:19], s60 offen sc1 lds
  s_add_u32 s60, s60, 32768
  s_cmp_eq_u32 s60, s98
  s_cselect_b32 s60, s96, s60
  buffer_store_dwordx4 v[176:179], v144, s[12:15], s57 offen offset:0 sc1
  v_mfma_f32_16x16x32_bf16 v[208:211], v[104:107], v[92:95], v[208:211]
  ds_read_b64_tr_b16 v[142:143], v152 offset:36864
  s_mov_b64 exec, s[4:5]
  ds_write_b128 v159, v[176:179] offset:4096
  s_mov_b64 exec, -1
  v_mfma_f32_16x16x32_bf16 v[212:215], v[108:111], v[92:95], v[212:215]
  s_waitcnt vmcnt(12) lgkmcnt(0)
  s_barrier
  v_mfma_f32_16x16x32_bf16 v[200:203], v[128:131], v[112:115], v[200:203]
  ds_read_b128 v[80:83], v150 offset:49152
  ds_read_b128 v[84:87], v150 offset:50176
  v_cvt_pk_bf16_f32 v180, v40, v41
  v_mfma_f32_16x16x32_bf16 v[204:207], v[132:135], v[112:115], v[204:207]
  ds_read_b64_tr_b16 v[96:97], v151 offset:49152
  ds_read_b64_tr_b16 v[98:99], v151 offset:53248
  s_add_u32 m0, s61, 24576
  s_nop 0
  buffer_load_dwordx4 v148, s[32:35], s59 offen lds
  v_cvt_pk_bf16_f32 v181, v42, v43
  v_mfma_f32_16x16x32_bf16 v[208:211], v[128:131], v[116:119], v[208:211]
  ds_read_b64_tr_b16 v[100:101], v152 offset:49152
  ds_read_b64_tr_b16 v[102:103], v152 offset:53248
  v_cvt_pk_bf16_f32 v182, v44, v45
  v_mfma_f32_16x16x32_bf16 v[212:215], v[132:135], v[116:119], v[212:215]
  ds_read_b128 v[88:91], v150 offset:53248
  buffer_load_dwordx4 v149, s[32:35], s59 offen offset:1024 lds
  s_add_u32 s59, s59, 131072
  s_and_b32 s59, s59, 0x1fffff
  v_mfma_f32_16x16x32_bf16 v[200:203], v[136:139], v[120:123], v[200:203]
  ds_read_b128 v[92:95], v150 offset:54272
  ds_read_b64_tr_b16 v[104:105], v151 offset:57344
  v_cvt_pk_bf16_f32 v183, v46, v47
  v_mfma_f32_16x16x32_bf16 v[204:207], v[140:143], v[120:123], v[204:207]
  ds_read_b64_tr_b16 v[106:107], v151 offset:61440
  ds_read_b64_tr_b16 v[108:109], v152 offset:57344
  s_add_u32 m0, s62, 24576
  s_nop 0
  buffer_load_dwordx4 v144, s[16:19], s60 offen sc1 lds
  s_add_u32 s60, s60, 32768
  s_cmp_eq_u32 s60, s98
  s_cselect_b32 s60, s96, s60
  buffer_store_dwordx4 v[180:183], v144, s[12:15], s57 offen offset:1024 sc1
  s_add_u32 s57, s57, 4096
  v_mfma_f32_16x16x32_bf16 v[208:211], v[136:139], v[124:127], v[208:211]
  ds_read_b64_tr_b16 v[110:111], v152 offset:61440
  s_mov_b64 exec, s[4:5]
  ds_write_b128 v159, v[180:183] offset:5120
  s_mov_b64 exec, -1
  v_mfma_f32_16x16x32_bf16 v[212:215], v[140:143], v[124:127], v[212:215]
  s_waitcnt vmcnt(13) lgkmcnt(0)
  s_barrier
  v_mfma_f32_16x16x32_bf16 v[200:203], v[96:99], v[80:83], v[200:203]
  ds_read_b128 v[112:115], v155 offset:0
  ds_read_b128 v[116:119], v155 offset:1024
  v_cvt_pk_bf16_f32 v168, v48, v49
  v_mfma_f32_16x16x32_bf16 v[204:207], v[100:103], v[80:83], v[204:207]
  ds_read_b64_tr_b16 v[128:129], v156 offset:0
  ds_read_b64_tr_b16 v[130:131], v156 offset:4096
  s_add_u32 m0, s61, 49152
  s_nop 0
  buffer_load_dwordx4 v148, s[32:35], s59 offen lds
  v_cvt_pk_bf16_f32 v169, v50, v51
  v_mfma_f32_16x16x32_bf16 v[208:211], v[96:99], v[84:87], v[208:211]
  ds_read_b64_tr_b16 v[132:133], v157 offset:0
  ds_read_b64_tr_b16 v[134:135], v157 offset:4096
  v_cvt_pk_bf16_f32 v170, v52, v53
  v_mfma_f32_16x16x32_bf16 v[212:215], v[100:103], v[84:87], v[212:215]
  ds_read_b128 v[120:123], v155 offset:4096
  buffer_load_dwordx4 v149, s[32:35], s59 offen offset:1024 lds
  s_add_u32 s59, s59, 131072
  s_and_b32 s59, s59, 0x1fffff
  v_mfma_f32_16x16x32_bf16 v[200:203], v[104:107], v[88:91], v[200:203]
  ds_read_b128 v[124:127], v155 offset:5120
  ds_read_b64_tr_b16 v[136:137], v156 offset:8192
  v_cvt_pk_bf16_f32 v171, v54, v55
  v_mfma_f32_16x16x32_bf16 v[204:207], v[108:111], v[88:91], v[204:207]
  ds_read_b64_tr_b16 v[138:139], v156 offset:12288
  ds_read_b64_tr_b16 v[140:141], v157 offset:8192
  s_add_u32 m0, s62, 49152
  s_nop 0
  buffer_load_dwordx4 v144, s[16:19], s60 offen sc1 lds
  s_add_u32 s60, s60, 32768
  s_cmp_eq_u32 s60, s98
  s_cselect_b32 s60, s96, s60
  buffer_store_dwordx4 v[168:171], v144, s[12:15], s57 offen offset:0 sc1
  v_mfma_f32_16x16x32_bf16 v[208:211], v[104:107], v[92:95], v[208:211]
  ds_read_b64_tr_b16 v[142:143], v157 offset:12288
  s_mov_b64 exec, s[4:5]
  ds_write_b128 v159, v[168:171] offset:8192
  s_mov_b64 exec, -1
  v_mfma_f32_16x16x32_bf16 v[212:215], v[108:111], v[92:95], v[212:215]
  s_waitcnt vmcnt(13) lgkmcnt(0)
  s_barrier
  v_mfma_f32_16x16x32_bf16 v[200:203], v[128:131], v[112:115], v[200:203]
  ds_read_b128 v[80:83], v155 offset:24576
  ds_read_b128 v[84:87], v155 offset:25600
  v_cvt_pk_bf16_f32 v172, v56, v57
  v_mfma_f32_16x16x32_bf16 v[204:207], v[132:135], v[112:115], v[204:207]
  ds_read_b64_tr_b16 v[96:97], v156 offset:24576
  ds_read_b64_tr_b16 v[98:99], v156 offset:28672
  s_add_u32 m0, s61, 73728
  s_nop 0
  buffer_load_dwordx4 v148, s[32:35], s59 offen lds
  v_cvt_pk_bf16_f32 v173, v58, v59
  v_mfma_f32_16x16x32_bf16 v[208:211], v[128:131], v[116:119], v[208:211]
  ds_read_b64_tr_b16 v[100:101], v157 offset:24576
  ds_read_b64_tr_b16 v[102:103], v157 offset:28672
  v_cvt_pk_bf16_f32 v174, v60, v61
  v_mfma_f32_16x16x32_bf16 v[212:215], v[132:135], v[116:119], v[212:215]
  ds_read_b128 v[88:91], v155 offset:28672
  buffer_load_dwordx4 v149, s[32:35], s59 offen offset:1024 lds
  s_add_u32 s59, s59, 131072
  s_and_b32 s59, s59, 0x1fffff
  v_mfma_f32_16x16x32_bf16 v[200:203], v[136:139], v[120:123], v[200:203]
  ds_read_b128 v[92:95], v155 offset:29696
  ds_read_b64_tr_b16 v[104:105], v156 offset:32768
  v_cvt_pk_bf16_f32 v175, v62, v63
  v_mfma_f32_16x16x32_bf16 v[204:207], v[140:143], v[120:123], v[204:207]
  ds_read_b64_tr_b16 v[106:107], v156 offset:36864
  ds_read_b64_tr_b16 v[108:109], v157 offset:32768
  s_add_u32 m0, s62, 73728
  s_nop 0
  buffer_load_dwordx4 v144, s[16:19], s60 offen sc1 lds
  s_add_u32 s60, s60, 32768
  s_cmp_eq_u32 s60, s98
  s_cselect_b32 s60, s96, s60
  buffer_store_dwordx4 v[172:175], v144, s[12:15], s57 offen offset:1024 sc1
  s_add_u32 s57, s57, 4096
  v_mfma_f32_16x16x32_bf16 v[208:211], v[136:139], v[124:127], v[208:211]
  ds_read_b64_tr_b16 v[110:111], v157 offset:36864
  s_mov_b64 exec, s[4:5]
  ds_write_b128 v159, v[172:175] offset:9216
  s_mov_b64 exec, -1
  v_mfma_f32_16x16x32_bf16 v[212:215], v[140:143], v[124:127], v[212:215]
  s_waitcnt vmcnt(13) lgkmcnt(0)
  s_barrier
  v_mfma_f32_16x16x32_bf16 v[200:203], v[96:99], v[80:83], v[200:203]
  ds_read_b128 v[112:115], v150 offset:0
  ds_read_b128 v[116:119], v150 offset:1024
  v_cvt_pk_bf16_f32 v176, v64, v65
  v_mfma_f32_16x16x32_bf16 v[204:207], v[100:103], v[80:83], v[204:207]
  ds_read_b64_tr_b16 v[128:129], v151 offset:0
  ds_read_b64_tr_b16 v[130:131], v151 offset:4096
  s_add_u32 m0, s61, 98304
  s_nop 0
  buffer_load_dwordx4 v148, s[32:35], s59 offen lds
  v_cvt_pk_bf16_f32 v177, v66, v67
  v_mfma_f32_16x16x32_bf16 v[208:211], v[96:99], v[84:87], v[208:211]
  ds_read_b64_tr_b16 v[132:133], v152 offset:0
  ds_read_b64_tr_b16 v[134:135], v152 offset:4096
  v_cvt_pk_bf16_f32 v178, v68, v69
  v_mfma_f32_16x16x32_bf16 v[212:215], v[100:103], v[84:87], v[212:215]
  ds_read_b128 v[120:123], v150 offset:4096
  buffer_load_dwordx4 v149, s[32:35], s59 offen offset:1024 lds
  s_add_u32 s59, s59, 131072
  s_and_b32 s59, s59, 0x1fffff
  v_mfma_f32_16x16x32_bf16 v[200:203], v[104:107], v[88:91], v[200:203]
  ds_read_b128 v[124:127], v150 offset:5120
  ds_read_b64_tr_b16 v[136:137], v151 offset:8192
  v_cvt_pk_bf16_f32 v179, v70, v71
  v_mfma_f32_16x16x32_bf16 v[204:207], v[108:111], v[88:91], v[204:207]
  ds_read_b64_tr_b16 v[138:139], v151 offset:12288
  ds_read_b64_tr_b16 v[140:141], v152 offset:8192
  s_add_u32 m0, s62, 98304
  s_nop 0
  buffer_load_dwordx4 v144, s[16:19], s60 offen sc1 lds
  s_add_u32 s60, s60, 32768
  s_cmp_eq_u32 s60, s98
  s_cselect_b32 s60, s96, s60
  buffer_store_dwordx4 v[176:179], v144, s[12:15], s57 offen offset:0 sc1
  v_mfma_f32_16x16x32_bf16 v[208:211], v[104:107], v[92:95], v[208:211]
  ds_read_b64_tr_b16 v[142:143], v152 offset:12288
  s_mov_b64 exec, s[4:5]
  ds_write_b128 v159, v[176:179] offset:12288
  s_mov_b64 exec, -1
  v_mfma_f32_16x16x32_bf16 v[212:215], v[108:111], v[92:95], v[212:215]
  s_waitcnt vmcnt(13) lgkmcnt(0)
  s_barrier
  v_mfma_f32_16x16x32_bf16 v[200:203], v[128:131], v[112:115], v[200:203]
  ds_read_b128 v[80:83], v150 offset:24576
  ds_read_b128 v[84:87], v150 offset:25600
  v_cvt_pk_bf16_f32 v180, v72, v73
  v_mfma_f32_16x16x32_bf16 v[204:207], v[132:135], v[112:115], v[204:207]
  ds_read_b64_tr_b16 v[96:97], v151 offset:24576
  ds_read_b64_tr_b16 v[98:99], v151 offset:28672
  s_add_u32 m0, s61, 0
  s_nop 0
  buffer_load_dwordx4 v148, s[32:35], s59 offen lds
  v_cvt_pk_bf16_f32 v181, v74, v75
  v_mfma_f32_16x16x32_bf16 v[208:211], v[128:131], v[116:119], v[208:211]
  ds_read_b64_tr_b16 v[100:101], v152 offset:24576
  ds_read_b64_tr_b16 v[102:103], v152 offset:28672
  v_cvt_pk_bf16_f32 v182, v76, v77
  v_mfma_f32_16x16x32_bf16 v[212:215], v[132:135], v[116:119], v[212:215]
  ds_read_b128 v[88:91], v150 offset:28672
  buffer_load_dwordx4 v149, s[32:35], s59 offen offset:1024 lds
  s_add_u32 s59, s59, 131072
  s_branch L_tover_7
L_touch_7:
  s_branch L_tret_B0
L_tover_7:
  s_and_b32 s59, s59, 0x1fffff
  v_mfma_f32_16x16x32_bf16 v[200:203], v[136:139], v[120:123], v[200:203]
  ds_read_b128 v[92:95], v150 offset:29696
  ds_read_b64_tr_b16 v[104:105], v151 offset:32768
  v_cvt_pk_bf16_f32 v183, v78, v79
  v_mfma_f32_16x16x32_bf16 v[204:207], v[140:143], v[120:123], v[204:207]
  ds_read_b64_tr_b16 v[106:107], v151 offset:36864
  ds_read_b64_tr_b16 v[108:109], v152 offset:32768
  s_add_u32 m0, s62, 0
  s_nop 0
  buffer_load_dwordx4 v144, s[16:19], s60 offen sc1 lds
  s_add_u32 s60, s60, 32768
  s_cmp_eq_u32 s60, s98
  s_cselect_b32 s60, s96, s60
  buffer_store_dwordx4 v[180:183], v144, s[12:15], s57 offen offset:1024 sc1
  v_mfma_f32_16x16x32_bf16 v[208:211], v[136:139], v[124:127], v[208:211]
  ds_read_b64_tr_b16 v[110:111], v152 offset:36864
  s_mov_b64 exec, s[4:5]
  ds_write_b128 v159, v[180:183] offset:13312
  s_mov_b64 exec, -1
  v_mfma_f32_16x16x32_bf16 v[212:215], v[140:143], v[124:127], v[212:215]
  s_waitcnt vmcnt(13) lgkmcnt(0)
  s_barrier
  v_mfma_f32_16x16x32_bf16 v[200:203], v[96:99], v[80:83], v[200:203]
  ds_read_b128 v[112:115], v150 offset:49152
  ds_read_b128 v[116:119], v150 offset:50176
  v_mfma_f32_16x16x32_bf16 v[204:207], v[100:103], v[80:83], v[204:207]
  ds_read_b64_tr_b16 v[128:129], v151 offset:49152
  ds_read_b64_tr_b16 v[130:131], v151 offset:53248
  s_add_u32 m0, s61, 24576
  s_nop 0
  buffer_load_dwordx4 v148, s[32:35], s59 offen lds
  v_mfma_f32_16x16x32_bf16 v[208:211], v[96:99], v[84:87], v[208:211]
  ds_read_b64_tr_b16 v[132:133], v152 offset:49152
  ds_read_b64_tr_b16 v[134:135], v152 offset:53248
  v_mfma_f32_16x16x32_bf16 v[212:215], v[100:103], v[84:87], v[212:215]
  ds_read_b128 v[120:123], v150 offset:53248
  buffer_load_dwordx4 v149, s[32:35], s59 offen offset:1024 lds
  s_add_u32 s59, s59, 131072
  s_and_b32 s59, s59, 0x1fffff
  v_mfma_f32_16x16x32_bf16 v[200:203], v[104:107], v[88:91], v[200:203]
  ds_read_b128 v[124:127], v150 offset:54272
  ds_read_b64_tr_b16 v[136:137], v151 offset:57344
  v_mfma_f32_16x16x32_bf16 v[204:207], v[108:111], v[88:91], v[204:207]
  ds_read_b64_tr_b16 v[138:139], v151 offset:61440
  ds_read_b64_tr_b16 v[140:141], v152 offset:57344
  s_add_u32 m0, s62, 24576
  s_nop 0
  buffer_load_dwordx4 v144, s[16:19], s60 offen sc1 lds
  s_add_u32 s60, s60, 32768
  s_cmp_eq_u32 s60, s98
  s_cselect_b32 s60, s96, s60
  v_mfma_f32_16x16x32_bf16 v[208:211], v[104:107], v[92:95], v[208:211]
  ds_read_b64_tr_b16 v[142:143], v152 offset:61440
  v_mfma_f32_16x16x32_bf16 v[212:215], v[108:111], v[92:95], v[212:215]
  s_waitcnt vmcnt(3) lgkmcnt(0)
  s_barrier
  v_mfma_f32_16x16x32_bf16 v[200:203], v[128:131], v[112:115], v[200:203]
  ds_read_b128 v[80:83], v155 offset:0
  ds_read_b128 v[84:87], v155 offset:1024
  v_mfma_f32_16x16x32_bf16 v[204:207], v[132:135], v[112:115], v[204:207]
  ds_read_b64_tr_b16 v[96:97], v156 offset:0
  ds_read_b64_tr_b16 v[98:99], v156 offset:4096
  s_add_u32 m0, s61, 49152
  s_nop 0
  buffer_load_dwordx4 v148, s[32:35], s59 offen lds
  s_cmp_eq_u32 s44, 0
  s_cbranch_scc1 L_w0_f5
L_w0r_f5:
  v_mfma_f32_16x16x32_bf16 v[208:211], v[128:131], v[116:119], v[208:211]
  ds_read_b64_tr_b16 v[100:101], v157 offset:0
  ds_read_b64_tr_b16 v[102:103], v157 offset:4096
  v_mfma_f32_16x16x32_bf16 v[212:215], v[132:135], v[116:119], v[212:215]
  ds_read_b128 v[88:91], v155 offset:4096
  buffer_load_dwordx4 v149, s[32:35], s59 offen offset:1024 lds
  s_add_u32 s59, s59, 131072
  s_and_b32 s59, s59, 0x1fffff
  v_mfma_f32_16x16x32_bf16 v[200:203], v[136:139], v[120:123], v[200:203]
  ds_read_b128 v[92:95], v155 offset:5120
  ds_read_b64_tr_b16 v[104:105], v156 offset:8192
  v_mfma_f32_16x16x32_bf16 v[204:207], v[140:143], v[120:123], v[204:207]
  ds_read_b64_tr_b16 v[106:107], v156 offset:12288
  ds_read_b64_tr_b16 v[108:109], v157 offset:8192
  s_add_u32 m0, s62, 49152
  s_nop 0
  buffer_load_dwordx4 v144, s[16:19], s60 offen sc1 lds
  s_add_u32 s60, s60, 32768
  s_cmp_eq_u32 s60, s98
  s_cselect_b32 s60, s96, s60
  v_mfma_f32_16x16x32_bf16 v[208:211], v[136:139], v[124:127], v[208:211]
  ds_read_b64_tr_b16 v[110:111], v157 offset:12288
  v_mfma_f32_16x16x32_bf16 v[212:215], v[140:143], v[124:127], v[212:215]
  s_waitcnt vmcnt(11) lgkmcnt(0)
  s_barrier
  v_mfma_f32_16x16x32_bf16 v[200:203], v[96:99], v[80:83], v[200:203]
  ds_read_b128 v[112:115], v155 offset:24576
  ds_read_b128 v[116:119], v155 offset:25600
  v_and_b32 v1, 15, v0
  v_lshrrev_b32 v2, 4, v0
  s_lshl_b32 s51, s46, 8
  s_lshl_b32 s52, s49, 6
  s_add_u32 s51, s51, s52
  s_and_b32 s52, s44, 1
  s_lshl_b32 s52, s52, 5
  s_add_u32 s51, s51, s52
  v_mfma_f32_16x16x32_bf16 v[204:207], v[100:103], v[80:83], v[204:207]
  ds_read_b64_tr_b16 v[128:129], v156 offset:24576
  ds_read_b64_tr_b16 v[130:131], v156 offset:28672
  s_add_u32 m0, s61, 73728
  s_nop 0
  buffer_load_dwordx4 v148, s[32:35], s59 offen lds
  v_add_u32 v1, s51, v1
  v_lshlrev_b32 v1, 11, v1
  v_mfma_f32_16x16x32_bf16 v[208:211], v[96:99], v[84:87], v[208:211]
  ds_read_b64_tr_b16 v[132:133], v157 offset:24576
  ds_read_b64_tr_b16 v[134:135], v157 offset:28672
  v_lshrrev_b32 v3, 1, v2
  v_lshlrev_b32 v3, 4, v3
  v_mfma_f32_16x16x32_bf16 v[212:215], v[100:103], v[84:87], v[212:215]
  ds_read_b128 v[120:123], v155 offset:28672
  buffer_load_dwordx4 v149, s[32:35], s59 offen offset:1024 lds
  s_add_u32 s59, s59, 131072
  s_and_b32 s59, s59, 0x1fffff
  v_and_b32 v4, 1, v2
  v_lshl_add_u32 v3, v4, 5, v3
  v_mfma_f32_16x16x32_bf16 v[200:203], v[104:107], v[88:91], v[200:203]
  ds_read_b128 v[124:127], v155 offset:29696
  ds_read_b64_tr_b16 v[136:137], v156 offset:32768
  v_add_u32 v1, v1, v3
  s_lshl_b32 s51, s48, 8
  s_lshr_b32 s52, s44, 1
  s_lshl_b32 s52, s52, 6
  s_add_u32 s51, s51, s52
  s_mov_b32 s52, 32768
  v_mfma_f32_16x16x32_bf16 v[204:207], v[108:111], v[88:91], v[204:207]
  ds_read_b64_tr_b16 v[138:139], v156 offset:36864
  ds_read_b64_tr_b16 v[140:141], v157 offset:32768
  s_add_u32 m0, s62, 73728
  s_nop 0
  buffer_load_dwordx4 v144, s[16:19], s60 offen sc1 lds
  s_add_u32 s60, s60, 32768
  s_cmp_eq_u32 s60, s98
  s_cselect_b32 s60, s96, s60
  v_add_u32 v160, s51, v1
  buffer_load_dwordx4 v[216:219], v160, s[8:11], 0 offen
  v_mfma_f32_16x16x32_bf16 v[208:211], v[104:107], v[92:95], v[208:211]
  ds_read_b64_tr_b16 v[142:143], v157 offset:36864
  buffer_load_dwordx4 v[220:223], v160, s[8:11], s52 offen
  v_lshlrev_b32 v2, 3, v2
  v_mfma_f32_16x16x32_bf16 v[212:215], v[108:111], v[92:95], v[212:215]
  buffer_load_dwordx2 v[224:225], v2, s[40:43], s51 offen
  buffer_load_dwordx2 v[226:227], v2, s[40:43], s51 offen offset:32
  s_waitcnt vmcnt(14) lgkmcnt(0)
  s_barrier
  v_mfma_f32_16x16x32_bf16 v[200:203], v[128:131], v[112:115], v[200:203]
  ds_read_b128 v[80:83], v150 offset:0
  ds_read_b128 v[84:87], v150 offset:1024
  v_mfma_f32_16x16x32_bf16 v[204:207], v[132:135], v[112:115], v[204:207]
  ds_read_b64_tr_b16 v[96:97], v151 offset:0
  ds_read_b64_tr_b16 v[98:99], v151 offset:4096
  v_mfma_f32_16x16x32_bf16 v[208:211], v[128:131], v[116:119], v[208:211]
  ds_read_b64_tr_b16 v[100:101], v152 offset:0
  ds_read_b64_tr_b16 v[102:103], v152 offset:4096
  v_mfma_f32_16x16x32_bf16 v[212:215], v[132:135], v[116:119], v[212:215]
  ds_read_b128 v[88:91], v150 offset:4096
  v_mfma_f32_16x16x32_bf16 v[200:203], v[136:139], v[120:123], v[200:203]
  ds_read_b128 v[92:95], v150 offset:5120
  ds_read_b64_tr_b16 v[104:105], v151 offset:8192
  v_mfma_f32_16x16x32_bf16 v[204:207], v[140:143], v[120:123], v[204:207]
  ds_read_b64_tr_b16 v[106:107], v151 offset:12288
  ds_read_b64_tr_b16 v[108:109], v152 offset:8192
  s_lshl_b32 s51, s46, 3
  s_add_u32 s51, s51, s48
  s_lshl_b32 s51, s51, 8
  s_add_u32 s51, s51, 0x8c000
  v_and_b32 v1, 3, v0
  v_mfma_f32_16x16x32_bf16 v[208:211], v[136:139], v[124:127], v[208:211]
  ds_read_b64_tr_b16 v[110:111], v152 offset:12288
  v_lshlrev_b32 v1, 2, v1
  v_mfma_f32_16x16x32_bf16 v[212:215], v[140:143], v[124:127], v[212:215]
  buffer_load_dword v158, v1, s[16:19], s51 offen sc1
  s_waitcnt vmcnt(11) lgkmcnt(0)
  s_barrier
  v_mfma_f32_16x16x32_bf16 v[200:203], v[96:99], v[80:83], v[200:203]
  ds_read_b128 v[112:115], v150 offset:24576
  ds_read_b128 v[116:119], v150 offset:25600
  v_mfma_f32_16x16x32_bf16 v[204:207], v[100:103], v[80:83], v[204:207]
  ds_read_b64_tr_b16 v[128:129], v151 offset:24576
  ds_read_b64_tr_b16 v[130:131], v151 offset:28672
  v_mfma_f32_16x16x32_bf16 v[208:211], v[96:99], v[84:87], v[208:211]
  ds_read_b64_tr_b16 v[132:133], v152 offset:24576
  ds_read_b64_tr_b16 v[134:135], v152 offset:28672
  v_mfma_f32_16x16x32_bf16 v[212:215], v[100:103], v[84:87], v[212:215]
  ds_read_b128 v[120:123], v150 offset:28672
  v_mfma_f32_16x16x32_bf16 v[200:203], v[104:107], v[88:91], v[200:203]
  ds_read_b128 v[124:127], v150 offset:29696
  ds_read_b64_tr_b16 v[136:137], v151 offset:32768
  v_mfma_f32_16x16x32_bf16 v[204:207], v[108:111], v[88:91], v[204:207]
  ds_read_b64_tr_b16 v[138:139], v151 offset:36864
  ds_read_b64_tr_b16 v[140:141], v152 offset:32768
  v_mfma_f32_16x16x32_bf16 v[208:211], v[104:107], v[92:95], v[208:211]
  ds_read_b64_tr_b16 v[142:143], v152 offset:36864
  v_mfma_f32_16x16x32_bf16 v[212:215], v[108:111], v[92:95], v[212:215]
  s_waitcnt vmcnt(8) lgkmcnt(0)
  s_barrier
  v_mfma_f32_16x16x32_bf16 v[200:203], v[128:131], v[112:115], v[200:203]
  ds_read_b128 v[80:83], v150 offset:49152
  ds_read_b128 v[84:87], v150 offset:50176
  s_waitcnt vmcnt(0)
  v_cmp_gt_u32 vcc, 1, v158
  v_mfma_f32_16x16x32_bf16 v[204:207], v[132:135], v[112:115], v[204:207]
  ds_read_b64_tr_b16 v[96:97], v151 offset:49152
  ds_read_b64_tr_b16 v[98:99], v151 offset:53248
  s_nop 0
  s_cmp_eq_u64 vcc, 0
  s_cbranch_scc0 L_spin_f5
L_spinr_f5:
  s_lshl_b32 s51, s3, 2
  s_add_u32 s51, s51, s49
  s_lshl_b32 s51, s51, 16
  s_and_b32 s52, s44, 1
  s_lshl_b32 s52, s52, 13
  s_lshr_b32 s53, s44, 1
  s_lshl_b32 s53, s53, 10
  s_add_u32 s52, s52, s53
  s_add_u32 s51, s51, s52
  s_add_u32 s51, s51, 0x1800000
  v_mfma_f32_16x16x32_bf16 v[208:211], v[128:131], v[116:119], v[208:211]
  ds_read_b64_tr_b16 v[100:101], v152 offset:49152
  ds_read_b64_tr_b16 v[102:103], v152 offset:53248
  s_add_u32 s53, s49, 1
  s_and_b32 s53, s53, 3
  s_lshl_b32 s53, s53, 14
  s_add_u32 s53, s53, s51
  s_add_u32 s54, s53, 4096
  buffer_load_dwordx4 v[228:231], v144, s[16:19], s53 offen sc1
  buffer_load_dwordx4 v[232:235], v144, s[16:19], s54 offen sc1
  v_mfma_f32_16x16x32_bf16 v[212:215], v[132:135], v[116:119], v[212:215]
  ds_read_b128 v[88:91], v150 offset:53248
  s_add_u32 s53, s49, 2
  s_and_b32 s53, s53, 3
  s_lshl_b32 s53, s53, 14
  s_add_u32 s53, s53, s51
  s_add_u32 s54, s53, 4096
  buffer_load_dwordx4 v[236:239], v144, s[16:19], s53 offen sc1
  v_mfma_f32_16x16x32_bf16 v[200:203], v[136:139], v[120:123], v[200:203]
  ds_read_b128 v[92:95], v150 offset:54272
  ds_read_b64_tr_b16 v[104:105], v151 offset:57344
  buffer_load_dwordx4 v[240:243], v144, s[16:19], s54 offen sc1
  s_add_u32 s53, s49, 3
  s_and_b32 s53, s53, 3
  s_lshl_b32 s53, s53, 14
  s_add_u32 s53, s53, s51
  s_add_u32 s54, s53, 4096
  buffer_load_dwordx4 v[244:247], v144, s[16:19], s53 offen sc1
  v_mfma_f32_16x16x32_bf16 v[204:207], v[140:143], v[120:123], v[204:207]
  ds_read_b64_tr_b16 v[106:107], v151 offset:61440
  ds_read_b64_tr_b16 v[108:109], v152 offset:57344
  buffer_load_dwordx4 v[248:251], v144, s[16:19], s54 offen sc1
  s_add_u32 s52, s52, 122880
  v_mfma_f32_16x16x32_bf16 v[208:211], v[136:139], v[124:127], v[208:211]
  ds_read_b64_tr_b16 v[110:111], v152 offset:61440
  v_add_u32 v1, s52, v144
  ds_read_b128 v[16:19], v1
  v_mfma_f32_16x16x32_bf16 v[212:215], v[140:143], v[124:127], v[212:215]
  ds_read_b128 v[20:23], v1 offset:4096
  s_waitcnt vmcnt(11) lgkmcnt(0)
  s_barrier
  v_mfma_f32_16x16x32_bf16 v[200:203], v[96:99], v[80:83], v[200:203]
  ds_read_b128 v[112:115], v155 offset:0
  ds_read_b128 v[116:119], v155 offset:1024
  v_mfma_f32_16x16x32_bf16 v[204:207], v[100:103], v[80:83], v[204:207]
  ds_read_b64_tr_b16 v[128:129], v156 offset:0
  ds_read_b64_tr_b16 v[130:131], v156 offset:4096
  v_mfma_f32_16x16x32_bf16 v[208:211], v[96:99], v[84:87], v[208:211]
  ds_read_b64_tr_b16 v[132:133], v157 offset:0
  ds_read_b64_tr_b16 v[134:135], v157 offset:4096
  v_mfma_f32_16x16x32_bf16 v[212:215], v[100:103], v[84:87], v[212:215]
  ds_read_b128 v[120:123], v155 offset:4096
  v_mfma_f32_16x16x32_bf16 v[200:203], v[104:107], v[88:91], v[200:203]
  ds_read_b128 v[124:127], v155 offset:5120
  ds_read_b64_tr_b16 v[136:137], v156 offset:8192
  v_mfma_f32_16x16x32_bf16 v[204:207], v[108:111], v[88:91], v[204:207]
  ds_read_b64_tr_b16 v[138:139], v156 offset:12288
  ds_read_b64_tr_b16 v[140:141], v157 offset:8192
  v_mfma_f32_16x16x32_bf16 v[208:211], v[104:107], v[92:95], v[208:211]
  ds_read_b64_tr_b16 v[142:143], v157 offset:12288
  v_mfma_f32_16x16x32_bf16 v[212:215], v[108:111], v[92:95], v[212:215]
  s_waitcnt lgkmcnt(0)
  v_mfma_f32_16x16x32_bf16 v[200:203], v[128:131], v[112:115], v[200:203]
  v_mfma_f32_16x16x32_bf16 v[204:207], v[132:135], v[112:115], v[204:207]
  v_mfma_f32_16x16x32_bf16 v[208:211], v[128:131], v[116:119], v[208:211]
  v_mfma_f32_16x16x32_bf16 v[212:215], v[132:135], v[116:119], v[212:215]
  v_mfma_f32_16x16x32_bf16 v[200:203], v[136:139], v[120:123], v[200:203]
  v_mfma_f32_16x16x32_bf16 v[204:207], v[140:143], v[120:123], v[204:207]
  v_mfma_f32_16x16x32_bf16 v[208:211], v[136:139], v[124:127], v[208:211]
  v_mfma_f32_16x16x32_bf16 v[212:215], v[140:143], v[124:127], v[212:215]
  s_mov_b32 s99, 0x00003f80
  s_mov_b32 s6, 0x3f800000
  s_mov_b32 s100, 0xbfb8aa3b
  s_mov_b32 s101, 0xbfb8aa3b
  s_waitcnt vmcnt(7) lgkmcnt(0)
  v_lshlrev_b32 v24, 16, v224
  v_and_b32 v25, 0xffff0000, v224
  v_lshlrev_b32 v26, 16, v225
  v_and_b32 v27, 0xffff0000, v225
  v_lshlrev_b32 v28, 16, v226
  v_and_b32 v29, 0xffff0000, v226
  v_lshlrev_b32 v30, 16, v227
  v_and_b32 v31, 0xffff0000, v227
  v_mov_b64 v[32:33], v[24:25]
  v_mov_b64 v[34:35], v[26:27]
  v_mov_b64 v[36:37], v[28:29]
  v_mov_b64 v[38:39], v[30:31]
  v_dot2c_f32_bf16 v24, s99, v16
  v_dot2c_f32_bf16 v25, s6, v16
  v_dot2c_f32_bf16 v28, s99, v18
  v_dot2c_f32_bf16 v29, s6, v18
  v_dot2c_f32_bf16 v32, s99, v20
  v_dot2c_f32_bf16 v33, s6, v20
  v_dot2c_f32_bf16 v36, s99, v22
  v_dot2c_f32_bf16 v37, s6, v22
  v_dot2c_f32_bf16 v26, s99, v17
  v_dot2c_f32_bf16 v27, s6, v17
  v_dot2c_f32_bf16 v30, s99, v19
  v_dot2c_f32_bf16 v31, s6, v19
  v_dot2c_f32_bf16 v34, s99, v21
  v_dot2c_f32_bf16 v35, s6, v21
  v_dot2c_f32_bf16 v38, s99, v23
  v_dot2c_f32_bf16 v39, s6, v23
  v_permlane16_swap_b32 v216, v218
  v_permlane16_swap_b32 v217, v219
  v_permlane16_swap_b32 v220, v222
  v_permlane16_swap_b32 v221, v223
  v_lshlrev_b32 v40, 16, v216
  v_and_b32 v41, 0xffff0000, v216
  v_lshlrev_b32 v42, 16, v217
  v_and_b32 v43, 0xffff0000, v217
  v_lshlrev_b32 v44, 16, v218
  v_and_b32 v45, 0xffff0000, v218
  v_lshlrev_b32 v46, 16, v219
  v_and_b32 v47, 0xffff0000, v219
  v_lshlrev_b32 v48, 16, v220
  v_and_b32 v49, 0xffff0000, v220
  v_lshlrev_b32 v50, 16, v221
  v_and_b32 v51, 0xffff0000, v221
  v_lshlrev_b32 v52, 16, v222
  v_and_b32 v53, 0xffff0000, v222
  v_lshlrev_b32 v54, 16, v223
  v_and_b32 v55, 0xffff0000, v223
  s_waitcnt vmcnt(4)
  v_dot2c_f32_bf16 v24, s99, v228
  v_dot2c_f32_bf16 v25, s6, v228
  v_dot2c_f32_bf16 v28, s99, v230
  v_dot2c_f32_bf16 v29, s6, v230
  v_dot2c_f32_bf16 v32, s99, v232
  v_dot2c_f32_bf16 v33, s6, v232
  v_dot2c_f32_bf16 v36, s99, v234
  v_dot2c_f32_bf16 v37, s6, v234
  v_dot2c_f32_bf16 v26, s99, v229
  v_dot2c_f32_bf16 v27, s6, v229
  v_dot2c_f32_bf16 v30, s99, v231
  v_dot2c_f32_bf16 v31, s6, v231
  v_dot2c_f32_bf16 v34, s99, v233
  v_dot2c_f32_bf16 v35, s6, v233
  v_dot2c_f32_bf16 v38, s99, v235
  v_dot2c_f32_bf16 v39, s6, v235
  s_waitcnt vmcnt(2)
  v_dot2c_f32_bf16 v24, s99, v236
  v_dot2c_f32_bf16 v25, s6, v236
  v_dot2c_f32_bf16 v28, s99, v238
  v_dot2c_f32_bf16 v29, s6, v238
  v_dot2c_f32_bf16 v32, s99, v240
  v_dot2c_f32_bf16 v33, s6, v240
  v_dot2c_f32_bf16 v36, s99, v242
  v_dot2c_f32_bf16 v37, s6, v242
  v_dot2c_f32_bf16 v26, s99, v237
  v_dot2c_f32_bf16 v27, s6, v237
  v_dot2c_f32_bf16 v30, s99, v239
  v_dot2c_f32_bf16 v31, s6, v239
  v_dot2c_f32_bf16 v34, s99, v241
  v_dot2c_f32_bf16 v35, s6, v241
  v_dot2c_f32_bf16 v38, s99, v243
  v_dot2c_f32_bf16 v39, s6, v243
  s_waitcnt vmcnt(0)
  v_dot2c_f32_bf16 v24, s99, v244
  v_dot2c_f32_bf16 v25, s6, v244
  v_dot2c_f32_bf16 v28, s99, v246
  v_dot2c_f32_bf16 v29, s6, v246
  v_dot2c_f32_bf16 v32, s99, v248
  v_dot2c_f32_bf16 v33, s6, v248
  v_dot2c_f32_bf16 v36, s99, v250
  v_dot2c_f32_bf16 v37, s6, v250
  v_dot2c_f32_bf16 v26, s99, v245
  v_dot2c_f32_bf16 v27, s6, v245
  v_dot2c_f32_bf16 v30, s99, v247
  v_dot2c_f32_bf16 v31, s6, v247
  v_dot2c_f32_bf16 v34, s99, v249
  v_dot2c_f32_bf16 v35, s6, v249
  v_dot2c_f32_bf16 v38, s99, v251
  v_dot2c_f32_bf16 v39, s6, v251
  v_pk_mul_f32 v[56:57], v[24:25], s[100:101]
  v_pk_mul_f32 v[58:59], v[26:27], s[100:101]
  v_pk_mul_f32 v[60:61], v[28:29], s[100:101]
  v_pk_mul_f32 v[62:63], v[30:31], s[100:101]
  v_pk_mul_f32 v[64:65], v[32:33], s[100:101]
  v_pk_mul_f32 v[66:67], v[34:35], s[100:101]
  v_pk_mul_f32 v[68:69], v[36:37], s[100:101]
  v_pk_mul_f32 v[70:71], v[38:39], s[100:101]
  v_exp_f32 v56, v56
  v_exp_f32 v57, v57
  v_exp_f32 v58, v58
  v_exp_f32 v59, v59
  v_exp_f32 v60, v60
  v_exp_f32 v61, v61
  v_exp_f32 v62, v62
  v_exp_f32 v63, v63
  v_exp_f32 v64, v64
  v_exp_f32 v65, v65
  v_exp_f32 v66, v66
  v_exp_f32 v67, v67
  v_exp_f32 v68, v68
  v_exp_f32 v69, v69
  v_exp_f32 v70, v70
  v_exp_f32 v71, v71
  v_pk_add_f32 v[56:57], v[56:57], 1.0 op_sel_hi:[1,0]
  v_pk_add_f32 v[58:59], v[58:59], 1.0 op_sel_hi:[1,0]
  v_pk_add_f32 v[60:61], v[60:61], 1.0 op_sel_hi:[1,0]
  v_pk_add_f32 v[62:63], v[62:63], 1.0 op_sel_hi:[1,0]
  v_pk_add_f32 v[64:65], v[64:65], 1.0 op_sel_hi:[1,0]
  v_pk_add_f32 v[66:67], v[66:67], 1.0 op_sel_hi:[1,0]
  v_pk_add_f32 v[68:69], v[68:69], 1.0 op_sel_hi:[1,0]
  v_pk_add_f32 v[70:71], v[70:71], 1.0 op_sel_hi:[1,0]
  v_rcp_f32 v56, v56
  v_rcp_f32 v57, v57
  v_rcp_f32 v58, v58
  v_rcp_f32 v59, v59
  v_rcp_f32 v60, v60
  v_rcp_f32 v61, v61
  v_rcp_f32 v62, v62
  v_rcp_f32 v63, v63
  v_rcp_f32 v64, v64
  v_rcp_f32 v65, v65
  v_rcp_f32 v66, v66
  v_rcp_f32 v67, v67
  v_rcp_f32 v68, v68
  v_rcp_f32 v69, v69
  v_rcp_f32 v70, v70
  v_rcp_f32 v71, v71
  v_pk_mul_f32 v[24:25], v[24:25], v[56:57]
  v_pk_mul_f32 v[26:27], v[26:27], v[58:59]
  v_pk_mul_f32 v[28:29], v[28:29], v[60:61]
  v_pk_mul_f32 v[30:31], v[30:31], v[62:63]
  v_pk_mul_f32 v[32:33], v[32:33], v[64:65]
  v_pk_mul_f32 v[34:35], v[34:35], v[66:67]
  v_pk_mul_f32 v[36:37], v[36:37], v[68:69]
  v_pk_mul_f32 v[38:39], v[38:39], v[70:71]
  v_pk_fma_f32 v[24:25], v[24:25], v[200:201], v[40:41]
  v_pk_fma_f32 v[26:27], v[26:27], v[202:203], v[42:43]
  v_pk_fma_f32 v[28:29], v[28:29], v[204:205], v[44:45]
  v_pk_fma_f32 v[30:31], v[30:31], v[206:207], v[46:47]
  v_pk_fma_f32 v[32:33], v[32:33], v[208:209], v[48:49]
  v_pk_fma_f32 v[34:35], v[34:35], v[210:211], v[50:51]
  v_pk_fma_f32 v[36:37], v[36:37], v[212:213], v[52:53]
  v_pk_fma_f32 v[38:39], v[38:39], v[214:215], v[54:55]
  s_mov_b32 s52, 32768
  v_cvt_pk_bf16_f32 v72, v24, v25
  v_cvt_pk_bf16_f32 v73, v26, v27
  v_cvt_pk_bf16_f32 v74, v28, v29
  v_cvt_pk_bf16_f32 v75, v30, v31
  s_nop 0
  v_permlane16_swap_b32 v72, v74
  v_permlane16_swap_b32 v73, v75
  buffer_store_dwordx4 v[72:75], v160, s[36:39], 0 offen
  v_cvt_pk_bf16_f32 v76, v32, v33
  v_cvt_pk_bf16_f32 v77, v34, v35
  v_cvt_pk_bf16_f32 v78, v36, v37
  v_cvt_pk_bf16_f32 v79, v38, v39
  s_nop 0
  v_permlane16_swap_b32 v76, v78
  v_permlane16_swap_b32 v77, v79
  buffer_store_dwordx4 v[76:79], v160, s[36:39], s52 offen
L_exit:
  s_endpgm
L_spin_s1A:
  v_and_b32 v1, 1, v0
  v_lshlrev_b32 v1, 7, v1
  v_bfe_u32 v2, v0, 1, 2
  v_lshl_add_u32 v1, v2, 2, v1
  s_mov_b32 s54, 0
  s_mov_b32 s7, 0x40000
L_pg_10:
  buffer_load_dword v254, v1, s[20:23], s54 offen sc1
  s_waitcnt vmcnt(0)
  v_cmp_gt_u32 vcc, 32, v254
  s_nop 1
  s_cmp_eq_u64 vcc, 0
  s_cbranch_scc1 L_pg_10_done
  s_sub_u32 s7, s7, 1
  s_cmp_eq_u32 s7, 0
  s_cbranch_scc1 L_pg_10_done
  s_sleep 4
  s_branch L_pg_10
L_pg_10_done:
  s_branch L_spinr_s1A
L_spin_s1B:
  v_and_b32 v1, 1, v0
  v_lshlrev_b32 v1, 7, v1
  v_bfe_u32 v2, v0, 1, 2
  v_lshl_add_u32 v1, v2, 2, v1
  s_mov_b32 s54, 0
  s_mov_b32 s7, 0x40000
L_pg_11:
  buffer_load_dword v254, v1, s[20:23], s54 offen sc1
  s_waitcnt vmcnt(0)
  v_cmp_gt_u32 vcc, 32, v254
  s_nop 1
  s_cmp_eq_u64 vcc, 0
  s_cbranch_scc1 L_pg_11_done
  s_sub_u32 s7, s7, 1
  s_cmp_eq_u32 s7, 0
  s_cbranch_scc1 L_pg_11_done
  s_sleep 4
  s_branch L_pg_11
L_pg_11_done:
  s_branch L_spinr_s1B
L_w0_f2:
  s_lshl_b32 s51, s50, 8
  s_add_u32 s51, s51, 0x84000
  s_lshl_b32 s56, s46, 2
  s_add_u32 s51, s51, s56
  v_mov_b32 v1, 1
  v_mov_b32 v2, 0
  s_mov_b64 exec, 1
  buffer_store_dword v1, v2, s[16:19], s51 offen sc1
  s_mov_b64 exec, -1
  s_branch L_w0r_f2
L_spin_f2:
  s_lshl_b32 s51, s50, 8
  s_add_u32 s51, s51, 0x84000
  v_and_b32 v1, 7, v0
  v_lshlrev_b32 v1, 2, v1
  s_mov_b32 s7, 0x40000
L_pg_6:
  buffer_load_dword v158, v1, s[16:19], s51 offen sc1
  s_waitcnt vmcnt(0)
  v_cmp_gt_u32 vcc, 1, v158
  s_nop 1
  s_cmp_eq_u64 vcc, 0
  s_cbranch_scc1 L_pg_6_done
  s_sub_u32 s7, s7, 1
  s_cmp_eq_u32 s7, 0
  s_cbranch_scc1 L_pg_6_done
  s_sleep 2
  s_branch L_pg_6
L_pg_6_done:
  s_branch L_spinr_f2
L_w0_f4:
  s_lshl_b32 s51, s46, 8
  s_add_u32 s51, s51, 0x88000
  s_lshl_b32 s56, s50, 2
  s_add_u32 s51, s51, s56
  v_mov_b32 v1, 1
  v_mov_b32 v2, 0
  s_mov_b64 exec, 1
  buffer_store_dword v1, v2, s[16:19], s51 offen sc1
  s_mov_b64 exec, -1
  s_branch L_w0r_f4
L_spin_f4:
  s_lshl_b32 s51, s46, 8
  s_add_u32 s51, s51, 0x88000
  v_and_b32 v1, 31, v0
  v_lshlrev_b32 v1, 2, v1
  s_mov_b32 s7, 0x40000
L_pg_7:
  buffer_load_dword v158, v1, s[16:19], s51 offen sc1
  s_waitcnt vmcnt(0)
  v_cmp_gt_u32 vcc, 1, v158
  s_nop 1
  s_cmp_eq_u64 vcc, 0
  s_cbranch_scc1 L_pg_7_done
  s_sub_u32 s7, s7, 1
  s_cmp_eq_u32 s7, 0
  s_cbranch_scc1 L_pg_7_done
  s_sleep 2
  s_branch L_pg_7
L_pg_7_done:
  s_branch L_spinr_f4
L_w0_f5:
  s_lshl_b32 s51, s46, 3
  s_add_u32 s51, s51, s48
  s_lshl_b32 s51, s51, 8
  s_add_u32 s51, s51, 0x8c000
  s_lshl_b32 s56, s49, 2
  s_add_u32 s51, s51, s56
  v_mov_b32 v1, 1
  v_mov_b32 v2, 0
  s_mov_b64 exec, 1
  buffer_store_dword v1, v2, s[16:19], s51 offen sc1
  s_mov_b64 exec, -1
  s_branch L_w0r_f5
L_spin_f5:
  s_lshl_b32 s51, s46, 3
  s_add_u32 s51, s51, s48
  s_lshl_b32 s51, s51, 8
  s_add_u32 s51, s51, 0x8c000
  v_and_b32 v1, 3, v0
  v_lshlrev_b32 v1, 2, v1
  s_mov_b32 s7, 0x40000
L_pg_8:
  buffer_load_dword v158, v1, s[16:19], s51 offen sc1
  s_waitcnt vmcnt(0)
  v_cmp_gt_u32 vcc, 1, v158
  s_nop 1
  s_cmp_eq_u64 vcc, 0
  s_cbranch_scc1 L_pg_8_done
  s_sub_u32 s7, s7, 1
  s_cmp_eq_u32 s7, 0
  s_cbranch_scc1 L_pg_8_done
  s_sleep 2
  s_branch L_pg_8
L_pg_8_done:
  s_branch L_spinr_f5
L_spin_f3:
  s_waitcnt vmcnt(0)
  s_lshl_b32 s51, s46, 2
  s_add_u32 s51, s51, s49
  s_lshl_b32 s51, s51, 8
  s_add_u32 s51, s51, 0x80000
  v_and_b32 v1, 7, v0
  v_lshlrev_b32 v1, 2, v1
  s_mov_b32 s7, 0x40000
  v_cmp_gt_u32 vcc, 1, v159
  s_nop 1
  s_cmp_eq_u64 vcc, 0
  s_cbranch_scc1 L_pg_9_done
L_pg_9:
  buffer_load_dword v159, v1, s[16:19], s51 offen sc1
  s_waitcnt vmcnt(0)
  v_cmp_gt_u32 vcc, 1, v159
  s_nop 1
  s_cmp_eq_u64 vcc, 0
  s_cbranch_scc1 L_pg_9_done
  s_sub_u32 s7, s7, 1
  s_cmp_eq_u32 s7, 0
  s_cbranch_scc1 L_pg_9_done
  s_sleep 1
  s_branch L_pg_9
L_pg_9_done:
  s_branch L_spinr_f3
  s_endpgm
L_touch_8:
  s_branch L_tret_B1
.section .rodata,"a"
.p2align 6
.amdhsa_kernel recurrent_scan__linear_kernel_hedgehog__dense_activation_squared_relu__prompt_kernel
  .amdhsa_next_free_vgpr 256
  .amdhsa_next_free_sgpr 102
  .amdhsa_accum_offset 256
  .amdhsa_group_segment_fixed_size 0
  .amdhsa_kernarg_size 96
  .amdhsa_user_sgpr_count 2
  .amdhsa_user_sgpr_kernarg_segment_ptr 1
  .amdhsa_system_sgpr_workgroup_id_x 1
.end_amdhsa_kernel
```
